```python
import torch

def _softmax(x, axis=-1):
    return torch.softmax(x, dim=axis)
def _gelu(x):
    return torch.nn.functional.gelu(x, approximate="tanh")
def _silu(x):
    return torch.nn.functional.silu(x)
def _sigmoid(x):
    return torch.sigmoid(x)
def _layernorm(x, axis=-1, eps=1e-5):
    m = x.mean(dim=axis, keepdim=True)
    v = x.var(dim=axis, keepdim=True, unbiased=False)
    return (x - m) / torch.sqrt(v + eps)
def _scatter_add(tgt, idx, src, axis=0):
    return tgt.clone().index_add_(axis, idx, src)
def _segment_sum(src, seg, n):
    out = torch.zeros((n,) + src.shape[1:], dtype=src.dtype)
    return out.index_add_(0, seg, src)
def _pad(x, pw):
    flat = tuple(v for pair in reversed(pw) for v in pair)
    return torch.nn.functional.pad(x, flat)

kernel_name = 'concat_heads__mha_block_cached__gqa_block_cached__near_ridge'

def setup_inputs():

    _w = (lambda a: (lambda t: t.to(torch.bfloat16) if t.is_floating_point() else t)(torch.as_tensor(a)))
    def _A_setup():
        B, Sq, D = 8, 144, 576
        H, Sk, Dh = 32, 512, 128
        return {
            "x": _w((lambda *s: torch.randn(*s, dtype=torch.bfloat16) * 0.8)(B, Sq, D)),
            "k_cache": _w((lambda *s: torch.randn(*s, dtype=torch.bfloat16) * 0.8)(B, H, Sk, Dh)),
            "v_cache": _w((lambda *s: torch.randn(*s, dtype=torch.bfloat16) * 0.05)(B, H, Sk, Dh)),
            "wq": _w((lambda *s: torch.randn(*s, dtype=torch.bfloat16) * 0.8)(D, H * Dh) * (D ** -0.5)),
            "wo": _w((lambda *s: torch.randn(*s, dtype=torch.bfloat16) * 0.05)(H * Dh, D) * ((H * Dh) ** -0.5)),
        }
    _A_in = _A_setup()

    def _B_setup():
        B, Sq, D = 8, 144, 576
        Hq, Hkv, Sk, Dh = 32, 32, 512, 128
        assert Hq % Hkv == 0, (Hq, Hkv)
        return {
            "x": _w((lambda *s: torch.randn(*s, dtype=torch.bfloat16) * 0.8)(B, Sq, D)),
            "k_cache": _w((lambda *s: torch.randn(*s, dtype=torch.bfloat16) * 0.8)(B, Hkv, Sk, Dh)),
            "v_cache": _w((lambda *s: torch.randn(*s, dtype=torch.bfloat16) * 0.05)(B, Hkv, Sk, Dh)),
            "wq": _w((lambda *s: torch.randn(*s, dtype=torch.bfloat16) * 0.8)(D, Hq * Dh) * (D ** -0.5)),
            "wo": _w((lambda *s: torch.randn(*s, dtype=torch.bfloat16) * 0.05)(Hq * Dh, D) * ((Hq * Dh) ** -0.5)),
        }
    _B_in = _B_setup()

    return {
        "A_x": _A_in["x"],
        "A_k_cache": _A_in["k_cache"],
        "A_v_cache": _A_in["v_cache"],
        "A_wq": _A_in["wq"],
        "A_wo": _A_in["wo"],
        "B_x": _B_in["x"],
        "B_k_cache": _B_in["k_cache"],
        "B_v_cache": _B_in["v_cache"],
        "B_wq": _B_in["wq"],
        "B_wo": _B_in["wo"],
    }

def reference(A_x, A_k_cache, A_v_cache, A_wq, A_wo, B_x, B_k_cache, B_v_cache, B_wq, B_wo):
    def _A_ref(x, k_cache, v_cache, wq, wo):
        B, Sq, D = x.shape
        H, Dh = 32, 128
        q = (lambda x, *d: x.permute(*d))((x @ wq).reshape(B, Sq, H, Dh), 0, 2, 1, 3)
        scores = torch.einsum("bhqd,bhkd->bhqk", q, k_cache) * (Dh ** -0.5)
        p = _softmax(scores, axis=-1)
        o = torch.einsum("bhqk,bhkd->bhqd", p, v_cache)
        return (lambda x, *d: x.permute(*d))(o, 0, 2, 1, 3).reshape(B, Sq, H * Dh) @ wo

    def _B_ref(x, k_cache, v_cache, wq, wo):
        B, Sq, D = x.shape
        Hq, Dh = 32, 128
        Hkv = k_cache.shape[1]
        rep = Hq // Hkv
        q = (lambda x, *d: x.permute(*d))((x @ wq).reshape(B, Sq, Hq, Dh), 0, 2, 1, 3)
        k = (lambda x, n, axis: torch.repeat_interleave(x, n, dim=axis))(k_cache, rep, axis=1)
        v = (lambda x, n, axis: torch.repeat_interleave(x, n, dim=axis))(v_cache, rep, axis=1)
        scores = torch.einsum("bhqd,bhkd->bhqk", q, k) * (Dh ** -0.5)
        p = _softmax(scores, axis=-1)
        o = torch.einsum("bhqk,bhkd->bhqd", p, v)
        return (lambda x, *d: x.permute(*d))(o, 0, 2, 1, 3).reshape(B, Sq, Hq * Dh) @ wo

    a = _A_ref(A_x, A_k_cache, A_v_cache, A_wq, A_wo)
    b = _B_ref(B_x, B_k_cache, B_v_cache, B_wq, B_wo)
    return torch.concatenate([a, b], axis=-1)
```

```asm
; @launch grid=(256,1,1) block=(512,1,1) lds=163840
.amdgcn_target "amdgcn-amd-amdhsa--gfx950"
.text
.globl concat_heads__mha_block_cached__gqa_block_cached__near_ridge_kernel
.p2align 8
.type concat_heads__mha_block_cached__gqa_block_cached__near_ridge_kernel,@function
concat_heads__mha_block_cached__gqa_block_cached__near_ridge_kernel:
  s_cmp_ge_u32 s2, 256
  s_cbranch_scc1 .Lk1_end
  s_load_dwordx8 s[8:15], s[0:1], 0
  s_load_dwordx8 s[16:23], s[0:1], 40
  s_load_dwordx2 s[24:25], s[0:1], 96
  s_load_dwordx2 s[82:83], s[0:1], 88
  s_getpc_b64 s[56:57]
.Lpc_k1:
  s_sub_u32 s56, s56, .Lpc_k1-concat_heads__mha_block_cached__gqa_block_cached__near_ridge_kernel
  s_subb_u32 s57, s57, 0
  s_lshr_b32 s3, s2, 3
  s_lshl_b32 s3, s3, 11
  v_and_b32 v12, 15, v0
  v_lshlrev_b32 v12, 7, v12
  v_add_u32 v12, s3, v12
  s_mov_b32 s3, .Lcode_end-concat_heads__mha_block_cached__gqa_block_cached__near_ridge_kernel-4
  v_min_u32 v13, s3, v12
  global_load_dword v87, v13, s[56:57]
  v_lshrrev_b32 v14, 6, v0
  s_nop 0
  v_readfirstlane_b32 s87, v14
  v_and_b32 v191, 63, v0
  s_nop 2
  s_and_b32 s4, s87, 3
  s_lshr_b32 s81, s87, 2
  s_and_b32 s48, s2, 7
  s_lshr_b32 s49, s2, 3
  s_lshr_b32 s50, s48, 2
  s_and_b32 s51, s48, 3
  s_lshl_b32 s51, s51, 3
  s_and_b32 s55, s49, 3
  s_lshl_b32 s55, s55, 1
  s_add_u32 s51, s51, s55
  s_lshr_b32 s52, s49, 2
  s_mov_b32 s7, 0x3e0293ee
  s_cmp_eq_u32 s81, 0
  s_cbranch_scc0 .Lk1_b_1
  v_and_b32 v20, 15, v191
  v_lshrrev_b32 v21, 4, v191
  s_lshl_b32 s3, s4, 3
  s_add_u32 s3, s3, 0
  v_add_u32 v24, s3, v21
  v_and_b32 v25, 15, v24
  v_lshrrev_b32 v27, 3, v25
  v_lshrrev_b32 v28, 2, v25
  v_xor_b32 v28, v28, v27
  v_and_b32 v28, 1, v28
  v_lshl_or_b32 v27, v28, 1, v27
  v_and_b32 v26, 3, v25
  v_lshl_or_b32 v26, v26, 2, v27
  v_xor_b32 v26, v26, v20
  v_lshlrev_b32 v26, 4, v26
  v_lshl_add_u32 v74, v24, 13, v26
  s_lshl_b32 s3, s4, 3
  s_add_u32 s3, s3, 4
  v_add_u32 v24, s3, v21
  v_and_b32 v25, 15, v24
  v_lshrrev_b32 v27, 3, v25
  v_lshrrev_b32 v28, 2, v25
  v_xor_b32 v28, v28, v27
  v_and_b32 v28, 1, v28
  v_lshl_or_b32 v27, v28, 1, v27
  v_and_b32 v26, 3, v25
  v_lshl_or_b32 v26, v26, 2, v27
  v_xor_b32 v26, v26, v20
  v_lshlrev_b32 v26, 4, v26
  v_lshl_add_u32 v75, v24, 13, v26
  s_lshl_b32 s6, s4, 11
  s_add_u32 s53, s55, s52
  s_and_b32 s53, s53, 7
  s_mul_i32 s53, s53, 9
  s_lshr_b32 s53, s53, 2
  s_lshl_b32 s54, s53, 18
  s_waitcnt lgkmcnt(0)
  s_cmp_eq_u32 s50, 0
  s_cselect_b64 s[14:15], s[14:15], s[22:23]
  s_lshl_b32 s3, s51, 8
  s_add_u32 s14, s14, s3
  s_addc_u32 s15, s15, 0
  s_mov_b32 s32, s14
  s_and_b32 s33, s15, 0xffff
  s_mov_b32 s34, 4710912
  s_mov_b32 s35, 0x20000
  s_add_u32 m0, s6, 60416
  s_nop 0
  buffer_load_dwordx4 v74, s[32:35], s54 offen offset:0  lds
  s_add_u32 m0, s6, 61440
  s_nop 0
  buffer_load_dwordx4 v75, s[32:35], s54 offen offset:0  lds
  s_add_u32 m0, s6, 68352
  s_nop 0
  buffer_load_dwordx4 v74, s[32:35], s54 offen offset:256  lds
  s_add_u32 m0, s6, 69376
  s_nop 0
  buffer_load_dwordx4 v75, s[32:35], s54 offen offset:256  lds
  s_add_u32 s54, s54, 262144
  s_cmp_eq_u32 s54, 4718592
  s_cselect_b32 s54, 0, s54
  s_add_u32 m0, s6, 86016
  s_nop 0
  buffer_load_dwordx4 v74, s[32:35], s54 offen offset:0  lds
  s_add_u32 m0, s6, 87040
  s_nop 0
  buffer_load_dwordx4 v75, s[32:35], s54 offen offset:0  lds
  s_add_u32 m0, s6, 93952
  s_nop 0
  buffer_load_dwordx4 v74, s[32:35], s54 offen offset:256  lds
  s_add_u32 m0, s6, 94976
  s_nop 0
  buffer_load_dwordx4 v75, s[32:35], s54 offen offset:256  lds
  s_add_u32 s54, s54, 262144
  s_cmp_eq_u32 s54, 4718592
  s_cselect_b32 s54, 0, s54
  s_branch .Lk1_e_2
.Lk1_b_1:
  s_setprio 1
  v_and_b32 v3, 15, v191
  v_lshrrev_b32 v4, 4, v191
  v_lshrrev_b32 v5, 2, v3
  v_and_b32 v6, 3, v3
  v_lshrrev_b32 v7, 2, v191
  v_lshrrev_b32 v8, 2, v7
  v_sub_u32 v8, 4, v8
  v_and_b32 v8, 3, v8
  v_xor_b32 v8, v8, v6
  v_lshlrev_b32 v8, 4, v8
  v_mul_u32_u24 v9, 1152, v7
  v_add_u32 v9, v9, v8
  v_add_u32 v160, 147456, v9
  s_mul_i32 s3, s4, 18432
  v_add_u32 v158, s3, v9
  v_add_u32 v159, 73728, v158
  s_lshl_b32 s5, s4, 10
  s_lshl_b32 s6, s4, 11
  s_lshl_b32 s59, s4, 12
  s_waitcnt lgkmcnt(0)
  s_cmp_eq_u32 s50, 0
  s_cselect_b64 s[8:9], s[8:9], s[16:17]
  s_cselect_b64 s[10:11], s[10:11], s[18:19]
  s_cselect_b64 s[12:13], s[12:13], s[20:21]
  s_cselect_b64 s[14:15], s[14:15], s[22:23]
  s_mul_i32 s3, s52, 165888
  s_add_u32 s8, s8, s3
  s_addc_u32 s9, s9, 0
  s_mov_b32 s28, s8
  s_and_b32 s29, s9, 0xffff
  s_mov_b32 s30, 165888
  s_mov_b32 s31, 0x20000
  s_add_u32 s53, s55, s52
  s_and_b32 s53, s53, 7
  s_mul_i32 s53, s53, 9
  s_lshr_b32 s53, s53, 2
  s_lshl_b32 s53, s53, 6
  s_add_u32 m0, s5, 51200
  s_nop 0
  buffer_load_dwordx4 v158, s[28:31], s53 offen  lds
  s_add_u32 m0, s5, 55296
  s_nop 0
  buffer_load_dwordx4 v159, s[28:31], s53 offen  lds
  s_cmp_eq_u32 s4, 0
  s_cbranch_scc0 .Lk1_s_3
  s_mov_b32 m0, 59392
  s_nop 0
  buffer_load_dwordx4 v160, s[28:31], s53 offen  lds
.Lk1_s_3:
  s_add_u32 s53, s53, 64
  s_cmp_eq_u32 s53, 1152
  s_cselect_b32 s53, 0, s53
  s_add_u32 m0, s5, 76800
  s_nop 0
  buffer_load_dwordx4 v158, s[28:31], s53 offen  lds
  s_add_u32 m0, s5, 80896
  s_nop 0
  buffer_load_dwordx4 v159, s[28:31], s53 offen  lds
  s_cmp_eq_u32 s4, 1
  s_cbranch_scc0 .Lk1_s_4
  s_mov_b32 m0, 84992
  s_nop 0
  buffer_load_dwordx4 v160, s[28:31], s53 offen  lds
.Lk1_s_4:
  s_add_u32 s53, s53, 64
  s_cmp_eq_u32 s53, 1152
  s_cselect_b32 s53, 0, s53
.Lk1_e_2:
  v_and_b32 v2, 31, v0
  v_lshlrev_b32 v2, 2, v2
  v_lshl_add_u32 v2, v14, 7, v2
  v_add_u32 v186, 161792, v2
  v_and_b32 v2, 3, v0
  v_mul_u32_u24 v2, 132, v2
  v_add_u32 v187, 163328, v2
  v_and_b32 v2, 7, v0
  v_mul_u32_u24 v2, 132, v2
  v_add_u32 v188, 161792, v2
  v_mov_b32 v190, 0
  ds_write_b32 v186, v190
  ds_write_b32 v186, v190 offset:1024
  s_waitcnt lgkmcnt(0)
  s_cmp_eq_u32 s81, 0
  s_cbranch_scc0 .Lk1_b_5
  v_lshrrev_b32 v22, 2, v20
  v_and_b32 v23, 3, v20
  v_lshl_add_u32 v24, v21, 3, v22
  v_and_b32 v25, 15, v24
  v_lshrrev_b32 v27, 3, v25
  v_lshrrev_b32 v28, 2, v25
  v_xor_b32 v28, v28, v27
  v_and_b32 v28, 1, v28
  v_lshl_or_b32 v27, v28, 1, v27
  v_and_b32 v26, 3, v25
  v_lshl_or_b32 v26, v26, 2, v27
  v_lshrrev_b32 v27, 1, v23
  v_xor_b32 v26, v26, v27
  v_lshlrev_b32 v26, 4, v26
  v_and_b32 v27, 1, v23
  v_lshl_or_b32 v26, v27, 3, v26
  v_lshl_add_u32 v26, v24, 8, v26
  v_add_u32 v160, 9216, v26
  v_xor_b32 v161, 32, v160
  v_xor_b32 v162, 64, v160
  v_xor_b32 v163, 96, v160
  v_xor_b32 v164, 128, v160
  v_xor_b32 v165, 160, v160
  v_xor_b32 v166, 192, v160
  v_xor_b32 v167, 224, v160
  v_sub_u32 v26, 4, v22
  v_and_b32 v26, 3, v26
  v_xor_b32 v26, v26, v21
  v_lshlrev_b32 v26, 4, v26
  v_lshl_add_u32 v26, v20, 6, v26
  s_add_u32 s3, s6, 0
  v_add_u32 v168, s3, v26
  v_add_u32 v64, 51200, v160
  v_add_u32 v65, 51200, v161
  v_add_u32 v66, 51200, v162
  v_add_u32 v67, 51200, v163
  v_add_u32 v68, 51200, v164
  v_add_u32 v69, 51200, v165
  v_add_u32 v70, 51200, v166
  v_add_u32 v71, 51200, v167
  v_add_u32 v72, 51200, v168
  v_lshl_add_u32 v24, v21, 2, v22
  v_and_b32 v25, 15, v24
  v_lshrrev_b32 v27, 3, v25
  v_lshrrev_b32 v28, 2, v25
  v_xor_b32 v28, v28, v27
  v_and_b32 v28, 1, v28
  v_lshl_or_b32 v27, v28, 1, v27
  v_and_b32 v26, 3, v25
  v_lshl_or_b32 v26, v26, 2, v27
  v_lshrrev_b32 v27, 1, v23
  v_xor_b32 v26, v26, v27
  v_lshlrev_b32 v26, 4, v26
  v_and_b32 v27, 1, v23
  v_lshl_or_b32 v26, v27, 3, v26
  v_lshl_add_u32 v26, v24, 8, v26
  v_add_u32 v76, 32768, v26
  v_lshrrev_b32 v27, 3, v20
  v_lshrrev_b32 v28, 2, v20
  v_xor_b32 v28, v28, v27
  v_and_b32 v28, 1, v28
  v_lshl_or_b32 v27, v28, 1, v27
  v_and_b32 v26, 3, v20
  v_lshl_or_b32 v26, v26, 2, v27
  v_xor_b32 v26, v26, v21
  v_lshlrev_b32 v26, 4, v26
  v_lshl_add_u32 v188, v20, 8, v26
  s_mul_i32 s3, s50, 72
  s_mul_i32 s26, s52, 9
  s_add_u32 s3, s3, s26
  s_lshl_b32 s3, s3, 7
  s_lshl_b32 s26, s51, 2
  s_add_u32 s3, s3, s26
  s_lshl_b32 s3, s3, 10
  s_add_u32 s24, s24, s3
  s_addc_u32 s25, s25, 0
  s_mov_b32 s44, s24
  s_and_b32 s45, s25, 0xffff
  s_mov_b32 s46, 1056768
  s_mov_b32 s47, 0x20000
  s_waitcnt vmcnt(4)
  s_barrier
  ds_read_b128 v[170:173], v72 offset:0
  ds_read_b128 v[174:177], v72 offset:1024
  ds_read_b64_tr_b16 v[128:129], v64 offset:0
  ds_read_b64_tr_b16 v[130:131], v65 offset:1024
  ds_read_b64_tr_b16 v[132:133], v65 offset:0
  ds_read_b64_tr_b16 v[134:135], v64 offset:1024
  ds_read_b64_tr_b16 v[136:137], v66 offset:0
  ds_read_b64_tr_b16 v[138:139], v67 offset:1024
  ds_read_b64_tr_b16 v[140:141], v67 offset:0
  ds_read_b64_tr_b16 v[142:143], v66 offset:1024
  ds_read_b64_tr_b16 v[144:145], v68 offset:0
  ds_read_b64_tr_b16 v[146:147], v69 offset:1024
  s_add_u32 m0, s6, 111616
  s_nop 0
  buffer_load_dwordx4 v74, s[32:35], s54 offen offset:0  lds
  s_add_u32 m0, s6, 112640
  s_nop 0
  buffer_load_dwordx4 v75, s[32:35], s54 offen offset:0  lds
  s_add_u32 m0, s6, 119552
  s_nop 0
  buffer_load_dwordx4 v74, s[32:35], s54 offen offset:256  lds
  s_add_u32 m0, s6, 120576
  s_nop 0
  buffer_load_dwordx4 v75, s[32:35], s54 offen offset:256  lds
  s_add_u32 s54, s54, 262144
  s_cmp_eq_u32 s54, 4718592
  s_cselect_b32 s54, 0, s54
  s_waitcnt lgkmcnt(8)
  v_mfma_f32_16x16x32_bf16 v[0:3], v[128:131], v[170:173], 0
  ds_read_b64_tr_b16 v[148:149], v69 offset:0
  v_mfma_f32_16x16x32_bf16 v[4:7], v[128:131], v[174:177], 0
  ds_read_b64_tr_b16 v[150:151], v68 offset:1024
  s_add_u32 m0, s6, 9216
  s_waitcnt lgkmcnt(8)
  v_mfma_f32_16x16x32_bf16 v[8:11], v[132:135], v[170:173], 0
  buffer_load_dwordx4 v74, s[32:35], s54 offen offset:0  lds
  ds_read_b64_tr_b16 v[152:153], v70 offset:0
  v_mfma_f32_16x16x32_bf16 v[12:15], v[132:135], v[174:177], 0
  ds_read_b64_tr_b16 v[154:155], v71 offset:1024
  s_waitcnt lgkmcnt(8)
  v_mfma_f32_16x16x32_bf16 v[16:19], v[136:139], v[170:173], 0
  ds_read_b64_tr_b16 v[156:157], v71 offset:0
  v_mfma_f32_16x16x32_bf16 v[20:23], v[136:139], v[174:177], 0
  ds_read_b64_tr_b16 v[158:159], v70 offset:1024
  s_add_u32 m0, s6, 10240
  s_waitcnt lgkmcnt(8)
  v_mfma_f32_16x16x32_bf16 v[24:27], v[140:143], v[170:173], 0
  buffer_load_dwordx4 v75, s[32:35], s54 offen offset:0  lds
  ds_read_b64_tr_b16 v[128:129], v64 offset:8192
  v_mfma_f32_16x16x32_bf16 v[28:31], v[140:143], v[174:177], 0
  ds_read_b64_tr_b16 v[130:131], v65 offset:9216
  s_waitcnt lgkmcnt(8)
  v_mfma_f32_16x16x32_bf16 v[32:35], v[144:147], v[170:173], 0
  ds_read_b64_tr_b16 v[132:133], v65 offset:8192
  v_mfma_f32_16x16x32_bf16 v[36:39], v[144:147], v[174:177], 0
  ds_read_b64_tr_b16 v[134:135], v64 offset:9216
  s_add_u32 m0, s6, 17152
  s_waitcnt lgkmcnt(8)
  v_mfma_f32_16x16x32_bf16 v[40:43], v[148:151], v[170:173], 0
  buffer_load_dwordx4 v74, s[32:35], s54 offen offset:256  lds
  ds_read_b64_tr_b16 v[136:137], v66 offset:8192
  v_mfma_f32_16x16x32_bf16 v[44:47], v[148:151], v[174:177], 0
  ds_read_b64_tr_b16 v[138:139], v67 offset:9216
  s_waitcnt lgkmcnt(8)
  v_mfma_f32_16x16x32_bf16 v[48:51], v[152:155], v[170:173], 0
  ds_read_b64_tr_b16 v[140:141], v67 offset:8192
  v_mfma_f32_16x16x32_bf16 v[52:55], v[152:155], v[174:177], 0
  ds_read_b64_tr_b16 v[142:143], v66 offset:9216
  s_add_u32 m0, s6, 18176
  s_waitcnt lgkmcnt(8)
  v_mfma_f32_16x16x32_bf16 v[56:59], v[156:159], v[170:173], 0
  buffer_load_dwordx4 v75, s[32:35], s54 offen offset:256  lds
  ds_read_b64_tr_b16 v[144:145], v68 offset:8192
  v_mfma_f32_16x16x32_bf16 v[60:63], v[156:159], v[174:177], 0
  ds_read_b64_tr_b16 v[146:147], v69 offset:9216
  s_waitcnt lgkmcnt(8)
  v_mfma_f32_16x16x32_bf16 v[192:195], v[128:131], v[170:173], 0
  s_add_u32 s54, s54, 262144
  s_cmp_eq_u32 s54, 4718592
  s_cselect_b32 s54, 0, s54
  ds_read_b64_tr_b16 v[148:149], v69 offset:8192
  v_mfma_f32_16x16x32_bf16 v[196:199], v[128:131], v[174:177], 0
  ds_read_b64_tr_b16 v[150:151], v68 offset:9216
  s_waitcnt lgkmcnt(8)
  v_mfma_f32_16x16x32_bf16 v[200:203], v[132:135], v[170:173], 0
  ds_read_b64_tr_b16 v[152:153], v70 offset:8192
  v_mfma_f32_16x16x32_bf16 v[204:207], v[132:135], v[174:177], 0
  ds_read_b64_tr_b16 v[154:155], v71 offset:9216
  s_waitcnt lgkmcnt(8)
  v_mfma_f32_16x16x32_bf16 v[208:211], v[136:139], v[170:173], 0
  s_waitcnt vmcnt(8)
  s_barrier
  ds_read_b64_tr_b16 v[156:157], v71 offset:8192
  v_mfma_f32_16x16x32_bf16 v[212:215], v[136:139], v[174:177], 0
  ds_read_b64_tr_b16 v[158:159], v70 offset:9216
  s_waitcnt lgkmcnt(8)
  v_mfma_f32_16x16x32_bf16 v[216:219], v[140:143], v[170:173], 0
  ds_read_b64_tr_b16 v[128:129], v64 offset:25600
  v_mfma_f32_16x16x32_bf16 v[220:223], v[140:143], v[174:177], 0
  ds_read_b64_tr_b16 v[130:131], v65 offset:26624
  ds_read_b128 v[178:181], v72 offset:25600
  s_waitcnt lgkmcnt(9)
  v_mfma_f32_16x16x32_bf16 v[224:227], v[144:147], v[170:173], 0
  ds_read_b64_tr_b16 v[132:133], v65 offset:25600
  v_mfma_f32_16x16x32_bf16 v[228:231], v[144:147], v[174:177], 0
  ds_read_b64_tr_b16 v[134:135], v64 offset:26624
  ds_read_b128 v[182:185], v72 offset:26624
  s_waitcnt lgkmcnt(10)
  v_mfma_f32_16x16x32_bf16 v[232:235], v[148:151], v[170:173], 0
  ds_read_b64_tr_b16 v[136:137], v66 offset:25600
  v_mfma_f32_16x16x32_bf16 v[236:239], v[148:151], v[174:177], 0
  ds_read_b64_tr_b16 v[138:139], v67 offset:26624
  s_waitcnt lgkmcnt(10)
  v_mfma_f32_16x16x32_bf16 v[240:243], v[152:155], v[170:173], 0
  ds_read_b64_tr_b16 v[140:141], v67 offset:25600
  v_mfma_f32_16x16x32_bf16 v[244:247], v[152:155], v[174:177], 0
  ds_read_b64_tr_b16 v[142:143], v66 offset:26624
  s_waitcnt lgkmcnt(10)
  v_mfma_f32_16x16x32_bf16 v[248:251], v[156:159], v[170:173], 0
  ds_read_b64_tr_b16 v[144:145], v68 offset:25600
  v_mfma_f32_16x16x32_bf16 v[252:255], v[156:159], v[174:177], 0
  ds_read_b64_tr_b16 v[146:147], v69 offset:26624
  s_waitcnt lgkmcnt(6)
  v_mfma_f32_16x16x32_bf16 v[0:3], v[128:131], v[178:181], v[0:3]
  ds_read_b64_tr_b16 v[148:149], v69 offset:25600
  v_mfma_f32_16x16x32_bf16 v[4:7], v[128:131], v[182:185], v[4:7]
  ds_read_b64_tr_b16 v[150:151], v68 offset:26624
  s_add_u32 m0, s6, 34816
  v_mfma_f32_16x16x32_bf16 v[8:11], v[132:135], v[178:181], v[8:11]
  buffer_load_dwordx4 v74, s[32:35], s54 offen offset:0  lds
  ds_read_b64_tr_b16 v[152:153], v70 offset:25600
  v_mfma_f32_16x16x32_bf16 v[12:15], v[132:135], v[182:185], v[12:15]
  ds_read_b64_tr_b16 v[154:155], v71 offset:26624
  s_waitcnt lgkmcnt(8)
  v_mfma_f32_16x16x32_bf16 v[16:19], v[136:139], v[178:181], v[16:19]
  ds_read_b64_tr_b16 v[156:157], v71 offset:25600
  v_mfma_f32_16x16x32_bf16 v[20:23], v[136:139], v[182:185], v[20:23]
  ds_read_b64_tr_b16 v[158:159], v70 offset:26624
  s_add_u32 m0, s6, 35840
  s_waitcnt lgkmcnt(8)
  v_mfma_f32_16x16x32_bf16 v[24:27], v[140:143], v[178:181], v[24:27]
  buffer_load_dwordx4 v75, s[32:35], s54 offen offset:0  lds
  ds_read_b64_tr_b16 v[128:129], v64 offset:33792
  v_mfma_f32_16x16x32_bf16 v[28:31], v[140:143], v[182:185], v[28:31]
  ds_read_b64_tr_b16 v[130:131], v65 offset:34816
  s_waitcnt lgkmcnt(8)
  v_mfma_f32_16x16x32_bf16 v[32:35], v[144:147], v[178:181], v[32:35]
  ds_read_b64_tr_b16 v[132:133], v65 offset:33792
  v_mfma_f32_16x16x32_bf16 v[36:39], v[144:147], v[182:185], v[36:39]
  ds_read_b64_tr_b16 v[134:135], v64 offset:34816
  s_add_u32 m0, s6, 42752
  s_waitcnt lgkmcnt(8)
  v_mfma_f32_16x16x32_bf16 v[40:43], v[148:151], v[178:181], v[40:43]
  buffer_load_dwordx4 v74, s[32:35], s54 offen offset:256  lds
  ds_read_b64_tr_b16 v[136:137], v66 offset:33792
  v_mfma_f32_16x16x32_bf16 v[44:47], v[148:151], v[182:185], v[44:47]
  ds_read_b64_tr_b16 v[138:139], v67 offset:34816
  s_waitcnt lgkmcnt(8)
  v_mfma_f32_16x16x32_bf16 v[48:51], v[152:155], v[178:181], v[48:51]
  ds_read_b64_tr_b16 v[140:141], v67 offset:33792
  v_mfma_f32_16x16x32_bf16 v[52:55], v[152:155], v[182:185], v[52:55]
  ds_read_b64_tr_b16 v[142:143], v66 offset:34816
  s_add_u32 m0, s6, 43776
  s_waitcnt lgkmcnt(8)
  v_mfma_f32_16x16x32_bf16 v[56:59], v[156:159], v[178:181], v[56:59]
  buffer_load_dwordx4 v75, s[32:35], s54 offen offset:256  lds
  ds_read_b64_tr_b16 v[144:145], v68 offset:33792
  v_mfma_f32_16x16x32_bf16 v[60:63], v[156:159], v[182:185], v[60:63]
  ds_read_b64_tr_b16 v[146:147], v69 offset:34816
  s_waitcnt lgkmcnt(8)
  v_mfma_f32_16x16x32_bf16 v[192:195], v[128:131], v[178:181], v[192:195]
  s_add_u32 s54, s54, 262144
  s_cmp_eq_u32 s54, 4718592
  s_cselect_b32 s54, 0, s54
  ds_read_b64_tr_b16 v[148:149], v69 offset:33792
  v_mfma_f32_16x16x32_bf16 v[196:199], v[128:131], v[182:185], v[196:199]
  ds_read_b64_tr_b16 v[150:151], v68 offset:34816
  s_waitcnt lgkmcnt(8)
  v_mfma_f32_16x16x32_bf16 v[200:203], v[132:135], v[178:181], v[200:203]
  ds_read_b64_tr_b16 v[152:153], v70 offset:33792
  v_mfma_f32_16x16x32_bf16 v[204:207], v[132:135], v[182:185], v[204:207]
  ds_read_b64_tr_b16 v[154:155], v71 offset:34816
  s_waitcnt lgkmcnt(8)
  v_mfma_f32_16x16x32_bf16 v[208:211], v[136:139], v[178:181], v[208:211]
  s_waitcnt vmcnt(8)
  s_barrier
  ds_read_b64_tr_b16 v[156:157], v71 offset:33792
  v_mfma_f32_16x16x32_bf16 v[212:215], v[136:139], v[182:185], v[212:215]
  ds_read_b64_tr_b16 v[158:159], v70 offset:34816
  s_waitcnt lgkmcnt(8)
  v_mfma_f32_16x16x32_bf16 v[216:219], v[140:143], v[178:181], v[216:219]
  ds_read_b64_tr_b16 v[128:129], v64 offset:51200
  v_mfma_f32_16x16x32_bf16 v[220:223], v[140:143], v[182:185], v[220:223]
  ds_read_b64_tr_b16 v[130:131], v65 offset:52224
  ds_read_b128 v[170:173], v72 offset:51200
  s_waitcnt lgkmcnt(9)
  v_mfma_f32_16x16x32_bf16 v[224:227], v[144:147], v[178:181], v[224:227]
  ds_read_b64_tr_b16 v[132:133], v65 offset:51200
  v_mfma_f32_16x16x32_bf16 v[228:231], v[144:147], v[182:185], v[228:231]
  ds_read_b64_tr_b16 v[134:135], v64 offset:52224
  ds_read_b128 v[174:177], v72 offset:52224
  s_waitcnt lgkmcnt(10)
  v_mfma_f32_16x16x32_bf16 v[232:235], v[148:151], v[178:181], v[232:235]
  ds_read_b64_tr_b16 v[136:137], v66 offset:51200
  v_mfma_f32_16x16x32_bf16 v[236:239], v[148:151], v[182:185], v[236:239]
  ds_read_b64_tr_b16 v[138:139], v67 offset:52224
  s_waitcnt lgkmcnt(10)
  v_mfma_f32_16x16x32_bf16 v[240:243], v[152:155], v[178:181], v[240:243]
  ds_read_b64_tr_b16 v[140:141], v67 offset:51200
  v_mfma_f32_16x16x32_bf16 v[244:247], v[152:155], v[182:185], v[244:247]
  ds_read_b64_tr_b16 v[142:143], v66 offset:52224
  s_waitcnt lgkmcnt(10)
  v_mfma_f32_16x16x32_bf16 v[248:251], v[156:159], v[178:181], v[248:251]
  ds_read_b64_tr_b16 v[144:145], v68 offset:51200
  v_mfma_f32_16x16x32_bf16 v[252:255], v[156:159], v[182:185], v[252:255]
  ds_read_b64_tr_b16 v[146:147], v69 offset:52224
  s_waitcnt lgkmcnt(6)
  v_mfma_f32_16x16x32_bf16 v[0:3], v[128:131], v[170:173], v[0:3]
  ds_read_b64_tr_b16 v[148:149], v69 offset:51200
  v_mfma_f32_16x16x32_bf16 v[4:7], v[128:131], v[174:177], v[4:7]
  ds_read_b64_tr_b16 v[150:151], v68 offset:52224
  s_add_u32 m0, s6, 60416
  v_mfma_f32_16x16x32_bf16 v[8:11], v[132:135], v[170:173], v[8:11]
  buffer_load_dwordx4 v74, s[32:35], s54 offen offset:0  lds
  ds_read_b64_tr_b16 v[152:153], v70 offset:51200
  v_mfma_f32_16x16x32_bf16 v[12:15], v[132:135], v[174:177], v[12:15]
  ds_read_b64_tr_b16 v[154:155], v71 offset:52224
  s_waitcnt lgkmcnt(8)
  v_mfma_f32_16x16x32_bf16 v[16:19], v[136:139], v[170:173], v[16:19]
  ds_read_b64_tr_b16 v[156:157], v71 offset:51200
  v_mfma_f32_16x16x32_bf16 v[20:23], v[136:139], v[174:177], v[20:23]
  ds_read_b64_tr_b16 v[158:159], v70 offset:52224
  s_add_u32 m0, s6, 61440
  s_waitcnt lgkmcnt(8)
  v_mfma_f32_16x16x32_bf16 v[24:27], v[140:143], v[170:173], v[24:27]
  buffer_load_dwordx4 v75, s[32:35], s54 offen offset:0  lds
  ds_read_b64_tr_b16 v[128:129], v64 offset:59392
  v_mfma_f32_16x16x32_bf16 v[28:31], v[140:143], v[174:177], v[28:31]
  ds_read_b64_tr_b16 v[130:131], v65 offset:60416
  s_waitcnt lgkmcnt(8)
  v_mfma_f32_16x16x32_bf16 v[32:35], v[144:147], v[170:173], v[32:35]
  ds_read_b64_tr_b16 v[132:133], v65 offset:59392
  v_mfma_f32_16x16x32_bf16 v[36:39], v[144:147], v[174:177], v[36:39]
  ds_read_b64_tr_b16 v[134:135], v64 offset:60416
  s_add_u32 m0, s6, 68352
  s_waitcnt lgkmcnt(8)
  v_mfma_f32_16x16x32_bf16 v[40:43], v[148:151], v[170:173], v[40:43]
  buffer_load_dwordx4 v74, s[32:35], s54 offen offset:256  lds
  ds_read_b64_tr_b16 v[136:137], v66 offset:59392
  v_mfma_f32_16x16x32_bf16 v[44:47], v[148:151], v[174:177], v[44:47]
  ds_read_b64_tr_b16 v[138:139], v67 offset:60416
  s_waitcnt lgkmcnt(8)
  v_mfma_f32_16x16x32_bf16 v[48:51], v[152:155], v[170:173], v[48:51]
  ds_read_b64_tr_b16 v[140:141], v67 offset:59392
  v_mfma_f32_16x16x32_bf16 v[52:55], v[152:155], v[174:177], v[52:55]
  ds_read_b64_tr_b16 v[142:143], v66 offset:60416
  s_add_u32 m0, s6, 69376
  s_waitcnt lgkmcnt(8)
  v_mfma_f32_16x16x32_bf16 v[56:59], v[156:159], v[170:173], v[56:59]
  buffer_load_dwordx4 v75, s[32:35], s54 offen offset:256  lds
  ds_read_b64_tr_b16 v[144:145], v68 offset:59392
  v_mfma_f32_16x16x32_bf16 v[60:63], v[156:159], v[174:177], v[60:63]
  ds_read_b64_tr_b16 v[146:147], v69 offset:60416
  s_waitcnt lgkmcnt(8)
  v_mfma_f32_16x16x32_bf16 v[192:195], v[128:131], v[170:173], v[192:195]
  s_add_u32 s54, s54, 262144
  s_cmp_eq_u32 s54, 4718592
  s_cselect_b32 s54, 0, s54
  ds_read_b64_tr_b16 v[148:149], v69 offset:59392
  v_mfma_f32_16x16x32_bf16 v[196:199], v[128:131], v[174:177], v[196:199]
  ds_read_b64_tr_b16 v[150:151], v68 offset:60416
  s_waitcnt lgkmcnt(8)
  v_mfma_f32_16x16x32_bf16 v[200:203], v[132:135], v[170:173], v[200:203]
  ds_read_b64_tr_b16 v[152:153], v70 offset:59392
  v_mfma_f32_16x16x32_bf16 v[204:207], v[132:135], v[174:177], v[204:207]
  ds_read_b64_tr_b16 v[154:155], v71 offset:60416
  s_waitcnt lgkmcnt(8)
  v_mfma_f32_16x16x32_bf16 v[208:211], v[136:139], v[170:173], v[208:211]
  s_waitcnt vmcnt(8)
  s_barrier
  ds_read_b64_tr_b16 v[156:157], v71 offset:59392
  v_mfma_f32_16x16x32_bf16 v[212:215], v[136:139], v[174:177], v[212:215]
  ds_read_b64_tr_b16 v[158:159], v70 offset:60416
  s_waitcnt lgkmcnt(8)
  v_mfma_f32_16x16x32_bf16 v[216:219], v[140:143], v[170:173], v[216:219]
  ds_read_b64_tr_b16 v[128:129], v160 offset:0
  v_mfma_f32_16x16x32_bf16 v[220:223], v[140:143], v[174:177], v[220:223]
  ds_read_b64_tr_b16 v[130:131], v161 offset:1024
  ds_read_b128 v[178:181], v168 offset:0
  s_waitcnt lgkmcnt(9)
  v_mfma_f32_16x16x32_bf16 v[224:227], v[144:147], v[170:173], v[224:227]
  ds_read_b64_tr_b16 v[132:133], v161 offset:0
  v_mfma_f32_16x16x32_bf16 v[228:231], v[144:147], v[174:177], v[228:231]
  ds_read_b64_tr_b16 v[134:135], v160 offset:1024
  ds_read_b128 v[182:185], v168 offset:1024
  s_waitcnt lgkmcnt(10)
  v_mfma_f32_16x16x32_bf16 v[232:235], v[148:151], v[170:173], v[232:235]
  ds_read_b64_tr_b16 v[136:137], v162 offset:0
  v_mfma_f32_16x16x32_bf16 v[236:239], v[148:151], v[174:177], v[236:239]
  ds_read_b64_tr_b16 v[138:139], v163 offset:1024
  s_waitcnt lgkmcnt(10)
  v_mfma_f32_16x16x32_bf16 v[240:243], v[152:155], v[170:173], v[240:243]
  ds_read_b64_tr_b16 v[140:141], v163 offset:0
  v_mfma_f32_16x16x32_bf16 v[244:247], v[152:155], v[174:177], v[244:247]
  ds_read_b64_tr_b16 v[142:143], v162 offset:1024
  s_waitcnt lgkmcnt(10)
  v_mfma_f32_16x16x32_bf16 v[248:251], v[156:159], v[170:173], v[248:251]
  ds_read_b64_tr_b16 v[144:145], v164 offset:0
  v_mfma_f32_16x16x32_bf16 v[252:255], v[156:159], v[174:177], v[252:255]
  ds_read_b64_tr_b16 v[146:147], v165 offset:1024
  s_waitcnt lgkmcnt(6)
  v_mfma_f32_16x16x32_bf16 v[0:3], v[128:131], v[178:181], v[0:3]
  ds_read_b64_tr_b16 v[148:149], v165 offset:0
  v_mfma_f32_16x16x32_bf16 v[4:7], v[128:131], v[182:185], v[4:7]
  ds_read_b64_tr_b16 v[150:151], v164 offset:1024
  s_add_u32 m0, s6, 86016
  v_mfma_f32_16x16x32_bf16 v[8:11], v[132:135], v[178:181], v[8:11]
  buffer_load_dwordx4 v74, s[32:35], s54 offen offset:0  lds
  ds_read_b64_tr_b16 v[152:153], v166 offset:0
  v_mfma_f32_16x16x32_bf16 v[12:15], v[132:135], v[182:185], v[12:15]
  ds_read_b64_tr_b16 v[154:155], v167 offset:1024
  s_waitcnt lgkmcnt(8)
  v_mfma_f32_16x16x32_bf16 v[16:19], v[136:139], v[178:181], v[16:19]
  ds_read_b64_tr_b16 v[156:157], v167 offset:0
  v_mfma_f32_16x16x32_bf16 v[20:23], v[136:139], v[182:185], v[20:23]
  ds_read_b64_tr_b16 v[158:159], v166 offset:1024
  s_add_u32 m0, s6, 87040
  s_waitcnt lgkmcnt(8)
  v_mfma_f32_16x16x32_bf16 v[24:27], v[140:143], v[178:181], v[24:27]
  buffer_load_dwordx4 v75, s[32:35], s54 offen offset:0  lds
  ds_read_b64_tr_b16 v[128:129], v160 offset:8192
  v_mfma_f32_16x16x32_bf16 v[28:31], v[140:143], v[182:185], v[28:31]
  ds_read_b64_tr_b16 v[130:131], v161 offset:9216
  s_waitcnt lgkmcnt(8)
  v_mfma_f32_16x16x32_bf16 v[32:35], v[144:147], v[178:181], v[32:35]
  ds_read_b64_tr_b16 v[132:133], v161 offset:8192
  v_mfma_f32_16x16x32_bf16 v[36:39], v[144:147], v[182:185], v[36:39]
  ds_read_b64_tr_b16 v[134:135], v160 offset:9216
  s_add_u32 m0, s6, 93952
  s_waitcnt lgkmcnt(8)
  v_mfma_f32_16x16x32_bf16 v[40:43], v[148:151], v[178:181], v[40:43]
  buffer_load_dwordx4 v74, s[32:35], s54 offen offset:256  lds
  ds_read_b64_tr_b16 v[136:137], v162 offset:8192
  v_mfma_f32_16x16x32_bf16 v[44:47], v[148:151], v[182:185], v[44:47]
  ds_read_b64_tr_b16 v[138:139], v163 offset:9216
  s_waitcnt lgkmcnt(8)
  v_mfma_f32_16x16x32_bf16 v[48:51], v[152:155], v[178:181], v[48:51]
  ds_read_b64_tr_b16 v[140:141], v163 offset:8192
  v_mfma_f32_16x16x32_bf16 v[52:55], v[152:155], v[182:185], v[52:55]
  ds_read_b64_tr_b16 v[142:143], v162 offset:9216
  s_add_u32 m0, s6, 94976
  s_waitcnt lgkmcnt(8)
  v_mfma_f32_16x16x32_bf16 v[56:59], v[156:159], v[178:181], v[56:59]
  buffer_load_dwordx4 v75, s[32:35], s54 offen offset:256  lds
  ds_read_b64_tr_b16 v[144:145], v164 offset:8192
  v_mfma_f32_16x16x32_bf16 v[60:63], v[156:159], v[182:185], v[60:63]
  ds_read_b64_tr_b16 v[146:147], v165 offset:9216
  s_waitcnt lgkmcnt(8)
  v_mfma_f32_16x16x32_bf16 v[192:195], v[128:131], v[178:181], v[192:195]
  s_add_u32 s54, s54, 262144
  s_cmp_eq_u32 s54, 4718592
  s_cselect_b32 s54, 0, s54
  ds_read_b64_tr_b16 v[148:149], v165 offset:8192
  v_mfma_f32_16x16x32_bf16 v[196:199], v[128:131], v[182:185], v[196:199]
  ds_read_b64_tr_b16 v[150:151], v164 offset:9216
  s_waitcnt lgkmcnt(8)
  v_mfma_f32_16x16x32_bf16 v[200:203], v[132:135], v[178:181], v[200:203]
  ds_read_b64_tr_b16 v[152:153], v166 offset:8192
  v_mfma_f32_16x16x32_bf16 v[204:207], v[132:135], v[182:185], v[204:207]
  ds_read_b64_tr_b16 v[154:155], v167 offset:9216
  s_waitcnt lgkmcnt(8)
  v_mfma_f32_16x16x32_bf16 v[208:211], v[136:139], v[178:181], v[208:211]
  s_waitcnt vmcnt(8)
  s_barrier
  ds_read_b64_tr_b16 v[156:157], v167 offset:8192
  v_mfma_f32_16x16x32_bf16 v[212:215], v[136:139], v[182:185], v[212:215]
  ds_read_b64_tr_b16 v[158:159], v166 offset:9216
  s_waitcnt lgkmcnt(8)
  v_mfma_f32_16x16x32_bf16 v[216:219], v[140:143], v[178:181], v[216:219]
  ds_read_b64_tr_b16 v[128:129], v160 offset:25600
  v_mfma_f32_16x16x32_bf16 v[220:223], v[140:143], v[182:185], v[220:223]
  ds_read_b64_tr_b16 v[130:131], v161 offset:26624
  ds_read_b128 v[170:173], v168 offset:25600
  s_waitcnt lgkmcnt(9)
  v_mfma_f32_16x16x32_bf16 v[224:227], v[144:147], v[178:181], v[224:227]
  ds_read_b64_tr_b16 v[132:133], v161 offset:25600
  v_mfma_f32_16x16x32_bf16 v[228:231], v[144:147], v[182:185], v[228:231]
  ds_read_b64_tr_b16 v[134:135], v160 offset:26624
  ds_read_b128 v[174:177], v168 offset:26624
  s_waitcnt lgkmcnt(10)
  v_mfma_f32_16x16x32_bf16 v[232:235], v[148:151], v[178:181], v[232:235]
  ds_read_b64_tr_b16 v[136:137], v162 offset:25600
  v_mfma_f32_16x16x32_bf16 v[236:239], v[148:151], v[182:185], v[236:239]
  ds_read_b64_tr_b16 v[138:139], v163 offset:26624
  s_waitcnt lgkmcnt(10)
  v_mfma_f32_16x16x32_bf16 v[240:243], v[152:155], v[178:181], v[240:243]
  ds_read_b64_tr_b16 v[140:141], v163 offset:25600
  v_mfma_f32_16x16x32_bf16 v[244:247], v[152:155], v[182:185], v[244:247]
  ds_read_b64_tr_b16 v[142:143], v162 offset:26624
  s_waitcnt lgkmcnt(10)
  v_mfma_f32_16x16x32_bf16 v[248:251], v[156:159], v[178:181], v[248:251]
  ds_read_b64_tr_b16 v[144:145], v164 offset:25600
  v_mfma_f32_16x16x32_bf16 v[252:255], v[156:159], v[182:185], v[252:255]
  ds_read_b64_tr_b16 v[146:147], v165 offset:26624
  s_waitcnt lgkmcnt(6)
  v_mfma_f32_16x16x32_bf16 v[0:3], v[128:131], v[170:173], v[0:3]
  ds_read_b64_tr_b16 v[148:149], v165 offset:25600
  v_mfma_f32_16x16x32_bf16 v[4:7], v[128:131], v[174:177], v[4:7]
  ds_read_b64_tr_b16 v[150:151], v164 offset:26624
  s_add_u32 m0, s6, 111616
  v_mfma_f32_16x16x32_bf16 v[8:11], v[132:135], v[170:173], v[8:11]
  buffer_load_dwordx4 v74, s[32:35], s54 offen offset:0  lds
  ds_read_b64_tr_b16 v[152:153], v166 offset:25600
  v_mfma_f32_16x16x32_bf16 v[12:15], v[132:135], v[174:177], v[12:15]
  ds_read_b64_tr_b16 v[154:155], v167 offset:26624
  s_waitcnt lgkmcnt(8)
  v_mfma_f32_16x16x32_bf16 v[16:19], v[136:139], v[170:173], v[16:19]
  ds_read_b64_tr_b16 v[156:157], v167 offset:25600
  v_mfma_f32_16x16x32_bf16 v[20:23], v[136:139], v[174:177], v[20:23]
  ds_read_b64_tr_b16 v[158:159], v166 offset:26624
  s_add_u32 m0, s6, 112640
  s_waitcnt lgkmcnt(8)
  v_mfma_f32_16x16x32_bf16 v[24:27], v[140:143], v[170:173], v[24:27]
  buffer_load_dwordx4 v75, s[32:35], s54 offen offset:0  lds
  ds_read_b64_tr_b16 v[128:129], v160 offset:33792
  v_mfma_f32_16x16x32_bf16 v[28:31], v[140:143], v[174:177], v[28:31]
  ds_read_b64_tr_b16 v[130:131], v161 offset:34816
  s_waitcnt lgkmcnt(8)
  v_mfma_f32_16x16x32_bf16 v[32:35], v[144:147], v[170:173], v[32:35]
  ds_read_b64_tr_b16 v[132:133], v161 offset:33792
  v_mfma_f32_16x16x32_bf16 v[36:39], v[144:147], v[174:177], v[36:39]
  ds_read_b64_tr_b16 v[134:135], v160 offset:34816
  s_add_u32 m0, s6, 119552
  s_waitcnt lgkmcnt(8)
  v_mfma_f32_16x16x32_bf16 v[40:43], v[148:151], v[170:173], v[40:43]
  buffer_load_dwordx4 v74, s[32:35], s54 offen offset:256  lds
  ds_read_b64_tr_b16 v[136:137], v162 offset:33792
  v_mfma_f32_16x16x32_bf16 v[44:47], v[148:151], v[174:177], v[44:47]
  ds_read_b64_tr_b16 v[138:139], v163 offset:34816
  s_waitcnt lgkmcnt(8)
  v_mfma_f32_16x16x32_bf16 v[48:51], v[152:155], v[170:173], v[48:51]
  ds_read_b64_tr_b16 v[140:141], v163 offset:33792
  v_mfma_f32_16x16x32_bf16 v[52:55], v[152:155], v[174:177], v[52:55]
  ds_read_b64_tr_b16 v[142:143], v162 offset:34816
  s_add_u32 m0, s6, 120576
  s_waitcnt lgkmcnt(8)
  v_mfma_f32_16x16x32_bf16 v[56:59], v[156:159], v[170:173], v[56:59]
  buffer_load_dwordx4 v75, s[32:35], s54 offen offset:256  lds
  ds_read_b64_tr_b16 v[144:145], v164 offset:33792
  v_mfma_f32_16x16x32_bf16 v[60:63], v[156:159], v[174:177], v[60:63]
  ds_read_b64_tr_b16 v[146:147], v165 offset:34816
  s_waitcnt lgkmcnt(8)
  v_mfma_f32_16x16x32_bf16 v[192:195], v[128:131], v[170:173], v[192:195]
  s_add_u32 s54, s54, 262144
  s_cmp_eq_u32 s54, 4718592
  s_cselect_b32 s54, 0, s54
  ds_read_b64_tr_b16 v[148:149], v165 offset:33792
  v_mfma_f32_16x16x32_bf16 v[196:199], v[128:131], v[174:177], v[196:199]
  ds_read_b64_tr_b16 v[150:151], v164 offset:34816
  s_waitcnt lgkmcnt(8)
  v_mfma_f32_16x16x32_bf16 v[200:203], v[132:135], v[170:173], v[200:203]
  ds_read_b64_tr_b16 v[152:153], v166 offset:33792
  v_mfma_f32_16x16x32_bf16 v[204:207], v[132:135], v[174:177], v[204:207]
  ds_read_b64_tr_b16 v[154:155], v167 offset:34816
  s_waitcnt lgkmcnt(8)
  v_mfma_f32_16x16x32_bf16 v[208:211], v[136:139], v[170:173], v[208:211]
  s_waitcnt vmcnt(8)
  s_barrier
  ds_read_b64_tr_b16 v[156:157], v167 offset:33792
  v_mfma_f32_16x16x32_bf16 v[212:215], v[136:139], v[174:177], v[212:215]
  ds_read_b64_tr_b16 v[158:159], v166 offset:34816
  s_waitcnt lgkmcnt(8)
  v_mfma_f32_16x16x32_bf16 v[216:219], v[140:143], v[170:173], v[216:219]
  ds_read_b64_tr_b16 v[128:129], v64 offset:0
  v_mfma_f32_16x16x32_bf16 v[220:223], v[140:143], v[174:177], v[220:223]
  ds_read_b64_tr_b16 v[130:131], v65 offset:1024
  ds_read_b128 v[178:181], v72 offset:0
  s_waitcnt lgkmcnt(9)
  v_mfma_f32_16x16x32_bf16 v[224:227], v[144:147], v[170:173], v[224:227]
  ds_read_b64_tr_b16 v[132:133], v65 offset:0
  v_mfma_f32_16x16x32_bf16 v[228:231], v[144:147], v[174:177], v[228:231]
  ds_read_b64_tr_b16 v[134:135], v64 offset:1024
  ds_read_b128 v[182:185], v72 offset:1024
  s_waitcnt lgkmcnt(10)
  v_mfma_f32_16x16x32_bf16 v[232:235], v[148:151], v[170:173], v[232:235]
  ds_read_b64_tr_b16 v[136:137], v66 offset:0
  v_mfma_f32_16x16x32_bf16 v[236:239], v[148:151], v[174:177], v[236:239]
  ds_read_b64_tr_b16 v[138:139], v67 offset:1024
  s_waitcnt lgkmcnt(10)
  v_mfma_f32_16x16x32_bf16 v[240:243], v[152:155], v[170:173], v[240:243]
  ds_read_b64_tr_b16 v[140:141], v67 offset:0
  v_mfma_f32_16x16x32_bf16 v[244:247], v[152:155], v[174:177], v[244:247]
  ds_read_b64_tr_b16 v[142:143], v66 offset:1024
  s_waitcnt lgkmcnt(10)
  v_mfma_f32_16x16x32_bf16 v[248:251], v[156:159], v[170:173], v[248:251]
  ds_read_b64_tr_b16 v[144:145], v68 offset:0
  v_mfma_f32_16x16x32_bf16 v[252:255], v[156:159], v[174:177], v[252:255]
  ds_read_b64_tr_b16 v[146:147], v69 offset:1024
  s_waitcnt lgkmcnt(6)
  v_mfma_f32_16x16x32_bf16 v[0:3], v[128:131], v[178:181], v[0:3]
  ds_read_b64_tr_b16 v[148:149], v69 offset:0
  v_mfma_f32_16x16x32_bf16 v[4:7], v[128:131], v[182:185], v[4:7]
  ds_read_b64_tr_b16 v[150:151], v68 offset:1024
  s_add_u32 m0, s6, 9216
  v_mfma_f32_16x16x32_bf16 v[8:11], v[132:135], v[178:181], v[8:11]
  buffer_load_dwordx4 v74, s[32:35], s54 offen offset:0  lds
  ds_read_b64_tr_b16 v[152:153], v70 offset:0
  v_mfma_f32_16x16x32_bf16 v[12:15], v[132:135], v[182:185], v[12:15]
  ds_read_b64_tr_b16 v[154:155], v71 offset:1024
  s_waitcnt lgkmcnt(8)
  v_mfma_f32_16x16x32_bf16 v[16:19], v[136:139], v[178:181], v[16:19]
  ds_read_b64_tr_b16 v[156:157], v71 offset:0
  v_mfma_f32_16x16x32_bf16 v[20:23], v[136:139], v[182:185], v[20:23]
  ds_read_b64_tr_b16 v[158:159], v70 offset:1024
  s_add_u32 m0, s6, 10240
  s_waitcnt lgkmcnt(8)
  v_mfma_f32_16x16x32_bf16 v[24:27], v[140:143], v[178:181], v[24:27]
  buffer_load_dwordx4 v75, s[32:35], s54 offen offset:0  lds
  ds_read_b64_tr_b16 v[128:129], v64 offset:8192
  v_mfma_f32_16x16x32_bf16 v[28:31], v[140:143], v[182:185], v[28:31]
  ds_read_b64_tr_b16 v[130:131], v65 offset:9216
  s_waitcnt lgkmcnt(8)
  v_mfma_f32_16x16x32_bf16 v[32:35], v[144:147], v[178:181], v[32:35]
  ds_read_b64_tr_b16 v[132:133], v65 offset:8192
  v_mfma_f32_16x16x32_bf16 v[36:39], v[144:147], v[182:185], v[36:39]
  ds_read_b64_tr_b16 v[134:135], v64 offset:9216
  s_add_u32 m0, s6, 17152
  s_waitcnt lgkmcnt(8)
  v_mfma_f32_16x16x32_bf16 v[40:43], v[148:151], v[178:181], v[40:43]
  buffer_load_dwordx4 v74, s[32:35], s54 offen offset:256  lds
  ds_read_b64_tr_b16 v[136:137], v66 offset:8192
  v_mfma_f32_16x16x32_bf16 v[44:47], v[148:151], v[182:185], v[44:47]
  ds_read_b64_tr_b16 v[138:139], v67 offset:9216
  s_waitcnt lgkmcnt(8)
  v_mfma_f32_16x16x32_bf16 v[48:51], v[152:155], v[178:181], v[48:51]
  ds_read_b64_tr_b16 v[140:141], v67 offset:8192
  v_mfma_f32_16x16x32_bf16 v[52:55], v[152:155], v[182:185], v[52:55]
  ds_read_b64_tr_b16 v[142:143], v66 offset:9216
  s_add_u32 m0, s6, 18176
  s_waitcnt lgkmcnt(8)
  v_mfma_f32_16x16x32_bf16 v[56:59], v[156:159], v[178:181], v[56:59]
  buffer_load_dwordx4 v75, s[32:35], s54 offen offset:256  lds
  ds_read_b64_tr_b16 v[144:145], v68 offset:8192
  v_mfma_f32_16x16x32_bf16 v[60:63], v[156:159], v[182:185], v[60:63]
  ds_read_b64_tr_b16 v[146:147], v69 offset:9216
  s_waitcnt lgkmcnt(8)
  v_mfma_f32_16x16x32_bf16 v[192:195], v[128:131], v[178:181], v[192:195]
  s_add_u32 s54, s54, 262144
  s_cmp_eq_u32 s54, 4718592
  s_cselect_b32 s54, 0, s54
  ds_read_b64_tr_b16 v[148:149], v69 offset:8192
  v_mfma_f32_16x16x32_bf16 v[196:199], v[128:131], v[182:185], v[196:199]
  ds_read_b64_tr_b16 v[150:151], v68 offset:9216
  s_waitcnt lgkmcnt(8)
  v_mfma_f32_16x16x32_bf16 v[200:203], v[132:135], v[178:181], v[200:203]
  ds_read_b64_tr_b16 v[152:153], v70 offset:8192
  v_mfma_f32_16x16x32_bf16 v[204:207], v[132:135], v[182:185], v[204:207]
  ds_read_b64_tr_b16 v[154:155], v71 offset:9216
  s_waitcnt lgkmcnt(8)
  v_mfma_f32_16x16x32_bf16 v[208:211], v[136:139], v[178:181], v[208:211]
  s_waitcnt vmcnt(8)
  s_barrier
  ds_read_b64_tr_b16 v[156:157], v71 offset:8192
  v_mfma_f32_16x16x32_bf16 v[212:215], v[136:139], v[182:185], v[212:215]
  ds_read_b64_tr_b16 v[158:159], v70 offset:9216
  s_waitcnt lgkmcnt(8)
  v_mfma_f32_16x16x32_bf16 v[216:219], v[140:143], v[178:181], v[216:219]
  ds_read_b64_tr_b16 v[128:129], v64 offset:25600
  v_mfma_f32_16x16x32_bf16 v[220:223], v[140:143], v[182:185], v[220:223]
  ds_read_b64_tr_b16 v[130:131], v65 offset:26624
  ds_read_b128 v[170:173], v72 offset:25600
  s_waitcnt lgkmcnt(9)
  v_mfma_f32_16x16x32_bf16 v[224:227], v[144:147], v[178:181], v[224:227]
  ds_read_b64_tr_b16 v[132:133], v65 offset:25600
  v_mfma_f32_16x16x32_bf16 v[228:231], v[144:147], v[182:185], v[228:231]
  ds_read_b64_tr_b16 v[134:135], v64 offset:26624
  ds_read_b128 v[174:177], v72 offset:26624
  s_waitcnt lgkmcnt(10)
  v_mfma_f32_16x16x32_bf16 v[232:235], v[148:151], v[178:181], v[232:235]
  ds_read_b64_tr_b16 v[136:137], v66 offset:25600
  v_mfma_f32_16x16x32_bf16 v[236:239], v[148:151], v[182:185], v[236:239]
  ds_read_b64_tr_b16 v[138:139], v67 offset:26624
  s_waitcnt lgkmcnt(10)
  v_mfma_f32_16x16x32_bf16 v[240:243], v[152:155], v[178:181], v[240:243]
  ds_read_b64_tr_b16 v[140:141], v67 offset:25600
  v_mfma_f32_16x16x32_bf16 v[244:247], v[152:155], v[182:185], v[244:247]
  ds_read_b64_tr_b16 v[142:143], v66 offset:26624
  s_waitcnt lgkmcnt(10)
  v_mfma_f32_16x16x32_bf16 v[248:251], v[156:159], v[178:181], v[248:251]
  ds_read_b64_tr_b16 v[144:145], v68 offset:25600
  v_mfma_f32_16x16x32_bf16 v[252:255], v[156:159], v[182:185], v[252:255]
  ds_read_b64_tr_b16 v[146:147], v69 offset:26624
  s_waitcnt lgkmcnt(6)
  v_mfma_f32_16x16x32_bf16 v[0:3], v[128:131], v[170:173], v[0:3]
  ds_read_b64_tr_b16 v[148:149], v69 offset:25600
  v_mfma_f32_16x16x32_bf16 v[4:7], v[128:131], v[174:177], v[4:7]
  ds_read_b64_tr_b16 v[150:151], v68 offset:26624
  s_add_u32 m0, s6, 34816
  v_mfma_f32_16x16x32_bf16 v[8:11], v[132:135], v[170:173], v[8:11]
  buffer_load_dwordx4 v74, s[32:35], s54 offen offset:0  lds
  ds_read_b64_tr_b16 v[152:153], v70 offset:25600
  v_mfma_f32_16x16x32_bf16 v[12:15], v[132:135], v[174:177], v[12:15]
  ds_read_b64_tr_b16 v[154:155], v71 offset:26624
  s_waitcnt lgkmcnt(8)
  v_mfma_f32_16x16x32_bf16 v[16:19], v[136:139], v[170:173], v[16:19]
  ds_read_b64_tr_b16 v[156:157], v71 offset:25600
  v_mfma_f32_16x16x32_bf16 v[20:23], v[136:139], v[174:177], v[20:23]
  ds_read_b64_tr_b16 v[158:159], v70 offset:26624
  s_add_u32 m0, s6, 35840
  s_waitcnt lgkmcnt(8)
  v_mfma_f32_16x16x32_bf16 v[24:27], v[140:143], v[170:173], v[24:27]
  buffer_load_dwordx4 v75, s[32:35], s54 offen offset:0  lds
  ds_read_b64_tr_b16 v[128:129], v64 offset:33792
  v_mfma_f32_16x16x32_bf16 v[28:31], v[140:143], v[174:177], v[28:31]
  ds_read_b64_tr_b16 v[130:131], v65 offset:34816
  s_waitcnt lgkmcnt(8)
  v_mfma_f32_16x16x32_bf16 v[32:35], v[144:147], v[170:173], v[32:35]
  ds_read_b64_tr_b16 v[132:133], v65 offset:33792
  v_mfma_f32_16x16x32_bf16 v[36:39], v[144:147], v[174:177], v[36:39]
  ds_read_b64_tr_b16 v[134:135], v64 offset:34816
  s_add_u32 m0, s6, 42752
  s_waitcnt lgkmcnt(8)
  v_mfma_f32_16x16x32_bf16 v[40:43], v[148:151], v[170:173], v[40:43]
  buffer_load_dwordx4 v74, s[32:35], s54 offen offset:256  lds
  ds_read_b64_tr_b16 v[136:137], v66 offset:33792
  v_mfma_f32_16x16x32_bf16 v[44:47], v[148:151], v[174:177], v[44:47]
  ds_read_b64_tr_b16 v[138:139], v67 offset:34816
  s_waitcnt lgkmcnt(8)
  v_mfma_f32_16x16x32_bf16 v[48:51], v[152:155], v[170:173], v[48:51]
  ds_read_b64_tr_b16 v[140:141], v67 offset:33792
  v_mfma_f32_16x16x32_bf16 v[52:55], v[152:155], v[174:177], v[52:55]
  ds_read_b64_tr_b16 v[142:143], v66 offset:34816
  s_add_u32 m0, s6, 43776
  s_waitcnt lgkmcnt(8)
  v_mfma_f32_16x16x32_bf16 v[56:59], v[156:159], v[170:173], v[56:59]
  buffer_load_dwordx4 v75, s[32:35], s54 offen offset:256  lds
  ds_read_b64_tr_b16 v[144:145], v68 offset:33792
  v_mfma_f32_16x16x32_bf16 v[60:63], v[156:159], v[174:177], v[60:63]
  ds_read_b64_tr_b16 v[146:147], v69 offset:34816
  s_waitcnt lgkmcnt(8)
  v_mfma_f32_16x16x32_bf16 v[192:195], v[128:131], v[170:173], v[192:195]
  s_add_u32 s54, s54, 262144
  s_cmp_eq_u32 s54, 4718592
  s_cselect_b32 s54, 0, s54
  ds_read_b64_tr_b16 v[148:149], v69 offset:33792
  v_mfma_f32_16x16x32_bf16 v[196:199], v[128:131], v[174:177], v[196:199]
  ds_read_b64_tr_b16 v[150:151], v68 offset:34816
  s_waitcnt lgkmcnt(8)
  v_mfma_f32_16x16x32_bf16 v[200:203], v[132:135], v[170:173], v[200:203]
  ds_read_b64_tr_b16 v[152:153], v70 offset:33792
  v_mfma_f32_16x16x32_bf16 v[204:207], v[132:135], v[174:177], v[204:207]
  ds_read_b64_tr_b16 v[154:155], v71 offset:34816
  s_waitcnt lgkmcnt(8)
  v_mfma_f32_16x16x32_bf16 v[208:211], v[136:139], v[170:173], v[208:211]
  s_waitcnt vmcnt(8)
  s_barrier
  ds_read_b64_tr_b16 v[156:157], v71 offset:33792
  v_mfma_f32_16x16x32_bf16 v[212:215], v[136:139], v[174:177], v[212:215]
  ds_read_b64_tr_b16 v[158:159], v70 offset:34816
  s_waitcnt lgkmcnt(8)
  v_mfma_f32_16x16x32_bf16 v[216:219], v[140:143], v[170:173], v[216:219]
  ds_read_b64_tr_b16 v[128:129], v64 offset:51200
  v_mfma_f32_16x16x32_bf16 v[220:223], v[140:143], v[174:177], v[220:223]
  ds_read_b64_tr_b16 v[130:131], v65 offset:52224
  ds_read_b128 v[178:181], v72 offset:51200
  s_waitcnt lgkmcnt(9)
  v_mfma_f32_16x16x32_bf16 v[224:227], v[144:147], v[170:173], v[224:227]
  ds_read_b64_tr_b16 v[132:133], v65 offset:51200
  v_mfma_f32_16x16x32_bf16 v[228:231], v[144:147], v[174:177], v[228:231]
  ds_read_b64_tr_b16 v[134:135], v64 offset:52224
  ds_read_b128 v[182:185], v72 offset:52224
  s_waitcnt lgkmcnt(10)
  v_mfma_f32_16x16x32_bf16 v[232:235], v[148:151], v[170:173], v[232:235]
  ds_read_b64_tr_b16 v[136:137], v66 offset:51200
  v_mfma_f32_16x16x32_bf16 v[236:239], v[148:151], v[174:177], v[236:239]
  ds_read_b64_tr_b16 v[138:139], v67 offset:52224
  s_waitcnt lgkmcnt(10)
  v_mfma_f32_16x16x32_bf16 v[240:243], v[152:155], v[170:173], v[240:243]
  ds_read_b64_tr_b16 v[140:141], v67 offset:51200
  v_mfma_f32_16x16x32_bf16 v[244:247], v[152:155], v[174:177], v[244:247]
  ds_read_b64_tr_b16 v[142:143], v66 offset:52224
  s_waitcnt lgkmcnt(10)
  v_mfma_f32_16x16x32_bf16 v[248:251], v[156:159], v[170:173], v[248:251]
  ds_read_b64_tr_b16 v[144:145], v68 offset:51200
  v_mfma_f32_16x16x32_bf16 v[252:255], v[156:159], v[174:177], v[252:255]
  ds_read_b64_tr_b16 v[146:147], v69 offset:52224
  s_waitcnt lgkmcnt(6)
  v_mfma_f32_16x16x32_bf16 v[0:3], v[128:131], v[178:181], v[0:3]
  ds_read_b64_tr_b16 v[148:149], v69 offset:51200
  v_mfma_f32_16x16x32_bf16 v[4:7], v[128:131], v[182:185], v[4:7]
  ds_read_b64_tr_b16 v[150:151], v68 offset:52224
  s_add_u32 m0, s6, 60416
  v_mfma_f32_16x16x32_bf16 v[8:11], v[132:135], v[178:181], v[8:11]
  buffer_load_dwordx4 v74, s[32:35], s54 offen offset:0  lds
  ds_read_b64_tr_b16 v[152:153], v70 offset:51200
  v_mfma_f32_16x16x32_bf16 v[12:15], v[132:135], v[182:185], v[12:15]
  ds_read_b64_tr_b16 v[154:155], v71 offset:52224
  s_waitcnt lgkmcnt(8)
  v_mfma_f32_16x16x32_bf16 v[16:19], v[136:139], v[178:181], v[16:19]
  ds_read_b64_tr_b16 v[156:157], v71 offset:51200
  v_mfma_f32_16x16x32_bf16 v[20:23], v[136:139], v[182:185], v[20:23]
  ds_read_b64_tr_b16 v[158:159], v70 offset:52224
  s_add_u32 m0, s6, 61440
  s_waitcnt lgkmcnt(8)
  v_mfma_f32_16x16x32_bf16 v[24:27], v[140:143], v[178:181], v[24:27]
  buffer_load_dwordx4 v75, s[32:35], s54 offen offset:0  lds
  ds_read_b64_tr_b16 v[128:129], v64 offset:59392
  v_mfma_f32_16x16x32_bf16 v[28:31], v[140:143], v[182:185], v[28:31]
  ds_read_b64_tr_b16 v[130:131], v65 offset:60416
  s_waitcnt lgkmcnt(8)
  v_mfma_f32_16x16x32_bf16 v[32:35], v[144:147], v[178:181], v[32:35]
  ds_read_b64_tr_b16 v[132:133], v65 offset:59392
  v_mfma_f32_16x16x32_bf16 v[36:39], v[144:147], v[182:185], v[36:39]
  ds_read_b64_tr_b16 v[134:135], v64 offset:60416
  s_add_u32 m0, s6, 68352
  s_waitcnt lgkmcnt(8)
  v_mfma_f32_16x16x32_bf16 v[40:43], v[148:151], v[178:181], v[40:43]
  buffer_load_dwordx4 v74, s[32:35], s54 offen offset:256  lds
  ds_read_b64_tr_b16 v[136:137], v66 offset:59392
  v_mfma_f32_16x16x32_bf16 v[44:47], v[148:151], v[182:185], v[44:47]
  ds_read_b64_tr_b16 v[138:139], v67 offset:60416
  s_waitcnt lgkmcnt(8)
  v_mfma_f32_16x16x32_bf16 v[48:51], v[152:155], v[178:181], v[48:51]
  ds_read_b64_tr_b16 v[140:141], v67 offset:59392
  v_mfma_f32_16x16x32_bf16 v[52:55], v[152:155], v[182:185], v[52:55]
  ds_read_b64_tr_b16 v[142:143], v66 offset:60416
  s_add_u32 m0, s6, 69376
  s_waitcnt lgkmcnt(8)
  v_mfma_f32_16x16x32_bf16 v[56:59], v[156:159], v[178:181], v[56:59]
  buffer_load_dwordx4 v75, s[32:35], s54 offen offset:256  lds
  ds_read_b64_tr_b16 v[144:145], v68 offset:59392
  v_mfma_f32_16x16x32_bf16 v[60:63], v[156:159], v[182:185], v[60:63]
  ds_read_b64_tr_b16 v[146:147], v69 offset:60416
  s_waitcnt lgkmcnt(8)
  v_mfma_f32_16x16x32_bf16 v[192:195], v[128:131], v[178:181], v[192:195]
  s_add_u32 s54, s54, 262144
  s_cmp_eq_u32 s54, 4718592
  s_cselect_b32 s54, 0, s54
  ds_read_b64_tr_b16 v[148:149], v69 offset:59392
  v_mfma_f32_16x16x32_bf16 v[196:199], v[128:131], v[182:185], v[196:199]
  ds_read_b64_tr_b16 v[150:151], v68 offset:60416
  s_waitcnt lgkmcnt(8)
  v_mfma_f32_16x16x32_bf16 v[200:203], v[132:135], v[178:181], v[200:203]
  ds_read_b64_tr_b16 v[152:153], v70 offset:59392
  v_mfma_f32_16x16x32_bf16 v[204:207], v[132:135], v[182:185], v[204:207]
  ds_read_b64_tr_b16 v[154:155], v71 offset:60416
  s_waitcnt lgkmcnt(8)
  v_mfma_f32_16x16x32_bf16 v[208:211], v[136:139], v[178:181], v[208:211]
  s_waitcnt vmcnt(8)
  s_barrier
  ds_read_b64_tr_b16 v[156:157], v71 offset:59392
  v_mfma_f32_16x16x32_bf16 v[212:215], v[136:139], v[182:185], v[212:215]
  ds_read_b64_tr_b16 v[158:159], v70 offset:60416
  s_waitcnt lgkmcnt(8)
  v_mfma_f32_16x16x32_bf16 v[216:219], v[140:143], v[178:181], v[216:219]
  ds_read_b64_tr_b16 v[128:129], v160 offset:0
  v_mfma_f32_16x16x32_bf16 v[220:223], v[140:143], v[182:185], v[220:223]
  ds_read_b64_tr_b16 v[130:131], v161 offset:1024
  ds_read_b128 v[170:173], v168 offset:0
  s_waitcnt lgkmcnt(9)
  v_mfma_f32_16x16x32_bf16 v[224:227], v[144:147], v[178:181], v[224:227]
  ds_read_b64_tr_b16 v[132:133], v161 offset:0
  v_mfma_f32_16x16x32_bf16 v[228:231], v[144:147], v[182:185], v[228:231]
  ds_read_b64_tr_b16 v[134:135], v160 offset:1024
  ds_read_b128 v[174:177], v168 offset:1024
  s_waitcnt lgkmcnt(10)
  v_mfma_f32_16x16x32_bf16 v[232:235], v[148:151], v[178:181], v[232:235]
  ds_read_b64_tr_b16 v[136:137], v162 offset:0
  v_mfma_f32_16x16x32_bf16 v[236:239], v[148:151], v[182:185], v[236:239]
  ds_read_b64_tr_b16 v[138:139], v163 offset:1024
  s_waitcnt lgkmcnt(10)
  v_mfma_f32_16x16x32_bf16 v[240:243], v[152:155], v[178:181], v[240:243]
  ds_read_b64_tr_b16 v[140:141], v163 offset:0
  v_mfma_f32_16x16x32_bf16 v[244:247], v[152:155], v[182:185], v[244:247]
  ds_read_b64_tr_b16 v[142:143], v162 offset:1024
  s_waitcnt lgkmcnt(10)
  v_mfma_f32_16x16x32_bf16 v[248:251], v[156:159], v[178:181], v[248:251]
  ds_read_b64_tr_b16 v[144:145], v164 offset:0
  v_mfma_f32_16x16x32_bf16 v[252:255], v[156:159], v[182:185], v[252:255]
  ds_read_b64_tr_b16 v[146:147], v165 offset:1024
  s_waitcnt lgkmcnt(6)
  v_mfma_f32_16x16x32_bf16 v[0:3], v[128:131], v[170:173], v[0:3]
  ds_read_b64_tr_b16 v[148:149], v165 offset:0
  v_mfma_f32_16x16x32_bf16 v[4:7], v[128:131], v[174:177], v[4:7]
  ds_read_b64_tr_b16 v[150:151], v164 offset:1024
  s_add_u32 m0, s6, 86016
  v_mfma_f32_16x16x32_bf16 v[8:11], v[132:135], v[170:173], v[8:11]
  buffer_load_dwordx4 v74, s[32:35], s54 offen offset:0  lds
  ds_read_b64_tr_b16 v[152:153], v166 offset:0
  v_mfma_f32_16x16x32_bf16 v[12:15], v[132:135], v[174:177], v[12:15]
  ds_read_b64_tr_b16 v[154:155], v167 offset:1024
  s_waitcnt lgkmcnt(8)
  v_mfma_f32_16x16x32_bf16 v[16:19], v[136:139], v[170:173], v[16:19]
  ds_read_b64_tr_b16 v[156:157], v167 offset:0
  v_mfma_f32_16x16x32_bf16 v[20:23], v[136:139], v[174:177], v[20:23]
  ds_read_b64_tr_b16 v[158:159], v166 offset:1024
  s_add_u32 m0, s6, 87040
  s_waitcnt lgkmcnt(8)
  v_mfma_f32_16x16x32_bf16 v[24:27], v[140:143], v[170:173], v[24:27]
  buffer_load_dwordx4 v75, s[32:35], s54 offen offset:0  lds
  ds_read_b64_tr_b16 v[128:129], v160 offset:8192
  v_mfma_f32_16x16x32_bf16 v[28:31], v[140:143], v[174:177], v[28:31]
  ds_read_b64_tr_b16 v[130:131], v161 offset:9216
  s_waitcnt lgkmcnt(8)
  v_mfma_f32_16x16x32_bf16 v[32:35], v[144:147], v[170:173], v[32:35]
  ds_read_b64_tr_b16 v[132:133], v161 offset:8192
  v_mfma_f32_16x16x32_bf16 v[36:39], v[144:147], v[174:177], v[36:39]
  ds_read_b64_tr_b16 v[134:135], v160 offset:9216
  s_add_u32 m0, s6, 93952
  s_waitcnt lgkmcnt(8)
  v_mfma_f32_16x16x32_bf16 v[40:43], v[148:151], v[170:173], v[40:43]
  buffer_load_dwordx4 v74, s[32:35], s54 offen offset:256  lds
  ds_read_b64_tr_b16 v[136:137], v162 offset:8192
  v_mfma_f32_16x16x32_bf16 v[44:47], v[148:151], v[174:177], v[44:47]
  ds_read_b64_tr_b16 v[138:139], v163 offset:9216
  s_waitcnt lgkmcnt(8)
  v_mfma_f32_16x16x32_bf16 v[48:51], v[152:155], v[170:173], v[48:51]
  ds_read_b64_tr_b16 v[140:141], v163 offset:8192
  v_mfma_f32_16x16x32_bf16 v[52:55], v[152:155], v[174:177], v[52:55]
  ds_read_b64_tr_b16 v[142:143], v162 offset:9216
  s_add_u32 m0, s6, 94976
  s_waitcnt lgkmcnt(8)
  v_mfma_f32_16x16x32_bf16 v[56:59], v[156:159], v[170:173], v[56:59]
  buffer_load_dwordx4 v75, s[32:35], s54 offen offset:256  lds
  ds_read_b64_tr_b16 v[144:145], v164 offset:8192
  v_mfma_f32_16x16x32_bf16 v[60:63], v[156:159], v[174:177], v[60:63]
  ds_read_b64_tr_b16 v[146:147], v165 offset:9216
  s_waitcnt lgkmcnt(8)
  v_mfma_f32_16x16x32_bf16 v[192:195], v[128:131], v[170:173], v[192:195]
  s_add_u32 s54, s54, 262144
  s_cmp_eq_u32 s54, 4718592
  s_cselect_b32 s54, 0, s54
  ds_read_b64_tr_b16 v[148:149], v165 offset:8192
  v_mfma_f32_16x16x32_bf16 v[196:199], v[128:131], v[174:177], v[196:199]
  ds_read_b64_tr_b16 v[150:151], v164 offset:9216
  s_waitcnt lgkmcnt(8)
  v_mfma_f32_16x16x32_bf16 v[200:203], v[132:135], v[170:173], v[200:203]
  ds_read_b64_tr_b16 v[152:153], v166 offset:8192
  v_mfma_f32_16x16x32_bf16 v[204:207], v[132:135], v[174:177], v[204:207]
  ds_read_b64_tr_b16 v[154:155], v167 offset:9216
  s_waitcnt lgkmcnt(8)
  v_mfma_f32_16x16x32_bf16 v[208:211], v[136:139], v[170:173], v[208:211]
  s_waitcnt vmcnt(8)
  s_barrier
  ds_read_b64_tr_b16 v[156:157], v167 offset:8192
  v_mfma_f32_16x16x32_bf16 v[212:215], v[136:139], v[174:177], v[212:215]
  ds_read_b64_tr_b16 v[158:159], v166 offset:9216
  s_waitcnt lgkmcnt(8)
  v_mfma_f32_16x16x32_bf16 v[216:219], v[140:143], v[170:173], v[216:219]
  ds_read_b64_tr_b16 v[128:129], v160 offset:25600
  v_mfma_f32_16x16x32_bf16 v[220:223], v[140:143], v[174:177], v[220:223]
  ds_read_b64_tr_b16 v[130:131], v161 offset:26624
  ds_read_b128 v[178:181], v168 offset:25600
  s_waitcnt lgkmcnt(9)
  v_mfma_f32_16x16x32_bf16 v[224:227], v[144:147], v[170:173], v[224:227]
  ds_read_b64_tr_b16 v[132:133], v161 offset:25600
  v_mfma_f32_16x16x32_bf16 v[228:231], v[144:147], v[174:177], v[228:231]
  ds_read_b64_tr_b16 v[134:135], v160 offset:26624
  ds_read_b128 v[182:185], v168 offset:26624
  s_waitcnt lgkmcnt(10)
  v_mfma_f32_16x16x32_bf16 v[232:235], v[148:151], v[170:173], v[232:235]
  ds_read_b64_tr_b16 v[136:137], v162 offset:25600
  v_mfma_f32_16x16x32_bf16 v[236:239], v[148:151], v[174:177], v[236:239]
  ds_read_b64_tr_b16 v[138:139], v163 offset:26624
  s_waitcnt lgkmcnt(10)
  v_mfma_f32_16x16x32_bf16 v[240:243], v[152:155], v[170:173], v[240:243]
  ds_read_b64_tr_b16 v[140:141], v163 offset:25600
  v_mfma_f32_16x16x32_bf16 v[244:247], v[152:155], v[174:177], v[244:247]
  ds_read_b64_tr_b16 v[142:143], v162 offset:26624
  s_waitcnt lgkmcnt(10)
  v_mfma_f32_16x16x32_bf16 v[248:251], v[156:159], v[170:173], v[248:251]
  ds_read_b64_tr_b16 v[144:145], v164 offset:25600
  v_mfma_f32_16x16x32_bf16 v[252:255], v[156:159], v[174:177], v[252:255]
  ds_read_b64_tr_b16 v[146:147], v165 offset:26624
  s_waitcnt lgkmcnt(6)
  v_mfma_f32_16x16x32_bf16 v[0:3], v[128:131], v[178:181], v[0:3]
  ds_read_b64_tr_b16 v[148:149], v165 offset:25600
  v_mfma_f32_16x16x32_bf16 v[4:7], v[128:131], v[182:185], v[4:7]
  ds_read_b64_tr_b16 v[150:151], v164 offset:26624
  s_add_u32 m0, s6, 111616
  v_mfma_f32_16x16x32_bf16 v[8:11], v[132:135], v[178:181], v[8:11]
  buffer_load_dwordx4 v74, s[32:35], s54 offen offset:0  lds
  ds_read_b64_tr_b16 v[152:153], v166 offset:25600
  v_mfma_f32_16x16x32_bf16 v[12:15], v[132:135], v[182:185], v[12:15]
  ds_read_b64_tr_b16 v[154:155], v167 offset:26624
  s_waitcnt lgkmcnt(8)
  v_mfma_f32_16x16x32_bf16 v[16:19], v[136:139], v[178:181], v[16:19]
  ds_read_b64_tr_b16 v[156:157], v167 offset:25600
  v_mfma_f32_16x16x32_bf16 v[20:23], v[136:139], v[182:185], v[20:23]
  ds_read_b64_tr_b16 v[158:159], v166 offset:26624
  s_add_u32 m0, s6, 112640
  s_waitcnt lgkmcnt(8)
  v_mfma_f32_16x16x32_bf16 v[24:27], v[140:143], v[178:181], v[24:27]
  buffer_load_dwordx4 v75, s[32:35], s54 offen offset:0  lds
  ds_read_b64_tr_b16 v[128:129], v160 offset:33792
  v_mfma_f32_16x16x32_bf16 v[28:31], v[140:143], v[182:185], v[28:31]
  ds_read_b64_tr_b16 v[130:131], v161 offset:34816
  s_waitcnt lgkmcnt(8)
  v_mfma_f32_16x16x32_bf16 v[32:35], v[144:147], v[178:181], v[32:35]
  ds_read_b64_tr_b16 v[132:133], v161 offset:33792
  v_mfma_f32_16x16x32_bf16 v[36:39], v[144:147], v[182:185], v[36:39]
  ds_read_b64_tr_b16 v[134:135], v160 offset:34816
  s_add_u32 m0, s6, 119552
  s_waitcnt lgkmcnt(8)
  v_mfma_f32_16x16x32_bf16 v[40:43], v[148:151], v[178:181], v[40:43]
  buffer_load_dwordx4 v74, s[32:35], s54 offen offset:256  lds
  ds_read_b64_tr_b16 v[136:137], v162 offset:33792
  v_mfma_f32_16x16x32_bf16 v[44:47], v[148:151], v[182:185], v[44:47]
  ds_read_b64_tr_b16 v[138:139], v163 offset:34816
  s_waitcnt lgkmcnt(8)
  v_mfma_f32_16x16x32_bf16 v[48:51], v[152:155], v[178:181], v[48:51]
  ds_read_b64_tr_b16 v[140:141], v163 offset:33792
  v_mfma_f32_16x16x32_bf16 v[52:55], v[152:155], v[182:185], v[52:55]
  ds_read_b64_tr_b16 v[142:143], v162 offset:34816
  s_add_u32 m0, s6, 120576
  s_waitcnt lgkmcnt(8)
  v_mfma_f32_16x16x32_bf16 v[56:59], v[156:159], v[178:181], v[56:59]
  buffer_load_dwordx4 v75, s[32:35], s54 offen offset:256  lds
  ds_read_b64_tr_b16 v[144:145], v164 offset:33792
  v_mfma_f32_16x16x32_bf16 v[60:63], v[156:159], v[182:185], v[60:63]
  ds_read_b64_tr_b16 v[146:147], v165 offset:34816
  s_waitcnt lgkmcnt(8)
  v_mfma_f32_16x16x32_bf16 v[192:195], v[128:131], v[178:181], v[192:195]
  s_add_u32 s54, s54, 262144
  s_cmp_eq_u32 s54, 4718592
  s_cselect_b32 s54, 0, s54
  ds_read_b64_tr_b16 v[148:149], v165 offset:33792
  v_mfma_f32_16x16x32_bf16 v[196:199], v[128:131], v[182:185], v[196:199]
  ds_read_b64_tr_b16 v[150:151], v164 offset:34816
  s_waitcnt lgkmcnt(8)
  v_mfma_f32_16x16x32_bf16 v[200:203], v[132:135], v[178:181], v[200:203]
  ds_read_b64_tr_b16 v[152:153], v166 offset:33792
  v_mfma_f32_16x16x32_bf16 v[204:207], v[132:135], v[182:185], v[204:207]
  ds_read_b64_tr_b16 v[154:155], v167 offset:34816
  s_waitcnt lgkmcnt(8)
  v_mfma_f32_16x16x32_bf16 v[208:211], v[136:139], v[178:181], v[208:211]
  s_waitcnt vmcnt(8)
  s_barrier
  ds_read_b64_tr_b16 v[156:157], v167 offset:33792
  v_mfma_f32_16x16x32_bf16 v[212:215], v[136:139], v[182:185], v[212:215]
  ds_read_b64_tr_b16 v[158:159], v166 offset:34816
  s_waitcnt lgkmcnt(8)
  v_mfma_f32_16x16x32_bf16 v[216:219], v[140:143], v[178:181], v[216:219]
  ds_read_b64_tr_b16 v[128:129], v64 offset:0
  v_mfma_f32_16x16x32_bf16 v[220:223], v[140:143], v[182:185], v[220:223]
  ds_read_b64_tr_b16 v[130:131], v65 offset:1024
  ds_read_b128 v[170:173], v72 offset:0
  s_waitcnt lgkmcnt(9)
  v_mfma_f32_16x16x32_bf16 v[224:227], v[144:147], v[178:181], v[224:227]
  ds_read_b64_tr_b16 v[132:133], v65 offset:0
  v_mfma_f32_16x16x32_bf16 v[228:231], v[144:147], v[182:185], v[228:231]
  ds_read_b64_tr_b16 v[134:135], v64 offset:1024
  ds_read_b128 v[174:177], v72 offset:1024
  s_waitcnt lgkmcnt(10)
  v_mfma_f32_16x16x32_bf16 v[232:235], v[148:151], v[178:181], v[232:235]
  ds_read_b64_tr_b16 v[136:137], v66 offset:0
  v_mfma_f32_16x16x32_bf16 v[236:239], v[148:151], v[182:185], v[236:239]
  ds_read_b64_tr_b16 v[138:139], v67 offset:1024
  s_waitcnt lgkmcnt(10)
  v_mfma_f32_16x16x32_bf16 v[240:243], v[152:155], v[178:181], v[240:243]
  ds_read_b64_tr_b16 v[140:141], v67 offset:0
  v_mfma_f32_16x16x32_bf16 v[244:247], v[152:155], v[182:185], v[244:247]
  ds_read_b64_tr_b16 v[142:143], v66 offset:1024
  s_waitcnt lgkmcnt(10)
  v_mfma_f32_16x16x32_bf16 v[248:251], v[156:159], v[178:181], v[248:251]
  ds_read_b64_tr_b16 v[144:145], v68 offset:0
  v_mfma_f32_16x16x32_bf16 v[252:255], v[156:159], v[182:185], v[252:255]
  ds_read_b64_tr_b16 v[146:147], v69 offset:1024
  s_waitcnt lgkmcnt(6)
  v_mfma_f32_16x16x32_bf16 v[0:3], v[128:131], v[170:173], v[0:3]
  ds_read_b64_tr_b16 v[148:149], v69 offset:0
  v_mfma_f32_16x16x32_bf16 v[4:7], v[128:131], v[174:177], v[4:7]
  ds_read_b64_tr_b16 v[150:151], v68 offset:1024
  s_add_u32 m0, s6, 9216
  v_mfma_f32_16x16x32_bf16 v[8:11], v[132:135], v[170:173], v[8:11]
  buffer_load_dwordx4 v74, s[32:35], s54 offen offset:0  lds
  ds_read_b64_tr_b16 v[152:153], v70 offset:0
  v_mfma_f32_16x16x32_bf16 v[12:15], v[132:135], v[174:177], v[12:15]
  ds_read_b64_tr_b16 v[154:155], v71 offset:1024
  s_waitcnt lgkmcnt(8)
  v_mfma_f32_16x16x32_bf16 v[16:19], v[136:139], v[170:173], v[16:19]
  ds_read_b64_tr_b16 v[156:157], v71 offset:0
  v_mfma_f32_16x16x32_bf16 v[20:23], v[136:139], v[174:177], v[20:23]
  ds_read_b64_tr_b16 v[158:159], v70 offset:1024
  s_add_u32 m0, s6, 10240
  s_waitcnt lgkmcnt(8)
  v_mfma_f32_16x16x32_bf16 v[24:27], v[140:143], v[170:173], v[24:27]
  buffer_load_dwordx4 v75, s[32:35], s54 offen offset:0  lds
  ds_read_b64_tr_b16 v[128:129], v64 offset:8192
  v_mfma_f32_16x16x32_bf16 v[28:31], v[140:143], v[174:177], v[28:31]
  ds_read_b64_tr_b16 v[130:131], v65 offset:9216
  s_waitcnt lgkmcnt(8)
  v_mfma_f32_16x16x32_bf16 v[32:35], v[144:147], v[170:173], v[32:35]
  ds_read_b64_tr_b16 v[132:133], v65 offset:8192
  v_mfma_f32_16x16x32_bf16 v[36:39], v[144:147], v[174:177], v[36:39]
  ds_read_b64_tr_b16 v[134:135], v64 offset:9216
  s_add_u32 m0, s6, 17152
  s_waitcnt lgkmcnt(8)
  v_mfma_f32_16x16x32_bf16 v[40:43], v[148:151], v[170:173], v[40:43]
  buffer_load_dwordx4 v74, s[32:35], s54 offen offset:256  lds
  ds_read_b64_tr_b16 v[136:137], v66 offset:8192
  v_mfma_f32_16x16x32_bf16 v[44:47], v[148:151], v[174:177], v[44:47]
  ds_read_b64_tr_b16 v[138:139], v67 offset:9216
  s_waitcnt lgkmcnt(8)
  v_mfma_f32_16x16x32_bf16 v[48:51], v[152:155], v[170:173], v[48:51]
  ds_read_b64_tr_b16 v[140:141], v67 offset:8192
  v_mfma_f32_16x16x32_bf16 v[52:55], v[152:155], v[174:177], v[52:55]
  ds_read_b64_tr_b16 v[142:143], v66 offset:9216
  s_add_u32 m0, s6, 18176
  s_waitcnt lgkmcnt(8)
  v_mfma_f32_16x16x32_bf16 v[56:59], v[156:159], v[170:173], v[56:59]
  buffer_load_dwordx4 v75, s[32:35], s54 offen offset:256  lds
  ds_read_b64_tr_b16 v[144:145], v68 offset:8192
  v_mfma_f32_16x16x32_bf16 v[60:63], v[156:159], v[174:177], v[60:63]
  ds_read_b64_tr_b16 v[146:147], v69 offset:9216
  s_waitcnt lgkmcnt(8)
  v_mfma_f32_16x16x32_bf16 v[192:195], v[128:131], v[170:173], v[192:195]
  s_add_u32 s54, s54, 262144
  s_cmp_eq_u32 s54, 4718592
  s_cselect_b32 s54, 0, s54
  ds_read_b64_tr_b16 v[148:149], v69 offset:8192
  v_mfma_f32_16x16x32_bf16 v[196:199], v[128:131], v[174:177], v[196:199]
  ds_read_b64_tr_b16 v[150:151], v68 offset:9216
  s_waitcnt lgkmcnt(8)
  v_mfma_f32_16x16x32_bf16 v[200:203], v[132:135], v[170:173], v[200:203]
  ds_read_b64_tr_b16 v[152:153], v70 offset:8192
  v_mfma_f32_16x16x32_bf16 v[204:207], v[132:135], v[174:177], v[204:207]
  ds_read_b64_tr_b16 v[154:155], v71 offset:9216
  s_waitcnt lgkmcnt(8)
  v_mfma_f32_16x16x32_bf16 v[208:211], v[136:139], v[170:173], v[208:211]
  s_waitcnt vmcnt(8)
  s_barrier
  ds_read_b64_tr_b16 v[156:157], v71 offset:8192
  v_mfma_f32_16x16x32_bf16 v[212:215], v[136:139], v[174:177], v[212:215]
  ds_read_b64_tr_b16 v[158:159], v70 offset:9216
  s_waitcnt lgkmcnt(8)
  v_mfma_f32_16x16x32_bf16 v[216:219], v[140:143], v[170:173], v[216:219]
  ds_read_b64_tr_b16 v[128:129], v64 offset:25600
  v_mfma_f32_16x16x32_bf16 v[220:223], v[140:143], v[174:177], v[220:223]
  ds_read_b64_tr_b16 v[130:131], v65 offset:26624
  ds_read_b128 v[178:181], v72 offset:25600
  s_waitcnt lgkmcnt(9)
  v_mfma_f32_16x16x32_bf16 v[224:227], v[144:147], v[170:173], v[224:227]
  ds_read_b64_tr_b16 v[132:133], v65 offset:25600
  v_mfma_f32_16x16x32_bf16 v[228:231], v[144:147], v[174:177], v[228:231]
  ds_read_b64_tr_b16 v[134:135], v64 offset:26624
  ds_read_b128 v[182:185], v72 offset:26624
  s_waitcnt lgkmcnt(10)
  v_mfma_f32_16x16x32_bf16 v[232:235], v[148:151], v[170:173], v[232:235]
  ds_read_b64_tr_b16 v[136:137], v66 offset:25600
  v_mfma_f32_16x16x32_bf16 v[236:239], v[148:151], v[174:177], v[236:239]
  ds_read_b64_tr_b16 v[138:139], v67 offset:26624
  s_waitcnt lgkmcnt(10)
  v_mfma_f32_16x16x32_bf16 v[240:243], v[152:155], v[170:173], v[240:243]
  ds_read_b64_tr_b16 v[140:141], v67 offset:25600
  v_mfma_f32_16x16x32_bf16 v[244:247], v[152:155], v[174:177], v[244:247]
  ds_read_b64_tr_b16 v[142:143], v66 offset:26624
  s_waitcnt lgkmcnt(10)
  v_mfma_f32_16x16x32_bf16 v[248:251], v[156:159], v[170:173], v[248:251]
  ds_read_b64_tr_b16 v[144:145], v68 offset:25600
  v_mfma_f32_16x16x32_bf16 v[252:255], v[156:159], v[174:177], v[252:255]
  ds_read_b64_tr_b16 v[146:147], v69 offset:26624
  s_waitcnt lgkmcnt(6)
  v_mfma_f32_16x16x32_bf16 v[0:3], v[128:131], v[178:181], v[0:3]
  ds_read_b64_tr_b16 v[148:149], v69 offset:25600
  v_mfma_f32_16x16x32_bf16 v[4:7], v[128:131], v[182:185], v[4:7]
  ds_read_b64_tr_b16 v[150:151], v68 offset:26624
  s_add_u32 m0, s6, 34816
  v_mfma_f32_16x16x32_bf16 v[8:11], v[132:135], v[178:181], v[8:11]
  buffer_load_dwordx4 v74, s[32:35], s54 offen offset:0  lds
  ds_read_b64_tr_b16 v[152:153], v70 offset:25600
  v_mfma_f32_16x16x32_bf16 v[12:15], v[132:135], v[182:185], v[12:15]
  ds_read_b64_tr_b16 v[154:155], v71 offset:26624
  s_waitcnt lgkmcnt(8)
  v_mfma_f32_16x16x32_bf16 v[16:19], v[136:139], v[178:181], v[16:19]
  ds_read_b64_tr_b16 v[156:157], v71 offset:25600
  v_mfma_f32_16x16x32_bf16 v[20:23], v[136:139], v[182:185], v[20:23]
  ds_read_b64_tr_b16 v[158:159], v70 offset:26624
  s_add_u32 m0, s6, 35840
  s_waitcnt lgkmcnt(8)
  v_mfma_f32_16x16x32_bf16 v[24:27], v[140:143], v[178:181], v[24:27]
  buffer_load_dwordx4 v75, s[32:35], s54 offen offset:0  lds
  ds_read_b64_tr_b16 v[128:129], v64 offset:33792
  v_mfma_f32_16x16x32_bf16 v[28:31], v[140:143], v[182:185], v[28:31]
  ds_read_b64_tr_b16 v[130:131], v65 offset:34816
  s_waitcnt lgkmcnt(8)
  v_mfma_f32_16x16x32_bf16 v[32:35], v[144:147], v[178:181], v[32:35]
  ds_read_b64_tr_b16 v[132:133], v65 offset:33792
  v_mfma_f32_16x16x32_bf16 v[36:39], v[144:147], v[182:185], v[36:39]
  ds_read_b64_tr_b16 v[134:135], v64 offset:34816
  s_add_u32 m0, s6, 42752
  s_waitcnt lgkmcnt(8)
  v_mfma_f32_16x16x32_bf16 v[40:43], v[148:151], v[178:181], v[40:43]
  buffer_load_dwordx4 v74, s[32:35], s54 offen offset:256  lds
  ds_read_b64_tr_b16 v[136:137], v66 offset:33792
  v_mfma_f32_16x16x32_bf16 v[44:47], v[148:151], v[182:185], v[44:47]
  ds_read_b64_tr_b16 v[138:139], v67 offset:34816
  s_waitcnt lgkmcnt(8)
  v_mfma_f32_16x16x32_bf16 v[48:51], v[152:155], v[178:181], v[48:51]
  ds_read_b64_tr_b16 v[140:141], v67 offset:33792
  v_mfma_f32_16x16x32_bf16 v[52:55], v[152:155], v[182:185], v[52:55]
  ds_read_b64_tr_b16 v[142:143], v66 offset:34816
  s_add_u32 m0, s6, 43776
  s_waitcnt lgkmcnt(8)
  v_mfma_f32_16x16x32_bf16 v[56:59], v[156:159], v[178:181], v[56:59]
  buffer_load_dwordx4 v75, s[32:35], s54 offen offset:256  lds
  ds_read_b64_tr_b16 v[144:145], v68 offset:33792
  v_mfma_f32_16x16x32_bf16 v[60:63], v[156:159], v[182:185], v[60:63]
  ds_read_b64_tr_b16 v[146:147], v69 offset:34816
  s_waitcnt lgkmcnt(8)
  v_mfma_f32_16x16x32_bf16 v[192:195], v[128:131], v[178:181], v[192:195]
  s_add_u32 s54, s54, 262144
  s_cmp_eq_u32 s54, 4718592
  s_cselect_b32 s54, 0, s54
  ds_read_b64_tr_b16 v[148:149], v69 offset:33792
  v_mfma_f32_16x16x32_bf16 v[196:199], v[128:131], v[182:185], v[196:199]
  ds_read_b64_tr_b16 v[150:151], v68 offset:34816
  s_waitcnt lgkmcnt(8)
  v_mfma_f32_16x16x32_bf16 v[200:203], v[132:135], v[178:181], v[200:203]
  ds_read_b64_tr_b16 v[152:153], v70 offset:33792
  v_mfma_f32_16x16x32_bf16 v[204:207], v[132:135], v[182:185], v[204:207]
  ds_read_b64_tr_b16 v[154:155], v71 offset:34816
  s_waitcnt lgkmcnt(8)
  v_mfma_f32_16x16x32_bf16 v[208:211], v[136:139], v[178:181], v[208:211]
  s_waitcnt vmcnt(8)
  s_barrier
  ds_read_b64_tr_b16 v[156:157], v71 offset:33792
  v_mfma_f32_16x16x32_bf16 v[212:215], v[136:139], v[182:185], v[212:215]
  ds_read_b64_tr_b16 v[158:159], v70 offset:34816
  s_waitcnt lgkmcnt(8)
  v_mfma_f32_16x16x32_bf16 v[216:219], v[140:143], v[178:181], v[216:219]
  ds_read_b64_tr_b16 v[128:129], v64 offset:51200
  v_mfma_f32_16x16x32_bf16 v[220:223], v[140:143], v[182:185], v[220:223]
  ds_read_b64_tr_b16 v[130:131], v65 offset:52224
  ds_read_b128 v[170:173], v72 offset:51200
  s_waitcnt lgkmcnt(9)
  v_mfma_f32_16x16x32_bf16 v[224:227], v[144:147], v[178:181], v[224:227]
  ds_read_b64_tr_b16 v[132:133], v65 offset:51200
  v_mfma_f32_16x16x32_bf16 v[228:231], v[144:147], v[182:185], v[228:231]
  ds_read_b64_tr_b16 v[134:135], v64 offset:52224
  ds_read_b128 v[174:177], v72 offset:52224
  s_waitcnt lgkmcnt(10)
  v_mfma_f32_16x16x32_bf16 v[232:235], v[148:151], v[178:181], v[232:235]
  ds_read_b64_tr_b16 v[136:137], v66 offset:51200
  v_mfma_f32_16x16x32_bf16 v[236:239], v[148:151], v[182:185], v[236:239]
  ds_read_b64_tr_b16 v[138:139], v67 offset:52224
  s_waitcnt lgkmcnt(10)
  v_mfma_f32_16x16x32_bf16 v[240:243], v[152:155], v[178:181], v[240:243]
  ds_read_b64_tr_b16 v[140:141], v67 offset:51200
  v_mfma_f32_16x16x32_bf16 v[244:247], v[152:155], v[182:185], v[244:247]
  ds_read_b64_tr_b16 v[142:143], v66 offset:52224
  s_waitcnt lgkmcnt(10)
  v_mfma_f32_16x16x32_bf16 v[248:251], v[156:159], v[178:181], v[248:251]
  ds_read_b64_tr_b16 v[144:145], v68 offset:51200
  v_mfma_f32_16x16x32_bf16 v[252:255], v[156:159], v[182:185], v[252:255]
  ds_read_b64_tr_b16 v[146:147], v69 offset:52224
  s_waitcnt lgkmcnt(6)
  v_mfma_f32_16x16x32_bf16 v[0:3], v[128:131], v[170:173], v[0:3]
  ds_read_b64_tr_b16 v[148:149], v69 offset:51200
  v_mfma_f32_16x16x32_bf16 v[4:7], v[128:131], v[174:177], v[4:7]
  ds_read_b64_tr_b16 v[150:151], v68 offset:52224
  s_add_u32 m0, s6, 60416
  v_mfma_f32_16x16x32_bf16 v[8:11], v[132:135], v[170:173], v[8:11]
  buffer_load_dwordx4 v74, s[32:35], s54 offen offset:0  lds
  ds_read_b64_tr_b16 v[152:153], v70 offset:51200
  v_mfma_f32_16x16x32_bf16 v[12:15], v[132:135], v[174:177], v[12:15]
  ds_read_b64_tr_b16 v[154:155], v71 offset:52224
  s_waitcnt lgkmcnt(8)
  v_mfma_f32_16x16x32_bf16 v[16:19], v[136:139], v[170:173], v[16:19]
  ds_read_b64_tr_b16 v[156:157], v71 offset:51200
  v_mfma_f32_16x16x32_bf16 v[20:23], v[136:139], v[174:177], v[20:23]
  ds_read_b64_tr_b16 v[158:159], v70 offset:52224
  s_add_u32 m0, s6, 61440
  s_waitcnt lgkmcnt(8)
  v_mfma_f32_16x16x32_bf16 v[24:27], v[140:143], v[170:173], v[24:27]
  buffer_load_dwordx4 v75, s[32:35], s54 offen offset:0  lds
  ds_read_b64_tr_b16 v[128:129], v64 offset:59392
  v_mfma_f32_16x16x32_bf16 v[28:31], v[140:143], v[174:177], v[28:31]
  ds_read_b64_tr_b16 v[130:131], v65 offset:60416
  s_waitcnt lgkmcnt(8)
  v_mfma_f32_16x16x32_bf16 v[32:35], v[144:147], v[170:173], v[32:35]
  ds_read_b64_tr_b16 v[132:133], v65 offset:59392
  v_mfma_f32_16x16x32_bf16 v[36:39], v[144:147], v[174:177], v[36:39]
  ds_read_b64_tr_b16 v[134:135], v64 offset:60416
  s_add_u32 m0, s6, 68352
  s_waitcnt lgkmcnt(8)
  v_mfma_f32_16x16x32_bf16 v[40:43], v[148:151], v[170:173], v[40:43]
  buffer_load_dwordx4 v74, s[32:35], s54 offen offset:256  lds
  ds_read_b64_tr_b16 v[136:137], v66 offset:59392
  v_mfma_f32_16x16x32_bf16 v[44:47], v[148:151], v[174:177], v[44:47]
  ds_read_b64_tr_b16 v[138:139], v67 offset:60416
  s_waitcnt lgkmcnt(8)
  v_mfma_f32_16x16x32_bf16 v[48:51], v[152:155], v[170:173], v[48:51]
  ds_read_b64_tr_b16 v[140:141], v67 offset:59392
  v_mfma_f32_16x16x32_bf16 v[52:55], v[152:155], v[174:177], v[52:55]
  ds_read_b64_tr_b16 v[142:143], v66 offset:60416
  s_add_u32 m0, s6, 69376
  s_waitcnt lgkmcnt(8)
  v_mfma_f32_16x16x32_bf16 v[56:59], v[156:159], v[170:173], v[56:59]
  buffer_load_dwordx4 v75, s[32:35], s54 offen offset:256  lds
  ds_read_b64_tr_b16 v[144:145], v68 offset:59392
  v_mfma_f32_16x16x32_bf16 v[60:63], v[156:159], v[174:177], v[60:63]
  ds_read_b64_tr_b16 v[146:147], v69 offset:60416
  s_waitcnt lgkmcnt(8)
  v_mfma_f32_16x16x32_bf16 v[192:195], v[128:131], v[170:173], v[192:195]
  s_add_u32 s54, s54, 262144
  s_cmp_eq_u32 s54, 4718592
  s_cselect_b32 s54, 0, s54
  ds_read_b64_tr_b16 v[148:149], v69 offset:59392
  v_mfma_f32_16x16x32_bf16 v[196:199], v[128:131], v[174:177], v[196:199]
  ds_read_b64_tr_b16 v[150:151], v68 offset:60416
  s_waitcnt lgkmcnt(8)
  v_mfma_f32_16x16x32_bf16 v[200:203], v[132:135], v[170:173], v[200:203]
  ds_read_b64_tr_b16 v[152:153], v70 offset:59392
  v_mfma_f32_16x16x32_bf16 v[204:207], v[132:135], v[174:177], v[204:207]
  ds_read_b64_tr_b16 v[154:155], v71 offset:60416
  s_waitcnt lgkmcnt(8)
  v_mfma_f32_16x16x32_bf16 v[208:211], v[136:139], v[170:173], v[208:211]
  s_waitcnt vmcnt(8)
  s_barrier
  ds_read_b64_tr_b16 v[156:157], v71 offset:59392
  v_mfma_f32_16x16x32_bf16 v[212:215], v[136:139], v[174:177], v[212:215]
  ds_read_b64_tr_b16 v[158:159], v70 offset:60416
  s_waitcnt lgkmcnt(8)
  v_mfma_f32_16x16x32_bf16 v[216:219], v[140:143], v[170:173], v[216:219]
  ds_read_b64_tr_b16 v[128:129], v160 offset:0
  v_mfma_f32_16x16x32_bf16 v[220:223], v[140:143], v[174:177], v[220:223]
  ds_read_b64_tr_b16 v[130:131], v161 offset:1024
  ds_read_b128 v[178:181], v168 offset:0
  s_waitcnt lgkmcnt(9)
  v_mfma_f32_16x16x32_bf16 v[224:227], v[144:147], v[170:173], v[224:227]
  ds_read_b64_tr_b16 v[132:133], v161 offset:0
  v_mfma_f32_16x16x32_bf16 v[228:231], v[144:147], v[174:177], v[228:231]
  ds_read_b64_tr_b16 v[134:135], v160 offset:1024
  ds_read_b128 v[182:185], v168 offset:1024
  s_waitcnt lgkmcnt(10)
  v_mfma_f32_16x16x32_bf16 v[232:235], v[148:151], v[170:173], v[232:235]
  ds_read_b64_tr_b16 v[136:137], v162 offset:0
  v_mfma_f32_16x16x32_bf16 v[236:239], v[148:151], v[174:177], v[236:239]
  ds_read_b64_tr_b16 v[138:139], v163 offset:1024
  s_waitcnt lgkmcnt(10)
  v_mfma_f32_16x16x32_bf16 v[240:243], v[152:155], v[170:173], v[240:243]
  ds_read_b64_tr_b16 v[140:141], v163 offset:0
  v_mfma_f32_16x16x32_bf16 v[244:247], v[152:155], v[174:177], v[244:247]
  ds_read_b64_tr_b16 v[142:143], v162 offset:1024
  s_waitcnt lgkmcnt(10)
  v_mfma_f32_16x16x32_bf16 v[248:251], v[156:159], v[170:173], v[248:251]
  ds_read_b64_tr_b16 v[144:145], v164 offset:0
  v_mfma_f32_16x16x32_bf16 v[252:255], v[156:159], v[174:177], v[252:255]
  ds_read_b64_tr_b16 v[146:147], v165 offset:1024
  s_waitcnt lgkmcnt(6)
  v_mfma_f32_16x16x32_bf16 v[0:3], v[128:131], v[178:181], v[0:3]
  ds_read_b64_tr_b16 v[148:149], v165 offset:0
  v_mfma_f32_16x16x32_bf16 v[4:7], v[128:131], v[182:185], v[4:7]
  ds_read_b64_tr_b16 v[150:151], v164 offset:1024
  s_add_u32 m0, s6, 86016
  v_mfma_f32_16x16x32_bf16 v[8:11], v[132:135], v[178:181], v[8:11]
  buffer_load_dwordx4 v74, s[32:35], s54 offen offset:0  lds
  ds_read_b64_tr_b16 v[152:153], v166 offset:0
  v_mfma_f32_16x16x32_bf16 v[12:15], v[132:135], v[182:185], v[12:15]
  ds_read_b64_tr_b16 v[154:155], v167 offset:1024
  s_waitcnt lgkmcnt(8)
  v_mfma_f32_16x16x32_bf16 v[16:19], v[136:139], v[178:181], v[16:19]
  ds_read_b64_tr_b16 v[156:157], v167 offset:0
  v_mfma_f32_16x16x32_bf16 v[20:23], v[136:139], v[182:185], v[20:23]
  ds_read_b64_tr_b16 v[158:159], v166 offset:1024
  s_add_u32 m0, s6, 87040
  s_waitcnt lgkmcnt(8)
  v_mfma_f32_16x16x32_bf16 v[24:27], v[140:143], v[178:181], v[24:27]
  buffer_load_dwordx4 v75, s[32:35], s54 offen offset:0  lds
  ds_read_b64_tr_b16 v[128:129], v160 offset:8192
  v_mfma_f32_16x16x32_bf16 v[28:31], v[140:143], v[182:185], v[28:31]
  ds_read_b64_tr_b16 v[130:131], v161 offset:9216
  s_waitcnt lgkmcnt(8)
  v_mfma_f32_16x16x32_bf16 v[32:35], v[144:147], v[178:181], v[32:35]
  ds_read_b64_tr_b16 v[132:133], v161 offset:8192
  v_mfma_f32_16x16x32_bf16 v[36:39], v[144:147], v[182:185], v[36:39]
  ds_read_b64_tr_b16 v[134:135], v160 offset:9216
  s_add_u32 m0, s6, 93952
  s_waitcnt lgkmcnt(8)
  v_mfma_f32_16x16x32_bf16 v[40:43], v[148:151], v[178:181], v[40:43]
  buffer_load_dwordx4 v74, s[32:35], s54 offen offset:256  lds
  ds_read_b64_tr_b16 v[136:137], v162 offset:8192
  v_mfma_f32_16x16x32_bf16 v[44:47], v[148:151], v[182:185], v[44:47]
  ds_read_b64_tr_b16 v[138:139], v163 offset:9216
  s_waitcnt lgkmcnt(8)
  v_mfma_f32_16x16x32_bf16 v[48:51], v[152:155], v[178:181], v[48:51]
  ds_read_b64_tr_b16 v[140:141], v163 offset:8192
  v_mfma_f32_16x16x32_bf16 v[52:55], v[152:155], v[182:185], v[52:55]
  ds_read_b64_tr_b16 v[142:143], v162 offset:9216
  s_add_u32 m0, s6, 94976
  s_waitcnt lgkmcnt(8)
  v_mfma_f32_16x16x32_bf16 v[56:59], v[156:159], v[178:181], v[56:59]
  buffer_load_dwordx4 v75, s[32:35], s54 offen offset:256  lds
  ds_read_b64_tr_b16 v[144:145], v164 offset:8192
  v_mfma_f32_16x16x32_bf16 v[60:63], v[156:159], v[182:185], v[60:63]
  ds_read_b64_tr_b16 v[146:147], v165 offset:9216
  s_waitcnt lgkmcnt(8)
  v_mfma_f32_16x16x32_bf16 v[192:195], v[128:131], v[178:181], v[192:195]
  s_add_u32 s54, s54, 262144
  s_cmp_eq_u32 s54, 4718592
  s_cselect_b32 s54, 0, s54
  ds_read_b64_tr_b16 v[148:149], v165 offset:8192
  v_mfma_f32_16x16x32_bf16 v[196:199], v[128:131], v[182:185], v[196:199]
  ds_read_b64_tr_b16 v[150:151], v164 offset:9216
  s_waitcnt lgkmcnt(8)
  v_mfma_f32_16x16x32_bf16 v[200:203], v[132:135], v[178:181], v[200:203]
  ds_read_b64_tr_b16 v[152:153], v166 offset:8192
  v_mfma_f32_16x16x32_bf16 v[204:207], v[132:135], v[182:185], v[204:207]
  ds_read_b64_tr_b16 v[154:155], v167 offset:9216
  s_waitcnt lgkmcnt(8)
  v_mfma_f32_16x16x32_bf16 v[208:211], v[136:139], v[178:181], v[208:211]
  s_waitcnt vmcnt(8)
  s_barrier
  ds_read_b64_tr_b16 v[156:157], v167 offset:8192
  v_mfma_f32_16x16x32_bf16 v[212:215], v[136:139], v[182:185], v[212:215]
  ds_read_b64_tr_b16 v[158:159], v166 offset:9216
  s_waitcnt lgkmcnt(8)
  v_mfma_f32_16x16x32_bf16 v[216:219], v[140:143], v[178:181], v[216:219]
  ds_read_b64_tr_b16 v[128:129], v160 offset:25600
  v_mfma_f32_16x16x32_bf16 v[220:223], v[140:143], v[182:185], v[220:223]
  ds_read_b64_tr_b16 v[130:131], v161 offset:26624
  ds_read_b128 v[170:173], v168 offset:25600
  s_waitcnt lgkmcnt(9)
  v_mfma_f32_16x16x32_bf16 v[224:227], v[144:147], v[178:181], v[224:227]
  ds_read_b64_tr_b16 v[132:133], v161 offset:25600
  v_mfma_f32_16x16x32_bf16 v[228:231], v[144:147], v[182:185], v[228:231]
  ds_read_b64_tr_b16 v[134:135], v160 offset:26624
  ds_read_b128 v[174:177], v168 offset:26624
  s_waitcnt lgkmcnt(10)
  v_mfma_f32_16x16x32_bf16 v[232:235], v[148:151], v[178:181], v[232:235]
  ds_read_b64_tr_b16 v[136:137], v162 offset:25600
  v_mfma_f32_16x16x32_bf16 v[236:239], v[148:151], v[182:185], v[236:239]
  ds_read_b64_tr_b16 v[138:139], v163 offset:26624
  s_waitcnt lgkmcnt(10)
  v_mfma_f32_16x16x32_bf16 v[240:243], v[152:155], v[178:181], v[240:243]
  ds_read_b64_tr_b16 v[140:141], v163 offset:25600
  v_mfma_f32_16x16x32_bf16 v[244:247], v[152:155], v[182:185], v[244:247]
  ds_read_b64_tr_b16 v[142:143], v162 offset:26624
  s_waitcnt lgkmcnt(10)
  v_mfma_f32_16x16x32_bf16 v[248:251], v[156:159], v[178:181], v[248:251]
  ds_read_b64_tr_b16 v[144:145], v164 offset:25600
  v_mfma_f32_16x16x32_bf16 v[252:255], v[156:159], v[182:185], v[252:255]
  ds_read_b64_tr_b16 v[146:147], v165 offset:26624
  s_waitcnt lgkmcnt(6)
  v_mfma_f32_16x16x32_bf16 v[0:3], v[128:131], v[170:173], v[0:3]
  ds_read_b64_tr_b16 v[148:149], v165 offset:25600
  v_mfma_f32_16x16x32_bf16 v[4:7], v[128:131], v[174:177], v[4:7]
  ds_read_b64_tr_b16 v[150:151], v164 offset:26624
  s_add_u32 m0, s6, 111616
  v_mfma_f32_16x16x32_bf16 v[8:11], v[132:135], v[170:173], v[8:11]
  buffer_load_dwordx4 v74, s[32:35], s54 offen offset:0  lds
  ds_read_b64_tr_b16 v[152:153], v166 offset:25600
  v_mfma_f32_16x16x32_bf16 v[12:15], v[132:135], v[174:177], v[12:15]
  ds_read_b64_tr_b16 v[154:155], v167 offset:26624
  s_waitcnt lgkmcnt(8)
  v_mfma_f32_16x16x32_bf16 v[16:19], v[136:139], v[170:173], v[16:19]
  ds_read_b64_tr_b16 v[156:157], v167 offset:25600
  v_mfma_f32_16x16x32_bf16 v[20:23], v[136:139], v[174:177], v[20:23]
  ds_read_b64_tr_b16 v[158:159], v166 offset:26624
  s_add_u32 m0, s6, 112640
  s_waitcnt lgkmcnt(8)
  v_mfma_f32_16x16x32_bf16 v[24:27], v[140:143], v[170:173], v[24:27]
  buffer_load_dwordx4 v75, s[32:35], s54 offen offset:0  lds
  ds_read_b64_tr_b16 v[128:129], v160 offset:33792
  v_mfma_f32_16x16x32_bf16 v[28:31], v[140:143], v[174:177], v[28:31]
  ds_read_b64_tr_b16 v[130:131], v161 offset:34816
  s_waitcnt lgkmcnt(8)
  v_mfma_f32_16x16x32_bf16 v[32:35], v[144:147], v[170:173], v[32:35]
  ds_read_b64_tr_b16 v[132:133], v161 offset:33792
  v_mfma_f32_16x16x32_bf16 v[36:39], v[144:147], v[174:177], v[36:39]
  ds_read_b64_tr_b16 v[134:135], v160 offset:34816
  s_add_u32 m0, s6, 119552
  s_waitcnt lgkmcnt(8)
  v_mfma_f32_16x16x32_bf16 v[40:43], v[148:151], v[170:173], v[40:43]
  buffer_load_dwordx4 v74, s[32:35], s54 offen offset:256  lds
  ds_read_b64_tr_b16 v[136:137], v162 offset:33792
  v_mfma_f32_16x16x32_bf16 v[44:47], v[148:151], v[174:177], v[44:47]
  ds_read_b64_tr_b16 v[138:139], v163 offset:34816
  s_waitcnt lgkmcnt(8)
  v_mfma_f32_16x16x32_bf16 v[48:51], v[152:155], v[170:173], v[48:51]
  ds_read_b64_tr_b16 v[140:141], v163 offset:33792
  v_mfma_f32_16x16x32_bf16 v[52:55], v[152:155], v[174:177], v[52:55]
  ds_read_b64_tr_b16 v[142:143], v162 offset:34816
  s_add_u32 m0, s6, 120576
  s_waitcnt lgkmcnt(8)
  v_mfma_f32_16x16x32_bf16 v[56:59], v[156:159], v[170:173], v[56:59]
  buffer_load_dwordx4 v75, s[32:35], s54 offen offset:256  lds
  ds_read_b64_tr_b16 v[144:145], v164 offset:33792
  v_mfma_f32_16x16x32_bf16 v[60:63], v[156:159], v[174:177], v[60:63]
  ds_read_b64_tr_b16 v[146:147], v165 offset:34816
  s_waitcnt lgkmcnt(8)
  v_mfma_f32_16x16x32_bf16 v[192:195], v[128:131], v[170:173], v[192:195]
  s_add_u32 s54, s54, 262144
  s_cmp_eq_u32 s54, 4718592
  s_cselect_b32 s54, 0, s54
  ds_read_b64_tr_b16 v[148:149], v165 offset:33792
  v_mfma_f32_16x16x32_bf16 v[196:199], v[128:131], v[174:177], v[196:199]
  ds_read_b64_tr_b16 v[150:151], v164 offset:34816
  s_waitcnt lgkmcnt(8)
  v_mfma_f32_16x16x32_bf16 v[200:203], v[132:135], v[170:173], v[200:203]
  ds_read_b64_tr_b16 v[152:153], v166 offset:33792
  v_mfma_f32_16x16x32_bf16 v[204:207], v[132:135], v[174:177], v[204:207]
  ds_read_b64_tr_b16 v[154:155], v167 offset:34816
  s_waitcnt lgkmcnt(8)
  v_mfma_f32_16x16x32_bf16 v[208:211], v[136:139], v[170:173], v[208:211]
  s_waitcnt vmcnt(8)
  s_barrier
  ds_read_b64_tr_b16 v[156:157], v167 offset:33792
  v_mfma_f32_16x16x32_bf16 v[212:215], v[136:139], v[174:177], v[212:215]
  ds_read_b64_tr_b16 v[158:159], v166 offset:34816
  s_waitcnt lgkmcnt(8)
  v_mfma_f32_16x16x32_bf16 v[216:219], v[140:143], v[170:173], v[216:219]
  ds_read_b64_tr_b16 v[128:129], v64 offset:0
  v_mfma_f32_16x16x32_bf16 v[220:223], v[140:143], v[174:177], v[220:223]
  ds_read_b64_tr_b16 v[130:131], v65 offset:1024
  ds_read_b128 v[178:181], v72 offset:0
  s_waitcnt lgkmcnt(9)
  v_mfma_f32_16x16x32_bf16 v[224:227], v[144:147], v[170:173], v[224:227]
  ds_read_b64_tr_b16 v[132:133], v65 offset:0
  v_mfma_f32_16x16x32_bf16 v[228:231], v[144:147], v[174:177], v[228:231]
  ds_read_b64_tr_b16 v[134:135], v64 offset:1024
  ds_read_b128 v[182:185], v72 offset:1024
  s_waitcnt lgkmcnt(10)
  v_mfma_f32_16x16x32_bf16 v[232:235], v[148:151], v[170:173], v[232:235]
  ds_read_b64_tr_b16 v[136:137], v66 offset:0
  v_mfma_f32_16x16x32_bf16 v[236:239], v[148:151], v[174:177], v[236:239]
  ds_read_b64_tr_b16 v[138:139], v67 offset:1024
  s_waitcnt lgkmcnt(10)
  v_mfma_f32_16x16x32_bf16 v[240:243], v[152:155], v[170:173], v[240:243]
  ds_read_b64_tr_b16 v[140:141], v67 offset:0
  v_mfma_f32_16x16x32_bf16 v[244:247], v[152:155], v[174:177], v[244:247]
  ds_read_b64_tr_b16 v[142:143], v66 offset:1024
  s_waitcnt lgkmcnt(10)
  v_mfma_f32_16x16x32_bf16 v[248:251], v[156:159], v[170:173], v[248:251]
  ds_read_b64_tr_b16 v[144:145], v68 offset:0
  v_mfma_f32_16x16x32_bf16 v[252:255], v[156:159], v[174:177], v[252:255]
  ds_read_b64_tr_b16 v[146:147], v69 offset:1024
  s_waitcnt lgkmcnt(6)
  v_mfma_f32_16x16x32_bf16 v[0:3], v[128:131], v[178:181], v[0:3]
  ds_read_b64_tr_b16 v[148:149], v69 offset:0
  v_mfma_f32_16x16x32_bf16 v[4:7], v[128:131], v[182:185], v[4:7]
  ds_read_b64_tr_b16 v[150:151], v68 offset:1024
  v_mfma_f32_16x16x32_bf16 v[8:11], v[132:135], v[178:181], v[8:11]
  ds_read_b64_tr_b16 v[152:153], v70 offset:0
  v_mfma_f32_16x16x32_bf16 v[12:15], v[132:135], v[182:185], v[12:15]
  ds_read_b64_tr_b16 v[154:155], v71 offset:1024
  s_waitcnt lgkmcnt(8)
  v_mfma_f32_16x16x32_bf16 v[16:19], v[136:139], v[178:181], v[16:19]
  ds_read_b64_tr_b16 v[156:157], v71 offset:0
  v_mfma_f32_16x16x32_bf16 v[20:23], v[136:139], v[182:185], v[20:23]
  ds_read_b64_tr_b16 v[158:159], v70 offset:1024
  s_waitcnt lgkmcnt(8)
  v_mfma_f32_16x16x32_bf16 v[24:27], v[140:143], v[178:181], v[24:27]
  ds_read_b64_tr_b16 v[128:129], v64 offset:8192
  v_mfma_f32_16x16x32_bf16 v[28:31], v[140:143], v[182:185], v[28:31]
  ds_read_b64_tr_b16 v[130:131], v65 offset:9216
  s_waitcnt lgkmcnt(8)
  v_mfma_f32_16x16x32_bf16 v[32:35], v[144:147], v[178:181], v[32:35]
  ds_read_b64_tr_b16 v[132:133], v65 offset:8192
  v_mfma_f32_16x16x32_bf16 v[36:39], v[144:147], v[182:185], v[36:39]
  ds_read_b64_tr_b16 v[134:135], v64 offset:9216
  s_waitcnt lgkmcnt(8)
  v_mfma_f32_16x16x32_bf16 v[40:43], v[148:151], v[178:181], v[40:43]
  ds_read_b64_tr_b16 v[136:137], v66 offset:8192
  v_mfma_f32_16x16x32_bf16 v[44:47], v[148:151], v[182:185], v[44:47]
  ds_read_b64_tr_b16 v[138:139], v67 offset:9216
  s_waitcnt lgkmcnt(8)
  v_mfma_f32_16x16x32_bf16 v[48:51], v[152:155], v[178:181], v[48:51]
  ds_read_b64_tr_b16 v[140:141], v67 offset:8192
  v_mfma_f32_16x16x32_bf16 v[52:55], v[152:155], v[182:185], v[52:55]
  ds_read_b64_tr_b16 v[142:143], v66 offset:9216
  s_waitcnt lgkmcnt(8)
  v_mfma_f32_16x16x32_bf16 v[56:59], v[156:159], v[178:181], v[56:59]
  ds_read_b64_tr_b16 v[144:145], v68 offset:8192
  v_mfma_f32_16x16x32_bf16 v[60:63], v[156:159], v[182:185], v[60:63]
  ds_read_b64_tr_b16 v[146:147], v69 offset:9216
  s_waitcnt lgkmcnt(8)
  v_mfma_f32_16x16x32_bf16 v[192:195], v[128:131], v[178:181], v[192:195]
  ds_read_b64_tr_b16 v[148:149], v69 offset:8192
  v_mfma_f32_16x16x32_bf16 v[196:199], v[128:131], v[182:185], v[196:199]
  ds_read_b64_tr_b16 v[150:151], v68 offset:9216
  s_waitcnt lgkmcnt(8)
  v_mfma_f32_16x16x32_bf16 v[200:203], v[132:135], v[178:181], v[200:203]
  ds_read_b64_tr_b16 v[152:153], v70 offset:8192
  v_mfma_f32_16x16x32_bf16 v[204:207], v[132:135], v[182:185], v[204:207]
  ds_read_b64_tr_b16 v[154:155], v71 offset:9216
  s_waitcnt lgkmcnt(8)
  v_mfma_f32_16x16x32_bf16 v[208:211], v[136:139], v[178:181], v[208:211]
  s_waitcnt vmcnt(4)
  s_barrier
  ds_read_b64_tr_b16 v[156:157], v71 offset:8192
  v_mfma_f32_16x16x32_bf16 v[212:215], v[136:139], v[182:185], v[212:215]
  ds_read_b64_tr_b16 v[158:159], v70 offset:9216
  s_waitcnt lgkmcnt(8)
  v_mfma_f32_16x16x32_bf16 v[216:219], v[140:143], v[178:181], v[216:219]
  ds_read_b64_tr_b16 v[128:129], v64 offset:25600
  v_mfma_f32_16x16x32_bf16 v[220:223], v[140:143], v[182:185], v[220:223]
  ds_read_b64_tr_b16 v[130:131], v65 offset:26624
  ds_read_b128 v[170:173], v72 offset:25600
  s_waitcnt lgkmcnt(9)
  v_mfma_f32_16x16x32_bf16 v[224:227], v[144:147], v[178:181], v[224:227]
  ds_read_b64_tr_b16 v[132:133], v65 offset:25600
  v_mfma_f32_16x16x32_bf16 v[228:231], v[144:147], v[182:185], v[228:231]
  ds_read_b64_tr_b16 v[134:135], v64 offset:26624
  ds_read_b128 v[174:177], v72 offset:26624
  s_waitcnt lgkmcnt(10)
  v_mfma_f32_16x16x32_bf16 v[232:235], v[148:151], v[178:181], v[232:235]
  ds_read_b64_tr_b16 v[136:137], v66 offset:25600
  v_mfma_f32_16x16x32_bf16 v[236:239], v[148:151], v[182:185], v[236:239]
  ds_read_b64_tr_b16 v[138:139], v67 offset:26624
  s_waitcnt lgkmcnt(10)
  v_mfma_f32_16x16x32_bf16 v[240:243], v[152:155], v[178:181], v[240:243]
  ds_read_b64_tr_b16 v[140:141], v67 offset:25600
  v_mfma_f32_16x16x32_bf16 v[244:247], v[152:155], v[182:185], v[244:247]
  ds_read_b64_tr_b16 v[142:143], v66 offset:26624
  s_waitcnt lgkmcnt(10)
  v_mfma_f32_16x16x32_bf16 v[248:251], v[156:159], v[178:181], v[248:251]
  ds_read_b64_tr_b16 v[144:145], v68 offset:25600
  v_mfma_f32_16x16x32_bf16 v[252:255], v[156:159], v[182:185], v[252:255]
  ds_read_b64_tr_b16 v[146:147], v69 offset:26624
  s_waitcnt lgkmcnt(6)
  v_mfma_f32_16x16x32_bf16 v[0:3], v[128:131], v[170:173], v[0:3]
  ds_read_b64_tr_b16 v[148:149], v69 offset:25600
  v_mfma_f32_16x16x32_bf16 v[4:7], v[128:131], v[174:177], v[4:7]
  ds_read_b64_tr_b16 v[150:151], v68 offset:26624
  v_mfma_f32_16x16x32_bf16 v[8:11], v[132:135], v[170:173], v[8:11]
  ds_read_b64_tr_b16 v[152:153], v70 offset:25600
  v_mfma_f32_16x16x32_bf16 v[12:15], v[132:135], v[174:177], v[12:15]
  ds_read_b64_tr_b16 v[154:155], v71 offset:26624
  s_waitcnt lgkmcnt(8)
  v_mfma_f32_16x16x32_bf16 v[16:19], v[136:139], v[170:173], v[16:19]
  ds_read_b64_tr_b16 v[156:157], v71 offset:25600
  v_mfma_f32_16x16x32_bf16 v[20:23], v[136:139], v[174:177], v[20:23]
  ds_read_b64_tr_b16 v[158:159], v70 offset:26624
  s_waitcnt lgkmcnt(8)
  v_mfma_f32_16x16x32_bf16 v[24:27], v[140:143], v[170:173], v[24:27]
  ds_read_b64_tr_b16 v[128:129], v64 offset:33792
  v_mfma_f32_16x16x32_bf16 v[28:31], v[140:143], v[174:177], v[28:31]
  ds_read_b64_tr_b16 v[130:131], v65 offset:34816
  s_waitcnt lgkmcnt(8)
  v_mfma_f32_16x16x32_bf16 v[32:35], v[144:147], v[170:173], v[32:35]
  ds_read_b64_tr_b16 v[132:133], v65 offset:33792
  v_mfma_f32_16x16x32_bf16 v[36:39], v[144:147], v[174:177], v[36:39]
  ds_read_b64_tr_b16 v[134:135], v64 offset:34816
  s_waitcnt lgkmcnt(8)
  v_mfma_f32_16x16x32_bf16 v[40:43], v[148:151], v[170:173], v[40:43]
  ds_read_b64_tr_b16 v[136:137], v66 offset:33792
  v_mfma_f32_16x16x32_bf16 v[44:47], v[148:151], v[174:177], v[44:47]
  ds_read_b64_tr_b16 v[138:139], v67 offset:34816
  s_waitcnt lgkmcnt(8)
  v_mfma_f32_16x16x32_bf16 v[48:51], v[152:155], v[170:173], v[48:51]
  ds_read_b64_tr_b16 v[140:141], v67 offset:33792
  v_mfma_f32_16x16x32_bf16 v[52:55], v[152:155], v[174:177], v[52:55]
  ds_read_b64_tr_b16 v[142:143], v66 offset:34816
  s_waitcnt lgkmcnt(8)
  v_mfma_f32_16x16x32_bf16 v[56:59], v[156:159], v[170:173], v[56:59]
  ds_read_b64_tr_b16 v[144:145], v68 offset:33792
  v_mfma_f32_16x16x32_bf16 v[60:63], v[156:159], v[174:177], v[60:63]
  ds_read_b64_tr_b16 v[146:147], v69 offset:34816
  s_waitcnt lgkmcnt(8)
  v_mfma_f32_16x16x32_bf16 v[192:195], v[128:131], v[170:173], v[192:195]
  ds_read_b64_tr_b16 v[148:149], v69 offset:33792
  v_mfma_f32_16x16x32_bf16 v[196:199], v[128:131], v[174:177], v[196:199]
  ds_read_b64_tr_b16 v[150:151], v68 offset:34816
  s_waitcnt lgkmcnt(8)
  v_mfma_f32_16x16x32_bf16 v[200:203], v[132:135], v[170:173], v[200:203]
  ds_read_b64_tr_b16 v[152:153], v70 offset:33792
  v_mfma_f32_16x16x32_bf16 v[204:207], v[132:135], v[174:177], v[204:207]
  ds_read_b64_tr_b16 v[154:155], v71 offset:34816
  s_waitcnt lgkmcnt(8)
  v_mfma_f32_16x16x32_bf16 v[208:211], v[136:139], v[170:173], v[208:211]
  s_waitcnt vmcnt(0)
  s_barrier
  ds_read_b64_tr_b16 v[156:157], v71 offset:33792
  v_mfma_f32_16x16x32_bf16 v[212:215], v[136:139], v[174:177], v[212:215]
  ds_read_b64_tr_b16 v[158:159], v70 offset:34816
  s_waitcnt lgkmcnt(8)
  v_mfma_f32_16x16x32_bf16 v[216:219], v[140:143], v[170:173], v[216:219]
  ds_read_b64_tr_b16 v[128:129], v64 offset:51200
  v_mfma_f32_16x16x32_bf16 v[220:223], v[140:143], v[174:177], v[220:223]
  ds_read_b64_tr_b16 v[130:131], v65 offset:52224
  ds_read_b128 v[178:181], v72 offset:51200
  s_waitcnt lgkmcnt(9)
  v_mfma_f32_16x16x32_bf16 v[224:227], v[144:147], v[170:173], v[224:227]
  ds_read_b64_tr_b16 v[132:133], v65 offset:51200
  v_mfma_f32_16x16x32_bf16 v[228:231], v[144:147], v[174:177], v[228:231]
  ds_read_b64_tr_b16 v[134:135], v64 offset:52224
  ds_read_b128 v[182:185], v72 offset:52224
  s_waitcnt lgkmcnt(10)
  v_mfma_f32_16x16x32_bf16 v[232:235], v[148:151], v[170:173], v[232:235]
  ds_read_b64_tr_b16 v[136:137], v66 offset:51200
  v_mfma_f32_16x16x32_bf16 v[236:239], v[148:151], v[174:177], v[236:239]
  ds_read_b64_tr_b16 v[138:139], v67 offset:52224
  s_waitcnt lgkmcnt(10)
  v_mfma_f32_16x16x32_bf16 v[240:243], v[152:155], v[170:173], v[240:243]
  ds_read_b64_tr_b16 v[140:141], v67 offset:51200
  v_mfma_f32_16x16x32_bf16 v[244:247], v[152:155], v[174:177], v[244:247]
  ds_read_b64_tr_b16 v[142:143], v66 offset:52224
  s_waitcnt lgkmcnt(10)
  v_mfma_f32_16x16x32_bf16 v[248:251], v[156:159], v[170:173], v[248:251]
  ds_read_b64_tr_b16 v[144:145], v68 offset:51200
  v_mfma_f32_16x16x32_bf16 v[252:255], v[156:159], v[174:177], v[252:255]
  ds_read_b64_tr_b16 v[146:147], v69 offset:52224
  s_waitcnt lgkmcnt(6)
  v_mfma_f32_16x16x32_bf16 v[0:3], v[128:131], v[178:181], v[0:3]
  ds_read_b64_tr_b16 v[148:149], v69 offset:51200
  v_mfma_f32_16x16x32_bf16 v[4:7], v[128:131], v[182:185], v[4:7]
  ds_read_b64_tr_b16 v[150:151], v68 offset:52224
  v_mfma_f32_16x16x32_bf16 v[8:11], v[132:135], v[178:181], v[8:11]
  ds_read_b64_tr_b16 v[152:153], v70 offset:51200
  v_mfma_f32_16x16x32_bf16 v[12:15], v[132:135], v[182:185], v[12:15]
  ds_read_b64_tr_b16 v[154:155], v71 offset:52224
  s_waitcnt lgkmcnt(8)
  v_mfma_f32_16x16x32_bf16 v[16:19], v[136:139], v[178:181], v[16:19]
  ds_read_b64_tr_b16 v[156:157], v71 offset:51200
  v_mfma_f32_16x16x32_bf16 v[20:23], v[136:139], v[182:185], v[20:23]
  ds_read_b64_tr_b16 v[158:159], v70 offset:52224
  s_waitcnt lgkmcnt(8)
  v_mfma_f32_16x16x32_bf16 v[24:27], v[140:143], v[178:181], v[24:27]
  ds_read_b64_tr_b16 v[128:129], v64 offset:59392
  v_mfma_f32_16x16x32_bf16 v[28:31], v[140:143], v[182:185], v[28:31]
  ds_read_b64_tr_b16 v[130:131], v65 offset:60416
  s_waitcnt lgkmcnt(8)
  v_mfma_f32_16x16x32_bf16 v[32:35], v[144:147], v[178:181], v[32:35]
  ds_read_b64_tr_b16 v[132:133], v65 offset:59392
  v_mfma_f32_16x16x32_bf16 v[36:39], v[144:147], v[182:185], v[36:39]
  ds_read_b64_tr_b16 v[134:135], v64 offset:60416
  s_waitcnt lgkmcnt(8)
  v_mfma_f32_16x16x32_bf16 v[40:43], v[148:151], v[178:181], v[40:43]
  ds_read_b64_tr_b16 v[136:137], v66 offset:59392
  v_mfma_f32_16x16x32_bf16 v[44:47], v[148:151], v[182:185], v[44:47]
  ds_read_b64_tr_b16 v[138:139], v67 offset:60416
  s_waitcnt lgkmcnt(8)
  v_mfma_f32_16x16x32_bf16 v[48:51], v[152:155], v[178:181], v[48:51]
  ds_read_b64_tr_b16 v[140:141], v67 offset:59392
  v_mfma_f32_16x16x32_bf16 v[52:55], v[152:155], v[182:185], v[52:55]
  ds_read_b64_tr_b16 v[142:143], v66 offset:60416
  s_waitcnt lgkmcnt(8)
  v_mfma_f32_16x16x32_bf16 v[56:59], v[156:159], v[178:181], v[56:59]
  ds_read_b64_tr_b16 v[144:145], v68 offset:59392
  v_mfma_f32_16x16x32_bf16 v[60:63], v[156:159], v[182:185], v[60:63]
  ds_read_b64_tr_b16 v[146:147], v69 offset:60416
  s_waitcnt lgkmcnt(8)
  v_mfma_f32_16x16x32_bf16 v[192:195], v[128:131], v[178:181], v[192:195]
  ds_read_b64_tr_b16 v[148:149], v69 offset:59392
  v_mfma_f32_16x16x32_bf16 v[196:199], v[128:131], v[182:185], v[196:199]
  ds_read_b64_tr_b16 v[150:151], v68 offset:60416
  s_waitcnt lgkmcnt(8)
  v_mfma_f32_16x16x32_bf16 v[200:203], v[132:135], v[178:181], v[200:203]
  ds_read_b64_tr_b16 v[152:153], v70 offset:59392
  v_mfma_f32_16x16x32_bf16 v[204:207], v[132:135], v[182:185], v[204:207]
  ds_read_b64_tr_b16 v[154:155], v71 offset:60416
  s_waitcnt lgkmcnt(8)
  v_mfma_f32_16x16x32_bf16 v[208:211], v[136:139], v[178:181], v[208:211]
  ds_read_b64_tr_b16 v[156:157], v71 offset:59392
  v_mfma_f32_16x16x32_bf16 v[212:215], v[136:139], v[182:185], v[212:215]
  ds_read_b64_tr_b16 v[158:159], v70 offset:60416
  s_waitcnt lgkmcnt(8)
  v_mfma_f32_16x16x32_bf16 v[216:219], v[140:143], v[178:181], v[216:219]
  v_mfma_f32_16x16x32_bf16 v[220:223], v[140:143], v[182:185], v[220:223]
  s_waitcnt lgkmcnt(6)
  v_mfma_f32_16x16x32_bf16 v[224:227], v[144:147], v[178:181], v[224:227]
  v_mfma_f32_16x16x32_bf16 v[228:231], v[144:147], v[182:185], v[228:231]
  s_waitcnt lgkmcnt(4)
  v_mfma_f32_16x16x32_bf16 v[232:235], v[148:151], v[178:181], v[232:235]
  v_mfma_f32_16x16x32_bf16 v[236:239], v[148:151], v[182:185], v[236:239]
  s_waitcnt lgkmcnt(2)
  v_mfma_f32_16x16x32_bf16 v[240:243], v[152:155], v[178:181], v[240:243]
  v_mfma_f32_16x16x32_bf16 v[244:247], v[152:155], v[182:185], v[244:247]
  s_waitcnt lgkmcnt(0)
  v_mfma_f32_16x16x32_bf16 v[248:251], v[156:159], v[178:181], v[248:251]
  v_mfma_f32_16x16x32_bf16 v[252:255], v[156:159], v[182:185], v[252:255]
  s_barrier
  v_mov_b32 v160, v188
  v_xor_b32 v161, 64, v160
  v_xor_b32 v162, 128, v160
  v_xor_b32 v163, 192, v160
  v_mov_b32 v168, v76
  v_xor_b32 v169, 32, v168
  v_xor_b32 v170, 64, v168
  v_xor_b32 v171, 96, v168
  v_xor_b32 v172, 128, v168
  v_xor_b32 v173, 160, v168
  v_xor_b32 v174, 192, v168
  v_xor_b32 v175, 224, v168
  v_mov_b32 v164, 0x3f803f80
  v_mov_b32 v165, 0x3f803f80
  v_mov_b32 v166, 0x3f803f80
  v_mov_b32 v167, 0x3f803f80
  s_mov_b32 s85, s7
  ds_read_b32 v189, v187
  s_waitcnt lgkmcnt(0)
  v_cmp_gt_u32 vcc, 19, v189
  s_cbranch_vccnz .Lk1_o_7
.Lk1_k_8:
  ds_read_b128 v[128:131], v160 offset:0
  v_mov_b32 v190, 18
  ds_write_b32 v186, v190 offset:0
  ds_read_b128 v[132:135], v161 offset:0
  v_pk_mul_f32 v[0:1], v[0:1], s[84:85] op_sel:[0,1]
  v_pk_mul_f32 v[2:3], v[2:3], s[84:85] op_sel:[0,1]
  v_pk_mul_f32 v[4:5], v[4:5], s[84:85] op_sel:[0,1]
  v_pk_mul_f32 v[6:7], v[6:7], s[84:85] op_sel:[0,1]
  v_pk_mul_f32 v[8:9], v[8:9], s[84:85] op_sel:[0,1]
  v_pk_mul_f32 v[10:11], v[10:11], s[84:85] op_sel:[0,1]
  v_pk_mul_f32 v[12:13], v[12:13], s[84:85] op_sel:[0,1]
  v_pk_mul_f32 v[14:15], v[14:15], s[84:85] op_sel:[0,1]
  v_pk_mul_f32 v[16:17], v[16:17], s[84:85] op_sel:[0,1]
  v_pk_mul_f32 v[18:19], v[18:19], s[84:85] op_sel:[0,1]
  v_pk_mul_f32 v[20:21], v[20:21], s[84:85] op_sel:[0,1]
  v_pk_mul_f32 v[22:23], v[22:23], s[84:85] op_sel:[0,1]
  v_pk_mul_f32 v[24:25], v[24:25], s[84:85] op_sel:[0,1]
  v_pk_mul_f32 v[26:27], v[26:27], s[84:85] op_sel:[0,1]
  v_pk_mul_f32 v[28:29], v[28:29], s[84:85] op_sel:[0,1]
  v_pk_mul_f32 v[30:31], v[30:31], s[84:85] op_sel:[0,1]
  v_pk_mul_f32 v[32:33], v[32:33], s[84:85] op_sel:[0,1]
  v_pk_mul_f32 v[34:35], v[34:35], s[84:85] op_sel:[0,1]
  v_pk_mul_f32 v[36:37], v[36:37], s[84:85] op_sel:[0,1]
  v_pk_mul_f32 v[38:39], v[38:39], s[84:85] op_sel:[0,1]
  v_pk_mul_f32 v[40:41], v[40:41], s[84:85] op_sel:[0,1]
  v_pk_mul_f32 v[42:43], v[42:43], s[84:85] op_sel:[0,1]
  v_pk_mul_f32 v[44:45], v[44:45], s[84:85] op_sel:[0,1]
  v_pk_mul_f32 v[46:47], v[46:47], s[84:85] op_sel:[0,1]
  v_pk_mul_f32 v[48:49], v[48:49], s[84:85] op_sel:[0,1]
  v_pk_mul_f32 v[50:51], v[50:51], s[84:85] op_sel:[0,1]
  v_pk_mul_f32 v[52:53], v[52:53], s[84:85] op_sel:[0,1]
  v_pk_mul_f32 v[54:55], v[54:55], s[84:85] op_sel:[0,1]
  v_pk_mul_f32 v[56:57], v[56:57], s[84:85] op_sel:[0,1]
  v_pk_mul_f32 v[58:59], v[58:59], s[84:85] op_sel:[0,1]
  v_pk_mul_f32 v[60:61], v[60:61], s[84:85] op_sel:[0,1]
  v_pk_mul_f32 v[62:63], v[62:63], s[84:85] op_sel:[0,1]
  v_cvt_pk_bf16_f32 v0, v0, v1
  v_cvt_pk_bf16_f32 v1, v2, v3
  v_cvt_pk_bf16_f32 v2, v8, v9
  v_cvt_pk_bf16_f32 v3, v10, v11
  v_cvt_pk_bf16_f32 v4, v4, v5
  v_cvt_pk_bf16_f32 v5, v6, v7
  v_cvt_pk_bf16_f32 v6, v12, v13
  v_cvt_pk_bf16_f32 v7, v14, v15
  v_cvt_pk_bf16_f32 v8, v16, v17
  v_cvt_pk_bf16_f32 v9, v18, v19
  v_cvt_pk_bf16_f32 v10, v24, v25
  v_cvt_pk_bf16_f32 v11, v26, v27
  v_cvt_pk_bf16_f32 v12, v20, v21
  v_cvt_pk_bf16_f32 v13, v22, v23
  v_cvt_pk_bf16_f32 v14, v28, v29
  v_cvt_pk_bf16_f32 v15, v30, v31
  v_cvt_pk_bf16_f32 v16, v32, v33
  v_cvt_pk_bf16_f32 v17, v34, v35
  v_cvt_pk_bf16_f32 v18, v40, v41
  v_cvt_pk_bf16_f32 v19, v42, v43
  v_cvt_pk_bf16_f32 v20, v36, v37
  v_cvt_pk_bf16_f32 v21, v38, v39
  v_cvt_pk_bf16_f32 v22, v44, v45
  v_cvt_pk_bf16_f32 v23, v46, v47
  v_cvt_pk_bf16_f32 v24, v48, v49
  v_cvt_pk_bf16_f32 v25, v50, v51
  v_cvt_pk_bf16_f32 v26, v56, v57
  v_cvt_pk_bf16_f32 v27, v58, v59
  v_cvt_pk_bf16_f32 v28, v52, v53
  v_cvt_pk_bf16_f32 v29, v54, v55
  v_cvt_pk_bf16_f32 v30, v60, v61
  v_cvt_pk_bf16_f32 v31, v62, v63
  v_permlane32_swap_b32 v0, v2
  v_permlane32_swap_b32 v1, v3
  v_permlane32_swap_b32 v4, v6
  v_permlane32_swap_b32 v5, v7
  v_permlane32_swap_b32 v8, v10
  v_permlane32_swap_b32 v9, v11
  v_permlane32_swap_b32 v12, v14
  v_permlane32_swap_b32 v13, v15
  v_permlane32_swap_b32 v16, v18
  v_permlane32_swap_b32 v17, v19
  v_permlane32_swap_b32 v20, v22
  v_permlane32_swap_b32 v21, v23
  v_permlane32_swap_b32 v24, v26
  v_permlane32_swap_b32 v25, v27
  v_permlane32_swap_b32 v28, v30
  v_permlane32_swap_b32 v29, v31
  v_permlane16_swap_b32 v0, v2
  v_permlane16_swap_b32 v1, v3
  v_permlane16_swap_b32 v4, v6
  v_permlane16_swap_b32 v5, v7
  v_permlane16_swap_b32 v8, v10
  v_permlane16_swap_b32 v9, v11
  v_permlane16_swap_b32 v12, v14
  v_permlane16_swap_b32 v13, v15
  v_permlane16_swap_b32 v16, v18
  v_permlane16_swap_b32 v17, v19
  v_permlane16_swap_b32 v20, v22
  v_permlane16_swap_b32 v21, v23
  v_permlane16_swap_b32 v24, v26
  v_permlane16_swap_b32 v25, v27
  v_permlane16_swap_b32 v28, v30
  v_permlane16_swap_b32 v29, v31
  v_mov_b32 v188, 0
  v_mov_b32 v191, 0
  s_mov_b32 s7, 0x42800000
  v_mov_b32 v184, 0xf149f2ca
  v_mov_b32 v185, 0xf149f2ca
  s_mov_b32 s89, 0x42800000
  s_mov_b32 s90, 19
  s_mov_b32 s94, 19
  s_mov_b32 s97, 0xee
  s_lshl_b32 s88, s4, 18
  s_add_u32 s99, s88, 131072
  s_mov_b32 s27, 0
.Lk1_loop_10:
  s_add_u32 s91, s90, 1
  s_add_u32 s92, s90, 2
  s_add_u32 s93, s90, 3
  s_add_u32 s95, s94, 1
  s_add_u32 s96, s94, 2
  s_cmp_eq_u32 s27, 4
  s_cbranch_scc1 .Lk1_o_11
.Lk1_k_12:
  s_cmp_eq_u32 s27, 0
  s_cbranch_scc1 .Lk1_o_13
  s_waitcnt lgkmcnt(2)
  v_mfma_f32_16x16x32_bf16 v[64:67], v[128:131], v[224:227], 0
  v_exp_f32 v106, v106
  v_mfma_f32_16x16x32_bf16 v[72:75], v[128:131], v[228:231], 0
  ds_read_b128 v[136:139], v162 offset:0
  v_cvt_pk_bf16_f32 v104, v104, v105
  s_waitcnt lgkmcnt(1)
  v_mfma_f32_16x16x32_bf16 v[64:67], v[132:135], v[232:235], v[64:67]
  v_exp_f32 v107, v107
  v_mfma_f32_16x16x32_bf16 v[72:75], v[132:135], v[236:239], v[72:75]
  ds_read_b128 v[140:143], v163 offset:0
  s_waitcnt lgkmcnt(1)
  v_mfma_f32_16x16x32_bf16 v[64:67], v[136:139], v[240:243], v[64:67]
  v_exp_f32 v108, v108
  v_mfma_f32_16x16x32_bf16 v[72:75], v[136:139], v[244:247], v[72:75]
  ds_read_b128 v[144:147], v160 offset:4096
  v_cvt_pk_bf16_f32 v105, v106, v107
  s_waitcnt lgkmcnt(1)
  v_mfma_f32_16x16x32_bf16 v[64:67], v[140:143], v[248:251], v[64:67]
  v_exp_f32 v109, v109
  v_mfma_f32_16x16x32_bf16 v[72:75], v[140:143], v[252:255], v[72:75]
  ds_read_b128 v[148:151], v161 offset:4096
  s_waitcnt lgkmcnt(1)
  v_mfma_f32_16x16x32_bf16 v[68:71], v[144:147], v[224:227], 0
  v_exp_f32 v110, v110
  v_mfma_f32_16x16x32_bf16 v[76:79], v[144:147], v[228:231], 0
  ds_read_b128 v[128:131], v162 offset:4096
  v_cvt_pk_bf16_f32 v106, v108, v109
  s_waitcnt lgkmcnt(1)
  v_mfma_f32_16x16x32_bf16 v[68:71], v[148:151], v[232:235], v[68:71]
  v_exp_f32 v111, v111
  v_mfma_f32_16x16x32_bf16 v[76:79], v[148:151], v[236:239], v[76:79]
  ds_read_b128 v[132:135], v163 offset:4096
  s_waitcnt lgkmcnt(1)
  v_mfma_f32_16x16x32_bf16 v[68:71], v[128:131], v[240:243], v[68:71]
  v_exp_f32 v112, v112
  v_mfma_f32_16x16x32_bf16 v[76:79], v[128:131], v[244:247], v[76:79]
  ds_read_b128 v[136:139], v160 offset:8192
  v_cvt_pk_bf16_f32 v107, v110, v111
  s_cmp_eq_u32 s27, 5
  s_cbranch_scc1 .Lk1_o_21
.Lk1_k_22:
  s_waitcnt lgkmcnt(1)
  v_mfma_f32_16x16x32_bf16 v[68:71], v[132:135], v[248:251], v[68:71]
  v_exp_f32 v113, v113
  v_mfma_f32_16x16x32_bf16 v[76:79], v[132:135], v[252:255], v[76:79]
  ds_read_b128 v[140:143], v161 offset:8192
  s_waitcnt lgkmcnt(1)
  v_mfma_f32_16x16x32_bf16 v[80:83], v[136:139], v[224:227], 0
  v_exp_f32 v114, v114
  v_mfma_f32_16x16x32_bf16 v[88:91], v[136:139], v[228:231], 0
  ds_read_b128 v[144:147], v162 offset:8192
  v_cvt_pk_bf16_f32 v176, v112, v113
  v_max3_f32 v184, v184, v64, v65
  s_waitcnt lgkmcnt(1)
  v_mfma_f32_16x16x32_bf16 v[80:83], v[140:143], v[232:235], v[80:83]
  v_exp_f32 v115, v115
  v_mfma_f32_16x16x32_bf16 v[88:91], v[140:143], v[236:239], v[88:91]
  ds_read_b128 v[148:151], v163 offset:8192
  v_max3_f32 v184, v184, v66, v67
  s_waitcnt lgkmcnt(1)
  v_mfma_f32_16x16x32_bf16 v[80:83], v[144:147], v[240:243], v[80:83]
  v_exp_f32 v116, v116
  v_mfma_f32_16x16x32_bf16 v[88:91], v[144:147], v[244:247], v[88:91]
  ds_read_b128 v[128:131], v160 offset:12288
  v_cvt_pk_bf16_f32 v177, v114, v115
  v_max3_f32 v184, v184, v68, v69
  s_waitcnt lgkmcnt(1)
  v_mfma_f32_16x16x32_bf16 v[80:83], v[148:151], v[248:251], v[80:83]
  v_exp_f32 v117, v117
  v_mfma_f32_16x16x32_bf16 v[88:91], v[148:151], v[252:255], v[88:91]
  ds_read_b32 v189, v187
  ds_read_b128 v[132:135], v161 offset:12288
  v_max3_f32 v184, v184, v70, v71
  s_waitcnt lgkmcnt(2)
  v_mfma_f32_16x16x32_bf16 v[84:87], v[128:131], v[224:227], 0
  v_exp_f32 v118, v118
  v_mfma_f32_16x16x32_bf16 v[92:95], v[128:131], v[228:231], 0
  ds_read_b128 v[136:139], v162 offset:12288
  v_cvt_pk_bf16_f32 v178, v116, v117
  v_max3_f32 v185, v185, v72, v73
  s_waitcnt lgkmcnt(1)
  v_mfma_f32_16x16x32_bf16 v[84:87], v[132:135], v[232:235], v[84:87]
  v_exp_f32 v119, v119
  v_mfma_f32_16x16x32_bf16 v[92:95], v[132:135], v[236:239], v[92:95]
  v_cmp_gt_u32 vcc, s90, v189
  s_cbranch_vccnz .Lk1_o_23
.Lk1_k_24:
  ds_read_b128 v[140:143], v163 offset:12288
  v_max3_f32 v185, v185, v74, v75
  s_waitcnt lgkmcnt(1)
  v_mfma_f32_16x16x32_bf16 v[84:87], v[136:139], v[240:243], v[84:87]
  v_exp_f32 v120, v120
  v_mfma_f32_16x16x32_bf16 v[92:95], v[136:139], v[244:247], v[92:95]
  ds_read_b64_tr_b16 v[144:145], v168 offset:16384
  ds_read_b64_tr_b16 v[146:147], v168 offset:20480
  v_cvt_pk_bf16_f32 v179, v118, v119
  v_max3_f32 v185, v185, v76, v77
  s_waitcnt lgkmcnt(2)
  v_mfma_f32_16x16x32_bf16 v[84:87], v[140:143], v[248:251], v[84:87]
  v_exp_f32 v121, v121
  v_mfma_f32_16x16x32_bf16 v[92:95], v[140:143], v[252:255], v[92:95]
  ds_read_b64_tr_b16 v[148:149], v169 offset:16384
  ds_read_b64_tr_b16 v[150:151], v169 offset:20480
  v_max3_f32 v185, v185, v78, v79
  s_waitcnt lgkmcnt(2)
  v_mfma_f32_16x16x32_bf16 v[0:3], v[144:147], v[96:99], v[0:3]
  v_exp_f32 v122, v122
  v_mfma_f32_16x16x32_bf16 v[32:35], v[144:147], v[104:107], v[32:35]
  ds_read_b64_tr_b16 v[128:129], v170 offset:16384
  ds_read_b64_tr_b16 v[130:131], v170 offset:20480
  v_cvt_pk_bf16_f32 v180, v120, v121
  v_max3_f32 v184, v184, v80, v81
  s_waitcnt lgkmcnt(2)
  v_mfma_f32_16x16x32_bf16 v[4:7], v[148:151], v[96:99], v[4:7]
  v_exp_f32 v123, v123
  v_mfma_f32_16x16x32_bf16 v[36:39], v[148:151], v[104:107], v[36:39]
  ds_read_b64_tr_b16 v[132:133], v171 offset:16384
  ds_read_b64_tr_b16 v[134:135], v171 offset:20480
  v_max3_f32 v184, v184, v82, v83
  s_waitcnt lgkmcnt(2)
  v_mfma_f32_16x16x32_bf16 v[8:11], v[128:131], v[96:99], v[8:11]
  v_exp_f32 v124, v124
  v_mfma_f32_16x16x32_bf16 v[40:43], v[128:131], v[104:107], v[40:43]
  v_mfma_f32_16x16x32_bf16 v[152:155], v[164:167], v[96:99], v[152:155]
  ds_read_b64_tr_b16 v[136:137], v172 offset:16384
  ds_read_b64_tr_b16 v[138:139], v172 offset:20480
  v_cvt_pk_bf16_f32 v181, v122, v123
  v_max3_f32 v184, v184, v84, v85
  s_waitcnt lgkmcnt(2)
  v_mfma_f32_16x16x32_bf16 v[12:15], v[132:135], v[96:99], v[12:15]
  v_exp_f32 v125, v125
  v_mfma_f32_16x16x32_bf16 v[44:47], v[132:135], v[104:107], v[44:47]
  ds_read_b32 v189, v187
  ds_read_b64_tr_b16 v[140:141], v173 offset:16384
  ds_read_b64_tr_b16 v[142:143], v173 offset:20480
  v_max3_f32 v184, v184, v86, v87
  s_waitcnt lgkmcnt(3)
  v_mfma_f32_16x16x32_bf16 v[16:19], v[136:139], v[96:99], v[16:19]
  v_exp_f32 v126, v126
  v_mfma_f32_16x16x32_bf16 v[48:51], v[136:139], v[104:107], v[48:51]
  ds_read_b64_tr_b16 v[144:145], v174 offset:16384
  ds_read_b64_tr_b16 v[146:147], v174 offset:20480
  v_cvt_pk_bf16_f32 v182, v124, v125
  v_max3_f32 v185, v185, v88, v89
  s_waitcnt lgkmcnt(2)
  v_mfma_f32_16x16x32_bf16 v[20:23], v[140:143], v[96:99], v[20:23]
  v_exp_f32 v127, v127
  v_mfma_f32_16x16x32_bf16 v[52:55], v[140:143], v[104:107], v[52:55]
  v_mfma_f32_16x16x32_bf16 v[156:159], v[164:167], v[104:107], v[156:159]
  v_cmp_gt_u32 vcc, s91, v189
  s_cbranch_vccnz .Lk1_o_26
.Lk1_k_27:
  ds_read_b64_tr_b16 v[148:149], v175 offset:16384
  ds_read_b64_tr_b16 v[150:151], v175 offset:20480
  v_max3_f32 v185, v185, v90, v91
  s_waitcnt lgkmcnt(2)
  v_mfma_f32_16x16x32_bf16 v[24:27], v[144:147], v[96:99], v[24:27]
  v_exp_f32 v64, v64
  v_mfma_f32_16x16x32_bf16 v[56:59], v[144:147], v[104:107], v[56:59]
  ds_read_b128 v[128:131], v160 offset:16384
  v_cvt_pk_bf16_f32 v183, v126, v127
  v_max3_f32 v185, v185, v92, v93
  s_cmp_eq_u32 s27, 5
  s_cbranch_scc1 .Lk1_o_29
.Lk1_k_30:
  s_waitcnt lgkmcnt(1)
  v_mfma_f32_16x16x32_bf16 v[28:31], v[148:151], v[96:99], v[28:31]
  v_exp_f32 v65, v65
  v_mfma_f32_16x16x32_bf16 v[60:63], v[148:151], v[104:107], v[60:63]
  ds_read_b128 v[132:135], v161 offset:16384
  v_max3_f32 v185, v185, v94, v95
  s_waitcnt lgkmcnt(1)
  v_mfma_f32_16x16x32_bf16 v[96:99], v[128:131], v[224:227], 0
  v_exp_f32 v66, v66
  v_mfma_f32_16x16x32_bf16 v[104:107], v[128:131], v[228:231], 0
  ds_read_b128 v[136:139], v162 offset:16384
  v_cvt_pk_bf16_f32 v64, v64, v65
  s_waitcnt lgkmcnt(1)
  v_mfma_f32_16x16x32_bf16 v[96:99], v[132:135], v[232:235], v[96:99]
  v_exp_f32 v67, v67
  v_mfma_f32_16x16x32_bf16 v[104:107], v[132:135], v[236:239], v[104:107]
  ds_read_b128 v[140:143], v163 offset:16384
  s_waitcnt lgkmcnt(1)
  v_mfma_f32_16x16x32_bf16 v[96:99], v[136:139], v[240:243], v[96:99]
  v_exp_f32 v68, v68
  v_mfma_f32_16x16x32_bf16 v[104:107], v[136:139], v[244:247], v[104:107]
  ds_read_b128 v[144:147], v160 offset:20480
  v_cvt_pk_bf16_f32 v65, v66, v67
  s_waitcnt lgkmcnt(1)
  v_mfma_f32_16x16x32_bf16 v[96:99], v[140:143], v[248:251], v[96:99]
  v_exp_f32 v69, v69
  v_mfma_f32_16x16x32_bf16 v[104:107], v[140:143], v[252:255], v[104:107]
  ds_read_b128 v[148:151], v161 offset:20480
  s_waitcnt lgkmcnt(1)
  v_mfma_f32_16x16x32_bf16 v[100:103], v[144:147], v[224:227], 0
  v_exp_f32 v70, v70
  v_mfma_f32_16x16x32_bf16 v[108:111], v[144:147], v[228:231], 0
  ds_read_b128 v[128:131], v162 offset:20480
  v_cvt_pk_bf16_f32 v66, v68, v69
  s_waitcnt lgkmcnt(1)
  v_mfma_f32_16x16x32_bf16 v[100:103], v[148:151], v[232:235], v[100:103]
  v_exp_f32 v71, v71
  v_mfma_f32_16x16x32_bf16 v[108:111], v[148:151], v[236:239], v[108:111]
  ds_read_b128 v[132:135], v163 offset:20480
  s_waitcnt lgkmcnt(1)
  v_mfma_f32_16x16x32_bf16 v[100:103], v[128:131], v[240:243], v[100:103]
  v_exp_f32 v72, v72
  v_mfma_f32_16x16x32_bf16 v[108:111], v[128:131], v[244:247], v[108:111]
  ds_read_b128 v[136:139], v160 offset:24576
  v_cvt_pk_bf16_f32 v67, v70, v71
  s_waitcnt lgkmcnt(1)
  v_mfma_f32_16x16x32_bf16 v[100:103], v[132:135], v[248:251], v[100:103]
  v_exp_f32 v73, v73
  v_mfma_f32_16x16x32_bf16 v[108:111], v[132:135], v[252:255], v[108:111]
  ds_read_b128 v[140:143], v161 offset:24576
  s_waitcnt lgkmcnt(1)
  v_mfma_f32_16x16x32_bf16 v[112:115], v[136:139], v[224:227], 0
  v_exp_f32 v74, v74
  v_mfma_f32_16x16x32_bf16 v[120:123], v[136:139], v[228:231], 0
  ds_read_b128 v[144:147], v162 offset:24576
  v_max3_f32 v184, v184, v96, v97
  v_cvt_pk_bf16_f32 v72, v72, v73
  s_waitcnt lgkmcnt(1)
  v_mfma_f32_16x16x32_bf16 v[112:115], v[140:143], v[232:235], v[112:115]
  v_exp_f32 v75, v75
  v_mfma_f32_16x16x32_bf16 v[120:123], v[140:143], v[236:239], v[120:123]
  ds_read_b128 v[148:151], v163 offset:24576
  v_max3_f32 v184, v184, v98, v99
  s_waitcnt lgkmcnt(1)
  v_mfma_f32_16x16x32_bf16 v[112:115], v[144:147], v[240:243], v[112:115]
  v_exp_f32 v76, v76
  v_mfma_f32_16x16x32_bf16 v[120:123], v[144:147], v[244:247], v[120:123]
  ds_read_b128 v[128:131], v160 offset:28672
  v_max3_f32 v184, v184, v100, v101
  v_cvt_pk_bf16_f32 v73, v74, v75
  s_waitcnt lgkmcnt(1)
  v_mfma_f32_16x16x32_bf16 v[112:115], v[148:151], v[248:251], v[112:115]
  v_exp_f32 v77, v77
  v_mfma_f32_16x16x32_bf16 v[120:123], v[148:151], v[252:255], v[120:123]
  ds_read_b128 v[132:135], v161 offset:28672
  v_max3_f32 v184, v184, v102, v103
  s_waitcnt lgkmcnt(1)
  v_mfma_f32_16x16x32_bf16 v[116:119], v[128:131], v[224:227], 0
  v_exp_f32 v78, v78
  v_mfma_f32_16x16x32_bf16 v[124:127], v[128:131], v[228:231], 0
  ds_read_b128 v[136:139], v162 offset:28672
  v_max3_f32 v185, v185, v104, v105
  v_cvt_pk_bf16_f32 v74, v76, v77
  s_waitcnt lgkmcnt(1)
  v_mfma_f32_16x16x32_bf16 v[116:119], v[132:135], v[232:235], v[116:119]
  v_exp_f32 v79, v79
  v_mfma_f32_16x16x32_bf16 v[124:127], v[132:135], v[236:239], v[124:127]
  ds_read_b128 v[140:143], v163 offset:28672
  v_max3_f32 v185, v185, v106, v107
  s_waitcnt lgkmcnt(1)
  v_mfma_f32_16x16x32_bf16 v[116:119], v[136:139], v[240:243], v[116:119]
  v_exp_f32 v80, v80
  v_mfma_f32_16x16x32_bf16 v[124:127], v[136:139], v[244:247], v[124:127]
  ds_read_b64_tr_b16 v[144:145], v168 offset:24576
  ds_read_b64_tr_b16 v[146:147], v168 offset:28672
  v_max3_f32 v185, v185, v108, v109
  v_cvt_pk_bf16_f32 v75, v78, v79
  s_cmp_eq_u32 s27, 5
  s_cbranch_scc1 .Lk1_o_31
.Lk1_k_32:
  s_waitcnt lgkmcnt(2)
  v_mfma_f32_16x16x32_bf16 v[116:119], v[140:143], v[248:251], v[116:119]
  v_exp_f32 v81, v81
  v_mfma_f32_16x16x32_bf16 v[124:127], v[140:143], v[252:255], v[124:127]
  ds_read_b64_tr_b16 v[148:149], v169 offset:24576
  ds_read_b64_tr_b16 v[150:151], v169 offset:28672
  v_max3_f32 v185, v185, v110, v111
  s_waitcnt lgkmcnt(2)
  v_mfma_f32_16x16x32_bf16 v[0:3], v[144:147], v[176:179], v[0:3]
  v_exp_f32 v82, v82
  v_mfma_f32_16x16x32_bf16 v[32:35], v[144:147], v[180:183], v[32:35]
  ds_read_b64_tr_b16 v[128:129], v170 offset:24576
  ds_read_b64_tr_b16 v[130:131], v170 offset:28672
  v_max3_f32 v184, v184, v112, v113
  v_cvt_pk_bf16_f32 v80, v80, v81
  s_waitcnt lgkmcnt(2)
  v_mfma_f32_16x16x32_bf16 v[4:7], v[148:151], v[176:179], v[4:7]
  v_exp_f32 v83, v83
  v_mfma_f32_16x16x32_bf16 v[36:39], v[148:151], v[180:183], v[36:39]
  ds_read_b64_tr_b16 v[132:133], v171 offset:24576
  ds_read_b64_tr_b16 v[134:135], v171 offset:28672
  v_max3_f32 v184, v184, v114, v115
  s_waitcnt lgkmcnt(2)
  v_mfma_f32_16x16x32_bf16 v[8:11], v[128:131], v[176:179], v[8:11]
  v_exp_f32 v84, v84
  v_mfma_f32_16x16x32_bf16 v[40:43], v[128:131], v[180:183], v[40:43]
  v_mfma_f32_16x16x32_bf16 v[152:155], v[164:167], v[176:179], v[152:155]
  ds_read_b64_tr_b16 v[136:137], v172 offset:24576
  ds_read_b64_tr_b16 v[138:139], v172 offset:28672
  v_max3_f32 v184, v184, v116, v117
  v_cvt_pk_bf16_f32 v81, v82, v83
  s_waitcnt lgkmcnt(2)
  v_mfma_f32_16x16x32_bf16 v[12:15], v[132:135], v[176:179], v[12:15]
  v_exp_f32 v85, v85
  v_mfma_f32_16x16x32_bf16 v[44:47], v[132:135], v[180:183], v[44:47]
  ds_read_b32 v189, v187
  ds_read_b64_tr_b16 v[140:141], v173 offset:24576
  ds_read_b64_tr_b16 v[142:143], v173 offset:28672
  v_max3_f32 v184, v184, v118, v119
  s_waitcnt lgkmcnt(3)
  v_mfma_f32_16x16x32_bf16 v[16:19], v[136:139], v[176:179], v[16:19]
  v_exp_f32 v86, v86
  v_mfma_f32_16x16x32_bf16 v[48:51], v[136:139], v[180:183], v[48:51]
  ds_read_b64_tr_b16 v[144:145], v174 offset:24576
  ds_read_b64_tr_b16 v[146:147], v174 offset:28672
  v_max3_f32 v185, v185, v120, v121
  v_cvt_pk_bf16_f32 v82, v84, v85
  s_waitcnt lgkmcnt(2)
  v_mfma_f32_16x16x32_bf16 v[20:23], v[140:143], v[176:179], v[20:23]
  v_exp_f32 v87, v87
  v_mfma_f32_16x16x32_bf16 v[52:55], v[140:143], v[180:183], v[52:55]
  v_mfma_f32_16x16x32_bf16 v[156:159], v[164:167], v[180:183], v[156:159]
  v_cmp_gt_u32 vcc, s92, v189
  s_cbranch_vccnz .Lk1_o_33
.Lk1_k_34:
  s_cmp_eq_u32 s27, 6
  s_cbranch_scc1 .Lk1_o_36
.Lk1_k_37:
  ds_read_b64_tr_b16 v[148:149], v175 offset:24576
  ds_read_b64_tr_b16 v[150:151], v175 offset:28672
  v_max3_f32 v185, v185, v122, v123
  v_xor_b32 v168, 0x10000, v168
  v_xor_b32 v169, 0x10000, v169
  v_xor_b32 v170, 0x10000, v170
  v_xor_b32 v171, 0x10000, v171
  v_xor_b32 v172, 0x10000, v172
  v_xor_b32 v173, 0x10000, v173
  v_xor_b32 v174, 0x10000, v174
  v_xor_b32 v175, 0x10000, v175
  s_waitcnt lgkmcnt(2)
  v_mfma_f32_16x16x32_bf16 v[24:27], v[144:147], v[176:179], v[24:27]
  v_exp_f32 v88, v88
  v_mfma_f32_16x16x32_bf16 v[56:59], v[144:147], v[180:183], v[56:59]
  ds_read_b64_tr_b16 v[128:129], v168 offset:0
  ds_read_b64_tr_b16 v[130:131], v168 offset:4096
  v_max3_f32 v185, v185, v124, v125
  v_cvt_pk_bf16_f32 v83, v86, v87
  s_waitcnt lgkmcnt(2)
  v_mfma_f32_16x16x32_bf16 v[28:31], v[148:151], v[176:179], v[28:31]
  v_exp_f32 v89, v89
  v_mfma_f32_16x16x32_bf16 v[60:63], v[148:151], v[180:183], v[60:63]
  v_mov_b32 v190, s94
  ds_write_b32 v186, v190 offset:0
  ds_read_b64_tr_b16 v[132:133], v169 offset:0
  ds_read_b64_tr_b16 v[134:135], v169 offset:4096
  v_max3_f32 v185, v185, v126, v127
.Lk1_k_14:
  s_cmp_eq_u32 s27, 4
  s_cbranch_scc1 .Lk1_o_38
.Lk1_k_39:
  v_max_f32 v189, abs(v184), abs(v185)
  v_cmp_lt_f32 vcc, s7, v189
  s_cbranch_vccnz .Lk1_o_40
  s_bitcmp0_b32 s97, s27
  s_cbranch_scc1 .Lk1_o_52
  s_waitcnt lgkmcnt(3)
  v_mfma_f32_16x16x32_bf16 v[0:3], v[128:131], v[64:67], v[0:3]
  v_exp_f32 v90, v90
  v_mfma_f32_16x16x32_bf16 v[32:35], v[128:131], v[72:75], v[32:35]
  ds_read_b64_tr_b16 v[136:137], v170 offset:0
  ds_read_b64_tr_b16 v[138:139], v170 offset:4096
  v_cvt_pk_bf16_f32 v88, v88, v89
  s_waitcnt lgkmcnt(2)
  v_mfma_f32_16x16x32_bf16 v[4:7], v[132:135], v[64:67], v[4:7]
  v_exp_f32 v91, v91
  v_mfma_f32_16x16x32_bf16 v[36:39], v[132:135], v[72:75], v[36:39]
  v_mov_b32 v190, s95
  ds_write_b32 v186, v190 offset:0
  ds_read_b64_tr_b16 v[140:141], v171 offset:0
  ds_read_b64_tr_b16 v[142:143], v171 offset:4096
  s_waitcnt lgkmcnt(3)
  v_mfma_f32_16x16x32_bf16 v[8:11], v[136:139], v[64:67], v[8:11]
  v_exp_f32 v92, v92
  v_mfma_f32_16x16x32_bf16 v[40:43], v[136:139], v[72:75], v[40:43]
  v_mfma_f32_16x16x32_bf16 v[152:155], v[164:167], v[64:67], v[152:155]
  ds_read_b64_tr_b16 v[144:145], v172 offset:0
  ds_read_b64_tr_b16 v[146:147], v172 offset:4096
  v_cvt_pk_bf16_f32 v89, v90, v91
  v_xor_b32 v160, 0x10000, v160
  s_waitcnt lgkmcnt(2)
  v_mfma_f32_16x16x32_bf16 v[12:15], v[140:143], v[64:67], v[12:15]
  v_exp_f32 v93, v93
  v_mfma_f32_16x16x32_bf16 v[44:47], v[140:143], v[72:75], v[44:47]
  ds_read_b64_tr_b16 v[148:149], v173 offset:0
  ds_read_b64_tr_b16 v[150:151], v173 offset:4096
  v_xor_b32 v161, 0x10000, v161
  s_waitcnt lgkmcnt(2)
  v_mfma_f32_16x16x32_bf16 v[16:19], v[144:147], v[64:67], v[16:19]
  v_exp_f32 v94, v94
  v_mfma_f32_16x16x32_bf16 v[48:51], v[144:147], v[72:75], v[48:51]
  ds_read_b64_tr_b16 v[128:129], v174 offset:0
  ds_read_b64_tr_b16 v[130:131], v174 offset:4096
  v_cvt_pk_bf16_f32 v90, v92, v93
  v_xor_b32 v162, 0x10000, v162
  s_waitcnt lgkmcnt(2)
  v_mfma_f32_16x16x32_bf16 v[20:23], v[148:151], v[64:67], v[20:23]
  v_exp_f32 v95, v95
  v_mfma_f32_16x16x32_bf16 v[52:55], v[148:151], v[72:75], v[52:55]
  v_mfma_f32_16x16x32_bf16 v[156:159], v[164:167], v[72:75], v[156:159]
  ds_read_b64_tr_b16 v[132:133], v175 offset:0
  ds_read_b64_tr_b16 v[134:135], v175 offset:4096
  v_xor_b32 v163, 0x10000, v163
  s_waitcnt lgkmcnt(2)
  v_mfma_f32_16x16x32_bf16 v[24:27], v[128:131], v[64:67], v[24:27]
  v_exp_f32 v96, v96
  v_mfma_f32_16x16x32_bf16 v[56:59], v[128:131], v[72:75], v[56:59]
  ds_read_b64_tr_b16 v[136:137], v168 offset:8192
  ds_read_b64_tr_b16 v[138:139], v168 offset:12288
  v_cvt_pk_bf16_f32 v91, v94, v95
  s_cmp_eq_u32 s27, 5
  s_cbranch_scc1 .Lk1_o_60
.Lk1_k_61:
  s_waitcnt lgkmcnt(2)
  v_mfma_f32_16x16x32_bf16 v[28:31], v[132:135], v[64:67], v[28:31]
  v_exp_f32 v97, v97
  v_mfma_f32_16x16x32_bf16 v[60:63], v[132:135], v[72:75], v[60:63]
  ds_read_b64_tr_b16 v[140:141], v169 offset:8192
  ds_read_b64_tr_b16 v[142:143], v169 offset:12288
.Lk1_k_53:
  s_waitcnt lgkmcnt(2)
  v_mfma_f32_16x16x32_bf16 v[0:3], v[136:139], v[80:83], v[0:3]
  v_exp_f32 v98, v98
  v_mfma_f32_16x16x32_bf16 v[32:35], v[136:139], v[88:91], v[32:35]
  ds_read_b64_tr_b16 v[144:145], v170 offset:8192
  ds_read_b64_tr_b16 v[146:147], v170 offset:12288
  v_cvt_pk_bf16_f32 v96, v96, v97
  s_waitcnt lgkmcnt(2)
  v_mfma_f32_16x16x32_bf16 v[4:7], v[140:143], v[80:83], v[4:7]
  v_exp_f32 v99, v99
  v_mfma_f32_16x16x32_bf16 v[36:39], v[140:143], v[88:91], v[36:39]
  ds_read_b64_tr_b16 v[148:149], v171 offset:8192
  ds_read_b64_tr_b16 v[150:151], v171 offset:12288
  s_waitcnt lgkmcnt(2)
  v_mfma_f32_16x16x32_bf16 v[8:11], v[144:147], v[80:83], v[8:11]
  v_exp_f32 v100, v100
  v_mfma_f32_16x16x32_bf16 v[40:43], v[144:147], v[88:91], v[40:43]
  v_mfma_f32_16x16x32_bf16 v[152:155], v[164:167], v[80:83], v[152:155]
  ds_read_b64_tr_b16 v[128:129], v172 offset:8192
  ds_read_b64_tr_b16 v[130:131], v172 offset:12288
  v_cvt_pk_bf16_f32 v97, v98, v99
  s_waitcnt lgkmcnt(2)
  v_mfma_f32_16x16x32_bf16 v[12:15], v[148:151], v[80:83], v[12:15]
  v_exp_f32 v101, v101
  v_mfma_f32_16x16x32_bf16 v[44:47], v[148:151], v[88:91], v[44:47]
  ds_read_b32 v189, v187
  ds_read_b64_tr_b16 v[132:133], v173 offset:8192
  ds_read_b64_tr_b16 v[134:135], v173 offset:12288
  s_waitcnt lgkmcnt(3)
  v_mfma_f32_16x16x32_bf16 v[16:19], v[128:131], v[80:83], v[16:19]
  v_exp_f32 v102, v102
  v_mfma_f32_16x16x32_bf16 v[48:51], v[128:131], v[88:91], v[48:51]
  ds_read_b64_tr_b16 v[136:137], v174 offset:8192
  ds_read_b64_tr_b16 v[138:139], v174 offset:12288
  v_cvt_pk_bf16_f32 v98, v100, v101
  s_waitcnt lgkmcnt(2)
  v_mfma_f32_16x16x32_bf16 v[20:23], v[132:135], v[80:83], v[20:23]
  v_exp_f32 v103, v103
  v_mfma_f32_16x16x32_bf16 v[52:55], v[132:135], v[88:91], v[52:55]
  v_mfma_f32_16x16x32_bf16 v[156:159], v[164:167], v[88:91], v[156:159]
  v_cmp_gt_u32 vcc, s93, v189
  s_cbranch_vccnz .Lk1_o_62
.Lk1_k_63:
  ds_read_b64_tr_b16 v[140:141], v175 offset:8192
  ds_read_b64_tr_b16 v[142:143], v175 offset:12288
  s_waitcnt lgkmcnt(2)
  v_mfma_f32_16x16x32_bf16 v[24:27], v[136:139], v[80:83], v[24:27]
  v_exp_f32 v104, v104
  v_mfma_f32_16x16x32_bf16 v[56:59], v[136:139], v[88:91], v[56:59]
  ds_read_b128 v[128:131], v160 offset:0
  v_cvt_pk_bf16_f32 v99, v102, v103
  s_waitcnt lgkmcnt(1)
  v_mfma_f32_16x16x32_bf16 v[28:31], v[140:143], v[80:83], v[28:31]
  v_exp_f32 v105, v105
  v_mfma_f32_16x16x32_bf16 v[60:63], v[140:143], v[88:91], v[60:63]
  v_mov_b32 v190, s96
  ds_write_b32 v186, v190 offset:0
  ds_read_b128 v[132:135], v161 offset:0
.Lk1_k_41:
  s_add_u32 s90, s90, 4
  s_add_u32 s94, s94, 3
  s_add_u32 s27, s27, 1
  s_cmp_lt_u32 s27, 8
  s_cbranch_scc1 .Lk1_loop_10
  s_waitcnt lgkmcnt(0)
  v_exp_f32 v106, v106
  v_cvt_pk_bf16_f32 v104, v104, v105
  v_exp_f32 v107, v107
  v_exp_f32 v108, v108
  v_cvt_pk_bf16_f32 v105, v106, v107
  v_exp_f32 v109, v109
  v_exp_f32 v110, v110
  v_cvt_pk_bf16_f32 v106, v108, v109
  v_exp_f32 v111, v111
  v_exp_f32 v112, v112
  v_cvt_pk_bf16_f32 v107, v110, v111
  v_exp_f32 v113, v113
  v_exp_f32 v114, v114
  v_cvt_pk_bf16_f32 v176, v112, v113
  v_exp_f32 v115, v115
  v_exp_f32 v116, v116
  v_cvt_pk_bf16_f32 v177, v114, v115
  v_exp_f32 v117, v117
  v_exp_f32 v118, v118
  v_cvt_pk_bf16_f32 v178, v116, v117
  v_exp_f32 v119, v119
  v_exp_f32 v120, v120
  ds_read_b64_tr_b16 v[144:145], v168 offset:16384
  ds_read_b64_tr_b16 v[146:147], v168 offset:20480
  v_cvt_pk_bf16_f32 v179, v118, v119
  v_exp_f32 v121, v121
  ds_read_b64_tr_b16 v[148:149], v169 offset:16384
  ds_read_b64_tr_b16 v[150:151], v169 offset:20480
  s_waitcnt lgkmcnt(2)
  v_mfma_f32_16x16x32_bf16 v[0:3], v[144:147], v[96:99], v[0:3]
  v_exp_f32 v122, v122
  v_mfma_f32_16x16x32_bf16 v[32:35], v[144:147], v[104:107], v[32:35]
  ds_read_b64_tr_b16 v[128:129], v170 offset:16384
  ds_read_b64_tr_b16 v[130:131], v170 offset:20480
  v_cvt_pk_bf16_f32 v180, v120, v121
  s_waitcnt lgkmcnt(2)
  v_mfma_f32_16x16x32_bf16 v[4:7], v[148:151], v[96:99], v[4:7]
  v_exp_f32 v123, v123
  v_mfma_f32_16x16x32_bf16 v[36:39], v[148:151], v[104:107], v[36:39]
  ds_read_b64_tr_b16 v[132:133], v171 offset:16384
  ds_read_b64_tr_b16 v[134:135], v171 offset:20480
  s_waitcnt lgkmcnt(2)
  v_mfma_f32_16x16x32_bf16 v[8:11], v[128:131], v[96:99], v[8:11]
  v_exp_f32 v124, v124
  v_mfma_f32_16x16x32_bf16 v[40:43], v[128:131], v[104:107], v[40:43]
  v_mfma_f32_16x16x32_bf16 v[152:155], v[164:167], v[96:99], v[152:155]
  ds_read_b64_tr_b16 v[136:137], v172 offset:16384
  ds_read_b64_tr_b16 v[138:139], v172 offset:20480
  v_cvt_pk_bf16_f32 v181, v122, v123
  s_waitcnt lgkmcnt(2)
  v_mfma_f32_16x16x32_bf16 v[12:15], v[132:135], v[96:99], v[12:15]
  v_exp_f32 v125, v125
  v_mfma_f32_16x16x32_bf16 v[44:47], v[132:135], v[104:107], v[44:47]
  ds_read_b64_tr_b16 v[140:141], v173 offset:16384
  ds_read_b64_tr_b16 v[142:143], v173 offset:20480
  s_waitcnt lgkmcnt(2)
  v_mfma_f32_16x16x32_bf16 v[16:19], v[136:139], v[96:99], v[16:19]
  v_exp_f32 v126, v126
  v_mfma_f32_16x16x32_bf16 v[48:51], v[136:139], v[104:107], v[48:51]
  ds_read_b64_tr_b16 v[144:145], v174 offset:16384
  ds_read_b64_tr_b16 v[146:147], v174 offset:20480
  v_cvt_pk_bf16_f32 v182, v124, v125
  s_waitcnt lgkmcnt(2)
  v_mfma_f32_16x16x32_bf16 v[20:23], v[140:143], v[96:99], v[20:23]
  v_exp_f32 v127, v127
  v_mfma_f32_16x16x32_bf16 v[52:55], v[140:143], v[104:107], v[52:55]
  v_mfma_f32_16x16x32_bf16 v[156:159], v[164:167], v[104:107], v[156:159]
  ds_read_b64_tr_b16 v[148:149], v175 offset:16384
  ds_read_b64_tr_b16 v[150:151], v175 offset:20480
  s_waitcnt lgkmcnt(2)
  v_mfma_f32_16x16x32_bf16 v[24:27], v[144:147], v[96:99], v[24:27]
  v_cvt_pk_bf16_f32 v183, v126, v127
  v_mfma_f32_16x16x32_bf16 v[56:59], v[144:147], v[104:107], v[56:59]
  s_waitcnt lgkmcnt(0)
  v_mfma_f32_16x16x32_bf16 v[28:31], v[148:151], v[96:99], v[28:31]
  v_mfma_f32_16x16x32_bf16 v[60:63], v[148:151], v[104:107], v[60:63]
  ds_read_b64_tr_b16 v[144:145], v168 offset:24576
  ds_read_b64_tr_b16 v[146:147], v168 offset:28672
  ds_read_b64_tr_b16 v[148:149], v169 offset:24576
  ds_read_b64_tr_b16 v[150:151], v169 offset:28672
  s_waitcnt lgkmcnt(2)
  v_mfma_f32_16x16x32_bf16 v[0:3], v[144:147], v[176:179], v[0:3]
  v_mfma_f32_16x16x32_bf16 v[32:35], v[144:147], v[180:183], v[32:35]
  ds_read_b64_tr_b16 v[128:129], v170 offset:24576
  ds_read_b64_tr_b16 v[130:131], v170 offset:28672
  s_waitcnt lgkmcnt(2)
  v_mfma_f32_16x16x32_bf16 v[4:7], v[148:151], v[176:179], v[4:7]
  v_mfma_f32_16x16x32_bf16 v[36:39], v[148:151], v[180:183], v[36:39]
  ds_read_b64_tr_b16 v[132:133], v171 offset:24576
  ds_read_b64_tr_b16 v[134:135], v171 offset:28672
  s_waitcnt lgkmcnt(2)
  v_mfma_f32_16x16x32_bf16 v[8:11], v[128:131], v[176:179], v[8:11]
  v_mfma_f32_16x16x32_bf16 v[40:43], v[128:131], v[180:183], v[40:43]
  v_mfma_f32_16x16x32_bf16 v[152:155], v[164:167], v[176:179], v[152:155]
  ds_read_b64_tr_b16 v[136:137], v172 offset:24576
  ds_read_b64_tr_b16 v[138:139], v172 offset:28672
  s_waitcnt lgkmcnt(2)
  v_mfma_f32_16x16x32_bf16 v[12:15], v[132:135], v[176:179], v[12:15]
  v_mfma_f32_16x16x32_bf16 v[44:47], v[132:135], v[180:183], v[44:47]
  ds_read_b64_tr_b16 v[140:141], v173 offset:24576
  ds_read_b64_tr_b16 v[142:143], v173 offset:28672
  s_waitcnt lgkmcnt(2)
  v_mfma_f32_16x16x32_bf16 v[16:19], v[136:139], v[176:179], v[16:19]
  v_mfma_f32_16x16x32_bf16 v[48:51], v[136:139], v[180:183], v[48:51]
  ds_read_b64_tr_b16 v[144:145], v174 offset:24576
  ds_read_b64_tr_b16 v[146:147], v174 offset:28672
  s_waitcnt lgkmcnt(2)
  v_mfma_f32_16x16x32_bf16 v[20:23], v[140:143], v[176:179], v[20:23]
  v_mfma_f32_16x16x32_bf16 v[52:55], v[140:143], v[180:183], v[52:55]
  v_mfma_f32_16x16x32_bf16 v[156:159], v[164:167], v[180:183], v[156:159]
  ds_read_b64_tr_b16 v[148:149], v175 offset:24576
  ds_read_b64_tr_b16 v[150:151], v175 offset:28672
  s_waitcnt lgkmcnt(2)
  v_mfma_f32_16x16x32_bf16 v[24:27], v[144:147], v[176:179], v[24:27]
  v_mfma_f32_16x16x32_bf16 v[56:59], v[144:147], v[180:183], v[56:59]
  s_waitcnt lgkmcnt(0)
  v_mfma_f32_16x16x32_bf16 v[28:31], v[148:151], v[176:179], v[28:31]
  v_mfma_f32_16x16x32_bf16 v[60:63], v[148:151], v[180:183], v[60:63]
  s_add_u32 s88, s88, 4096
  s_add_u32 s99, s99, 4096
  v_rcp_f32 v176, v152
  v_rcp_f32 v177, v156
  v_mbcnt_lo_u32_b32 v189, -1, 0
  v_mbcnt_hi_u32_b32 v189, -1, v189
  v_lshlrev_b32 v189, 4, v189
  v_pk_mul_f32 v[0:1], v[0:1], v[176:177] op_sel_hi:[1,0]
  v_pk_mul_f32 v[2:3], v[2:3], v[176:177] op_sel_hi:[1,0]
  v_pk_mul_f32 v[4:5], v[4:5], v[176:177] op_sel_hi:[1,0]
  v_pk_mul_f32 v[6:7], v[6:7], v[176:177] op_sel_hi:[1,0]
  v_cvt_pk_bf16_f32 v64, v0, v1
  v_cvt_pk_bf16_f32 v65, v2, v3
  v_cvt_pk_bf16_f32 v66, v4, v5
  v_cvt_pk_bf16_f32 v67, v6, v7
  v_pk_mul_f32 v[32:33], v[32:33], v[176:177] op_sel:[0,1]
  v_pk_mul_f32 v[34:35], v[34:35], v[176:177] op_sel:[0,1]
  v_pk_mul_f32 v[36:37], v[36:37], v[176:177] op_sel:[0,1]
  v_pk_mul_f32 v[38:39], v[38:39], v[176:177] op_sel:[0,1]
  v_cvt_pk_bf16_f32 v80, v32, v33
  v_cvt_pk_bf16_f32 v81, v34, v35
  v_cvt_pk_bf16_f32 v82, v36, v37
  v_cvt_pk_bf16_f32 v83, v38, v39
  buffer_store_dwordx4 v[64:67], v189, s[44:47], s88 offen offset:0 sc1
  buffer_store_dwordx4 v[80:83], v189, s[44:47], s99 offen offset:0 sc1
  v_pk_mul_f32 v[8:9], v[8:9], v[176:177] op_sel_hi:[1,0]
  v_pk_mul_f32 v[10:11], v[10:11], v[176:177] op_sel_hi:[1,0]
  v_pk_mul_f32 v[12:13], v[12:13], v[176:177] op_sel_hi:[1,0]
  v_pk_mul_f32 v[14:15], v[14:15], v[176:177] op_sel_hi:[1,0]
  v_cvt_pk_bf16_f32 v68, v8, v9
  v_cvt_pk_bf16_f32 v69, v10, v11
  v_cvt_pk_bf16_f32 v70, v12, v13
  v_cvt_pk_bf16_f32 v71, v14, v15
  v_pk_mul_f32 v[40:41], v[40:41], v[176:177] op_sel:[0,1]
  v_pk_mul_f32 v[42:43], v[42:43], v[176:177] op_sel:[0,1]
  v_pk_mul_f32 v[44:45], v[44:45], v[176:177] op_sel:[0,1]
  v_pk_mul_f32 v[46:47], v[46:47], v[176:177] op_sel:[0,1]
  v_cvt_pk_bf16_f32 v84, v40, v41
  v_cvt_pk_bf16_f32 v85, v42, v43
  v_cvt_pk_bf16_f32 v86, v44, v45
  v_cvt_pk_bf16_f32 v87, v46, v47
  buffer_store_dwordx4 v[68:71], v189, s[44:47], s88 offen offset:1024 sc1
  buffer_store_dwordx4 v[84:87], v189, s[44:47], s99 offen offset:1024 sc1
  v_pk_mul_f32 v[16:17], v[16:17], v[176:177] op_sel_hi:[1,0]
  v_pk_mul_f32 v[18:19], v[18:19], v[176:177] op_sel_hi:[1,0]
  v_pk_mul_f32 v[20:21], v[20:21], v[176:177] op_sel_hi:[1,0]
  v_pk_mul_f32 v[22:23], v[22:23], v[176:177] op_sel_hi:[1,0]
  v_cvt_pk_bf16_f32 v72, v16, v17
  v_cvt_pk_bf16_f32 v73, v18, v19
  v_cvt_pk_bf16_f32 v74, v20, v21
  v_cvt_pk_bf16_f32 v75, v22, v23
  v_pk_mul_f32 v[48:49], v[48:49], v[176:177] op_sel:[0,1]
  v_pk_mul_f32 v[50:51], v[50:51], v[176:177] op_sel:[0,1]
  v_pk_mul_f32 v[52:53], v[52:53], v[176:177] op_sel:[0,1]
  v_pk_mul_f32 v[54:55], v[54:55], v[176:177] op_sel:[0,1]
  v_cvt_pk_bf16_f32 v88, v48, v49
  v_cvt_pk_bf16_f32 v89, v50, v51
  v_cvt_pk_bf16_f32 v90, v52, v53
  v_cvt_pk_bf16_f32 v91, v54, v55
  buffer_store_dwordx4 v[72:75], v189, s[44:47], s88 offen offset:2048 sc1
  buffer_store_dwordx4 v[88:91], v189, s[44:47], s99 offen offset:2048 sc1
  v_pk_mul_f32 v[24:25], v[24:25], v[176:177] op_sel_hi:[1,0]
  v_pk_mul_f32 v[26:27], v[26:27], v[176:177] op_sel_hi:[1,0]
  v_pk_mul_f32 v[28:29], v[28:29], v[176:177] op_sel_hi:[1,0]
  v_pk_mul_f32 v[30:31], v[30:31], v[176:177] op_sel_hi:[1,0]
  v_cvt_pk_bf16_f32 v76, v24, v25
  v_cvt_pk_bf16_f32 v77, v26, v27
  v_cvt_pk_bf16_f32 v78, v28, v29
  v_cvt_pk_bf16_f32 v79, v30, v31
  v_pk_mul_f32 v[56:57], v[56:57], v[176:177] op_sel:[0,1]
  v_pk_mul_f32 v[58:59], v[58:59], v[176:177] op_sel:[0,1]
  v_pk_mul_f32 v[60:61], v[60:61], v[176:177] op_sel:[0,1]
  v_pk_mul_f32 v[62:63], v[62:63], v[176:177] op_sel:[0,1]
  v_cvt_pk_bf16_f32 v92, v56, v57
  v_cvt_pk_bf16_f32 v93, v58, v59
  v_cvt_pk_bf16_f32 v94, v60, v61
  v_cvt_pk_bf16_f32 v95, v62, v63
  buffer_store_dwordx4 v[76:79], v189, s[44:47], s88 offen offset:3072 sc1
  buffer_store_dwordx4 v[92:95], v189, s[44:47], s99 offen offset:3072 sc1
  v_mov_b32 v234, 162816
  ds_read_b64 v[234:235], v234
  s_waitcnt lgkmcnt(0)
  v_readfirstlane_b32 s79, v234
  s_nop 3
  s_cmp_ge_u32 s79, 27
  s_cbranch_scc1 .Lk1_o_65
.Lk1_k_66:
  s_load_dwordx2 s[12:13], s[0:1], 80
  s_load_dwordx2 s[14:15], s[0:1], 96
  v_mbcnt_lo_u32_b32 v0, -1, 0
  v_mbcnt_hi_u32_b32 v0, -1, v0
  v_and_b32 v3, 15, v0
  v_lshrrev_b32 v4, 4, v0
  v_lshrrev_b32 v5, 2, v3
  v_and_b32 v6, 3, v3
  v_lshlrev_b32 v183, 4, v0
  s_and_b32 s5, s4, 1
  s_lshr_b32 s6, s4, 1
  v_lshl_add_u32 v7, v4, 2, v5
  v_bfe_u32 v8, v7, 1, 2
  v_mul_u32_u24 v7, 384, v7
  v_lshl_add_u32 v7, v6, 3, v7
  s_mul_i32 s3, s5, 6
  s_add_u32 s26, s3, 0
  v_xor_b32 v9, s26, v8
  v_lshl_add_u32 v176, v9, 5, v7
  s_add_u32 s26, s3, 1
  v_xor_b32 v9, s26, v8
  v_lshl_add_u32 v177, v9, 5, v7
  s_add_u32 s26, s3, 2
  v_xor_b32 v9, s26, v8
  v_lshl_add_u32 v178, v9, 5, v7
  s_add_u32 s26, s3, 3
  v_xor_b32 v9, s26, v8
  v_lshl_add_u32 v179, v9, 5, v7
  s_add_u32 s26, s3, 4
  v_xor_b32 v9, s26, v8
  v_lshl_add_u32 v180, v9, 5, v7
  s_add_u32 s26, s3, 5
  v_xor_b32 v9, s26, v8
  v_lshl_add_u32 v181, v9, 5, v7
  s_lshl_b32 s3, s6, 10
  s_add_u32 s3, s3, 49152
  v_add_u32 v182, s3, v183
  v_mul_u32_u24 v7, 2304, v3
  v_lshl_add_u32 v7, v4, 4, v7
  s_mul_i32 s3, s5, 192
  s_mul_i32 s26, s6, 36864
  s_add_u32 s3, s3, s26
  v_add_u32 v184, s3, v7
  v_and_b32 v7, 3, v0
  v_max_u32 v7, 1, v7
  v_mov_b32 v185, v7
  v_mov_b32 v0, 0
  v_mov_b32 v1, 0
  v_mov_b32 v2, 0
  v_mov_b32 v3, 0
  v_mov_b32 v4, 0
  v_mov_b32 v5, 0
  v_mov_b32 v6, 0
  v_mov_b32 v7, 0
  v_mov_b32 v8, 0
  v_mov_b32 v9, 0
  v_mov_b32 v10, 0
  v_mov_b32 v11, 0
  v_mov_b32 v12, 0
  v_mov_b32 v13, 0
  v_mov_b32 v14, 0
  v_mov_b32 v15, 0
  v_mov_b32 v16, 0
  v_mov_b32 v17, 0
  v_mov_b32 v18, 0
  v_mov_b32 v19, 0
  v_mov_b32 v20, 0
  v_mov_b32 v21, 0
  v_mov_b32 v22, 0
  v_mov_b32 v23, 0
  v_mov_b32 v24, 0
  v_mov_b32 v25, 0
  v_mov_b32 v26, 0
  v_mov_b32 v27, 0
  v_mov_b32 v28, 0
  v_mov_b32 v29, 0
  v_mov_b32 v30, 0
  v_mov_b32 v31, 0
  v_mov_b32 v32, 0
  v_mov_b32 v33, 0
  v_mov_b32 v34, 0
  v_mov_b32 v35, 0
  v_mov_b32 v36, 0
  v_mov_b32 v37, 0
  v_mov_b32 v38, 0
  v_mov_b32 v39, 0
  v_mov_b32 v40, 0
  v_mov_b32 v41, 0
  v_mov_b32 v42, 0
  v_mov_b32 v43, 0
  v_mov_b32 v44, 0
  v_mov_b32 v45, 0
  v_mov_b32 v46, 0
  v_mov_b32 v47, 0
  v_mov_b32 v48, 0
  v_mov_b32 v49, 0
  v_mov_b32 v50, 0
  v_mov_b32 v51, 0
  v_mov_b32 v52, 0
  v_mov_b32 v53, 0
  v_mov_b32 v54, 0
  v_mov_b32 v55, 0
  v_mov_b32 v56, 0
  v_mov_b32 v57, 0
  v_mov_b32 v58, 0
  v_mov_b32 v59, 0
  v_mov_b32 v60, 0
  v_mov_b32 v61, 0
  v_mov_b32 v62, 0
  v_mov_b32 v63, 0
  v_mov_b32 v64, 0
  v_mov_b32 v65, 0
  v_mov_b32 v66, 0
  v_mov_b32 v67, 0
  v_mov_b32 v68, 0
  v_mov_b32 v69, 0
  v_mov_b32 v70, 0
  v_mov_b32 v71, 0
  v_mov_b32 v72, 0
  v_mov_b32 v73, 0
  v_mov_b32 v74, 0
  v_mov_b32 v75, 0
  v_mov_b32 v76, 0
  v_mov_b32 v77, 0
  v_mov_b32 v78, 0
  v_mov_b32 v79, 0
  v_mov_b32 v80, 0
  v_mov_b32 v81, 0
  v_mov_b32 v82, 0
  v_mov_b32 v83, 0
  v_mov_b32 v84, 0
  v_mov_b32 v85, 0
  v_mov_b32 v86, 0
  v_mov_b32 v87, 0
  v_mov_b32 v88, 0
  v_mov_b32 v89, 0
  v_mov_b32 v90, 0
  v_mov_b32 v91, 0
  v_mov_b32 v92, 0
  v_mov_b32 v93, 0
  v_mov_b32 v94, 0
  v_mov_b32 v95, 0
  s_waitcnt lgkmcnt(0)
  s_barrier
  ds_read_b128 v[144:147], v182 offset:0
  ds_read_b64_tr_b16 v[96:97], v176 offset:0
  ds_read_b64_tr_b16 v[98:99], v176 offset:6144
  ds_read_b64_tr_b16 v[100:101], v177 offset:0
  ds_read_b64_tr_b16 v[102:103], v177 offset:6144
  ds_read_b64_tr_b16 v[104:105], v178 offset:0
  ds_read_b64_tr_b16 v[106:107], v178 offset:6144
  ds_read_b128 v[148:151], v182 offset:2048
  ds_read_b64_tr_b16 v[108:109], v179 offset:0
  ds_read_b64_tr_b16 v[110:111], v179 offset:6144
  ds_read_b64_tr_b16 v[112:113], v180 offset:0
  ds_read_b64_tr_b16 v[114:115], v180 offset:6144
  s_waitcnt lgkmcnt(8)
  ds_read_b64_tr_b16 v[116:117], v181 offset:0
  ds_read_b64_tr_b16 v[118:119], v181 offset:6144
  ds_read_b128 v[152:155], v182 offset:4096
  ds_read_b128 v[156:159], v182 offset:6144
  s_and_b32 s48, s2, 3
  s_bfe_u32 s50, s2, 0x10002
  s_min_u32 s49, s79, 27
  s_mul_i32 s51, s49, 43
  s_lshr_b32 s51, s51, 7
  s_mul_i32 s3, s51, 3
  s_sub_u32 s52, s49, s3
  s_mul_i32 s53, s50, 27
  s_add_u32 s53, s53, s49
  s_mul_i32 s3, s53, 147456
  s_add_u32 s3, s3, 41943040
  s_add_u32 s8, s14, s3
  s_addc_u32 s9, s15, 0
  s_mov_b32 s28, s8
  s_and_b32 s29, s9, 0xffff
  s_mov_b32 s30, 147456
  s_mov_b32 s31, 0x20000
  s_lshl_b32 s3, s51, 2
  s_add_u32 s3, s3, s48
  s_mul_i32 s3, s3, 73728
  s_mul_i32 s26, s50, 1152
  s_add_u32 s3, s3, s26
  s_mul_i32 s26, s52, 384
  s_add_u32 s3, s3, s26
  s_add_u32 s12, s12, s3
  s_addc_u32 s13, s13, 0
  s_mov_b32 s32, s12
  s_and_b32 s33, s13, 0xffff
  s_mov_b32 s34, 71808
  s_mov_b32 s35, 0x20000
  v_xor_b32 v185, s48, v185
  s_lshl_b32 s3, s53, 2
  v_add_u32 v185, s3, v185
  v_lshl_add_u32 v185, v185, 2, s4
  v_lshlrev_b32 v185, 7, v185
  s_add_u32 s3, s3, s48
  s_lshl_b32 s3, s3, 2
  s_add_u32 s3, s3, s4
  s_lshl_b32 s3, s3, 7
  s_add_u32 s3, s3, 34603008
  v_mov_b32 v187, s3
  v_add_u32 v185, 34603008, v185
  s_mov_b32 s27, 0
.Lk1_loop_67:
  s_waitcnt lgkmcnt(0)
  s_barrier
  v_mfma_f32_16x16x32_bf16 v[0:3], v[96:99], v[144:147], v[0:3]
  ds_read_b128 v[160:163], v182 offset:8192
  v_mfma_f32_16x16x32_bf16 v[4:7], v[100:103], v[144:147], v[4:7]
  ds_read_b64_tr_b16 v[120:121], v176 offset:12288
  v_mfma_f32_16x16x32_bf16 v[8:11], v[104:107], v[144:147], v[8:11]
  ds_read_b64_tr_b16 v[122:123], v176 offset:18432
  v_mfma_f32_16x16x32_bf16 v[12:15], v[108:111], v[144:147], v[12:15]
  ds_read_b64_tr_b16 v[124:125], v177 offset:12288
  v_mfma_f32_16x16x32_bf16 v[16:19], v[112:115], v[144:147], v[16:19]
  ds_read_b64_tr_b16 v[126:127], v177 offset:18432
  v_mfma_f32_16x16x32_bf16 v[20:23], v[116:119], v[144:147], v[20:23]
  ds_read_b64_tr_b16 v[128:129], v178 offset:12288
  v_mfma_f32_16x16x32_bf16 v[24:27], v[96:99], v[148:151], v[24:27]
  ds_read_b64_tr_b16 v[130:131], v178 offset:18432
  v_mfma_f32_16x16x32_bf16 v[28:31], v[100:103], v[148:151], v[28:31]
  ds_read_b128 v[164:167], v182 offset:10240
  v_mfma_f32_16x16x32_bf16 v[32:35], v[104:107], v[148:151], v[32:35]
  ds_read_b64_tr_b16 v[132:133], v179 offset:12288
  v_mfma_f32_16x16x32_bf16 v[36:39], v[108:111], v[148:151], v[36:39]
  ds_read_b64_tr_b16 v[134:135], v179 offset:18432
  v_mfma_f32_16x16x32_bf16 v[40:43], v[112:115], v[148:151], v[40:43]
  ds_read_b64_tr_b16 v[136:137], v180 offset:12288
  v_mfma_f32_16x16x32_bf16 v[44:47], v[116:119], v[148:151], v[44:47]
  ds_read_b64_tr_b16 v[138:139], v180 offset:18432
  v_mfma_f32_16x16x32_bf16 v[48:51], v[96:99], v[152:155], v[48:51]
  ds_read_b64_tr_b16 v[140:141], v181 offset:12288
  v_mfma_f32_16x16x32_bf16 v[52:55], v[100:103], v[152:155], v[52:55]
  s_waitcnt lgkmcnt(8)
  ds_read_b64_tr_b16 v[142:143], v181 offset:18432
  v_mfma_f32_16x16x32_bf16 v[56:59], v[104:107], v[152:155], v[56:59]
  ds_read_b128 v[168:171], v182 offset:12288
  v_mfma_f32_16x16x32_bf16 v[60:63], v[108:111], v[152:155], v[60:63]
  ds_read_b128 v[172:175], v182 offset:14336
  v_mfma_f32_16x16x32_bf16 v[64:67], v[112:115], v[152:155], v[64:67]
  v_mfma_f32_16x16x32_bf16 v[68:71], v[116:119], v[152:155], v[68:71]
  v_mfma_f32_16x16x32_bf16 v[72:75], v[96:99], v[156:159], v[72:75]
  v_mfma_f32_16x16x32_bf16 v[76:79], v[100:103], v[156:159], v[76:79]
  v_mfma_f32_16x16x32_bf16 v[80:83], v[104:107], v[156:159], v[80:83]
  v_mfma_f32_16x16x32_bf16 v[84:87], v[108:111], v[156:159], v[84:87]
  v_mfma_f32_16x16x32_bf16 v[88:91], v[112:115], v[156:159], v[88:91]
  v_mfma_f32_16x16x32_bf16 v[92:95], v[116:119], v[156:159], v[92:95]
  s_waitcnt lgkmcnt(0)
  s_barrier
  v_mfma_f32_16x16x32_bf16 v[0:3], v[120:123], v[160:163], v[0:3]
  ds_read_b128 v[144:147], v182 offset:16384
  v_mfma_f32_16x16x32_bf16 v[4:7], v[124:127], v[160:163], v[4:7]
  ds_read_b64_tr_b16 v[96:97], v176 offset:24576
  v_mfma_f32_16x16x32_bf16 v[8:11], v[128:131], v[160:163], v[8:11]
  ds_read_b64_tr_b16 v[98:99], v176 offset:30720
  v_mfma_f32_16x16x32_bf16 v[12:15], v[132:135], v[160:163], v[12:15]
  ds_read_b64_tr_b16 v[100:101], v177 offset:24576
  v_mfma_f32_16x16x32_bf16 v[16:19], v[136:139], v[160:163], v[16:19]
  ds_read_b64_tr_b16 v[102:103], v177 offset:30720
  v_mfma_f32_16x16x32_bf16 v[20:23], v[140:143], v[160:163], v[20:23]
  ds_read_b64_tr_b16 v[104:105], v178 offset:24576
  v_mfma_f32_16x16x32_bf16 v[24:27], v[120:123], v[164:167], v[24:27]
  ds_read_b64_tr_b16 v[106:107], v178 offset:30720
  v_mfma_f32_16x16x32_bf16 v[28:31], v[124:127], v[164:167], v[28:31]
  ds_read_b128 v[148:151], v182 offset:18432
  v_mfma_f32_16x16x32_bf16 v[32:35], v[128:131], v[164:167], v[32:35]
  ds_read_b64_tr_b16 v[108:109], v179 offset:24576
  v_mfma_f32_16x16x32_bf16 v[36:39], v[132:135], v[164:167], v[36:39]
  ds_read_b64_tr_b16 v[110:111], v179 offset:30720
  v_mfma_f32_16x16x32_bf16 v[40:43], v[136:139], v[164:167], v[40:43]
  ds_read_b64_tr_b16 v[112:113], v180 offset:24576
  v_mfma_f32_16x16x32_bf16 v[44:47], v[140:143], v[164:167], v[44:47]
  ds_read_b64_tr_b16 v[114:115], v180 offset:30720
  v_mfma_f32_16x16x32_bf16 v[48:51], v[120:123], v[168:171], v[48:51]
  ds_read_b64_tr_b16 v[116:117], v181 offset:24576
  v_mfma_f32_16x16x32_bf16 v[52:55], v[124:127], v[168:171], v[52:55]
  s_waitcnt lgkmcnt(8)
  ds_read_b64_tr_b16 v[118:119], v181 offset:30720
  v_mfma_f32_16x16x32_bf16 v[56:59], v[128:131], v[168:171], v[56:59]
  ds_read_b128 v[152:155], v182 offset:20480
  v_mfma_f32_16x16x32_bf16 v[60:63], v[132:135], v[168:171], v[60:63]
  ds_read_b128 v[156:159], v182 offset:22528
  v_mfma_f32_16x16x32_bf16 v[64:67], v[136:139], v[168:171], v[64:67]
  v_mfma_f32_16x16x32_bf16 v[68:71], v[140:143], v[168:171], v[68:71]
  v_mfma_f32_16x16x32_bf16 v[72:75], v[120:123], v[172:175], v[72:75]
  v_mfma_f32_16x16x32_bf16 v[76:79], v[124:127], v[172:175], v[76:79]
  v_mfma_f32_16x16x32_bf16 v[80:83], v[128:131], v[172:175], v[80:83]
  v_mfma_f32_16x16x32_bf16 v[84:87], v[132:135], v[172:175], v[84:87]
  v_mfma_f32_16x16x32_bf16 v[88:91], v[136:139], v[172:175], v[88:91]
  v_mfma_f32_16x16x32_bf16 v[92:95], v[140:143], v[172:175], v[92:95]
  s_waitcnt lgkmcnt(0)
  s_barrier
  v_mfma_f32_16x16x32_bf16 v[0:3], v[96:99], v[144:147], v[0:3]
  ds_read_b128 v[160:163], v182 offset:24576
  v_mfma_f32_16x16x32_bf16 v[4:7], v[100:103], v[144:147], v[4:7]
  ds_read_b64_tr_b16 v[120:121], v176 offset:36864
  v_mfma_f32_16x16x32_bf16 v[8:11], v[104:107], v[144:147], v[8:11]
  ds_read_b64_tr_b16 v[122:123], v176 offset:43008
  v_mfma_f32_16x16x32_bf16 v[12:15], v[108:111], v[144:147], v[12:15]
  ds_read_b64_tr_b16 v[124:125], v177 offset:36864
  v_mfma_f32_16x16x32_bf16 v[16:19], v[112:115], v[144:147], v[16:19]
  ds_read_b64_tr_b16 v[126:127], v177 offset:43008
  v_mfma_f32_16x16x32_bf16 v[20:23], v[116:119], v[144:147], v[20:23]
  ds_read_b64_tr_b16 v[128:129], v178 offset:36864
  v_mfma_f32_16x16x32_bf16 v[24:27], v[96:99], v[148:151], v[24:27]
  ds_read_b64_tr_b16 v[130:131], v178 offset:43008
  v_mfma_f32_16x16x32_bf16 v[28:31], v[100:103], v[148:151], v[28:31]
  ds_read_b128 v[164:167], v182 offset:26624
  v_mfma_f32_16x16x32_bf16 v[32:35], v[104:107], v[148:151], v[32:35]
  ds_read_b64_tr_b16 v[132:133], v179 offset:36864
  v_mfma_f32_16x16x32_bf16 v[36:39], v[108:111], v[148:151], v[36:39]
  ds_read_b64_tr_b16 v[134:135], v179 offset:43008
  v_mfma_f32_16x16x32_bf16 v[40:43], v[112:115], v[148:151], v[40:43]
  ds_read_b64_tr_b16 v[136:137], v180 offset:36864
  v_mfma_f32_16x16x32_bf16 v[44:47], v[116:119], v[148:151], v[44:47]
  ds_read_b64_tr_b16 v[138:139], v180 offset:43008
  v_mfma_f32_16x16x32_bf16 v[48:51], v[96:99], v[152:155], v[48:51]
  ds_read_b64_tr_b16 v[140:141], v181 offset:36864
  v_mfma_f32_16x16x32_bf16 v[52:55], v[100:103], v[152:155], v[52:55]
  s_waitcnt lgkmcnt(8)
  ds_read_b64_tr_b16 v[142:143], v181 offset:43008
  v_mfma_f32_16x16x32_bf16 v[56:59], v[104:107], v[152:155], v[56:59]
  ds_read_b128 v[168:171], v182 offset:28672
  v_mfma_f32_16x16x32_bf16 v[60:63], v[108:111], v[152:155], v[60:63]
  ds_read_b128 v[172:175], v182 offset:30720
  v_mfma_f32_16x16x32_bf16 v[64:67], v[112:115], v[152:155], v[64:67]
  v_mfma_f32_16x16x32_bf16 v[68:71], v[116:119], v[152:155], v[68:71]
  v_mfma_f32_16x16x32_bf16 v[72:75], v[96:99], v[156:159], v[72:75]
  v_mfma_f32_16x16x32_bf16 v[76:79], v[100:103], v[156:159], v[76:79]
  v_mfma_f32_16x16x32_bf16 v[80:83], v[104:107], v[156:159], v[80:83]
  v_mfma_f32_16x16x32_bf16 v[84:87], v[108:111], v[156:159], v[84:87]
  v_mfma_f32_16x16x32_bf16 v[88:91], v[112:115], v[156:159], v[88:91]
  v_mfma_f32_16x16x32_bf16 v[92:95], v[116:119], v[156:159], v[92:95]
  s_waitcnt lgkmcnt(0)
  s_waitcnt vmcnt(0)
  s_barrier
  v_mfma_f32_16x16x32_bf16 v[0:3], v[120:123], v[160:163], v[0:3]
  ds_read_b128 v[144:147], v182 offset:0
  v_mfma_f32_16x16x32_bf16 v[4:7], v[124:127], v[160:163], v[4:7]
  ds_read_b64_tr_b16 v[96:97], v176 offset:0
  v_mfma_f32_16x16x32_bf16 v[8:11], v[128:131], v[160:163], v[8:11]
  ds_read_b64_tr_b16 v[98:99], v176 offset:6144
  v_mfma_f32_16x16x32_bf16 v[12:15], v[132:135], v[160:163], v[12:15]
  ds_read_b64_tr_b16 v[100:101], v177 offset:0
  v_mfma_f32_16x16x32_bf16 v[16:19], v[136:139], v[160:163], v[16:19]
  ds_read_b64_tr_b16 v[102:103], v177 offset:6144
  v_mfma_f32_16x16x32_bf16 v[20:23], v[140:143], v[160:163], v[20:23]
  ds_read_b64_tr_b16 v[104:105], v178 offset:0
  v_mfma_f32_16x16x32_bf16 v[24:27], v[120:123], v[164:167], v[24:27]
  ds_read_b64_tr_b16 v[106:107], v178 offset:6144
  v_mfma_f32_16x16x32_bf16 v[28:31], v[124:127], v[164:167], v[28:31]
  ds_read_b128 v[148:151], v182 offset:2048
  v_mfma_f32_16x16x32_bf16 v[32:35], v[128:131], v[164:167], v[32:35]
  ds_read_b64_tr_b16 v[108:109], v179 offset:0
  v_mfma_f32_16x16x32_bf16 v[36:39], v[132:135], v[164:167], v[36:39]
  ds_read_b64_tr_b16 v[110:111], v179 offset:6144
  v_mfma_f32_16x16x32_bf16 v[40:43], v[136:139], v[164:167], v[40:43]
  ds_read_b64_tr_b16 v[112:113], v180 offset:0
  v_mfma_f32_16x16x32_bf16 v[44:47], v[140:143], v[164:167], v[44:47]
  ds_read_b64_tr_b16 v[114:115], v180 offset:6144
  v_mfma_f32_16x16x32_bf16 v[48:51], v[120:123], v[168:171], v[48:51]
  ds_read_b64_tr_b16 v[116:117], v181 offset:0
  v_mfma_f32_16x16x32_bf16 v[52:55], v[124:127], v[168:171], v[52:55]
  s_waitcnt lgkmcnt(8)
  ds_read_b64_tr_b16 v[118:119], v181 offset:6144
  v_mfma_f32_16x16x32_bf16 v[56:59], v[128:131], v[168:171], v[56:59]
  ds_read_b128 v[152:155], v182 offset:4096
  v_mfma_f32_16x16x32_bf16 v[60:63], v[132:135], v[168:171], v[60:63]
  ds_read_b128 v[156:159], v182 offset:6144
  v_mfma_f32_16x16x32_bf16 v[64:67], v[136:139], v[168:171], v[64:67]
  v_mfma_f32_16x16x32_bf16 v[68:71], v[140:143], v[168:171], v[68:71]
  v_mfma_f32_16x16x32_bf16 v[72:75], v[120:123], v[172:175], v[72:75]
  v_mfma_f32_16x16x32_bf16 v[76:79], v[124:127], v[172:175], v[76:79]
  v_mfma_f32_16x16x32_bf16 v[80:83], v[128:131], v[172:175], v[80:83]
  v_mfma_f32_16x16x32_bf16 v[84:87], v[132:135], v[172:175], v[84:87]
  v_mfma_f32_16x16x32_bf16 v[88:91], v[136:139], v[172:175], v[88:91]
  v_mfma_f32_16x16x32_bf16 v[92:95], v[140:143], v[172:175], v[92:95]
  s_add_u32 s27, s27, 1
  s_cmp_lt_u32 s27, 8
  s_cbranch_scc1 .Lk1_loop_67
  s_waitcnt lgkmcnt(0)
  s_mul_i32 s49, s4, 3072
  s_xor_b32 s3, s48, 1
  s_mul_i32 s3, s3, 36864
  s_add_u32 s3, s3, s49
  s_add_u32 s26, s3, 0
  v_cvt_pk_bf16_f32 v96, v24, v25
  v_cvt_pk_bf16_f32 v97, v26, v27
  v_cvt_pk_bf16_f32 v98, v28, v29
  v_cvt_pk_bf16_f32 v99, v30, v31
  buffer_store_dwordx4 v[96:99], v183, s[28:31], s26 offen offset:0 sc1
  v_cvt_pk_bf16_f32 v100, v32, v33
  v_cvt_pk_bf16_f32 v101, v34, v35
  v_cvt_pk_bf16_f32 v102, v36, v37
  v_cvt_pk_bf16_f32 v103, v38, v39
  buffer_store_dwordx4 v[100:103], v183, s[28:31], s26 offen offset:1024 sc1
  v_cvt_pk_bf16_f32 v104, v40, v41
  v_cvt_pk_bf16_f32 v105, v42, v43
  v_cvt_pk_bf16_f32 v106, v44, v45
  v_cvt_pk_bf16_f32 v107, v46, v47
  buffer_store_dwordx4 v[104:107], v183, s[28:31], s26 offen offset:2048 sc1
  s_xor_b32 s3, s48, 2
  s_mul_i32 s3, s3, 36864
  s_add_u32 s3, s3, s49
  s_add_u32 s26, s3, 12288
  v_cvt_pk_bf16_f32 v108, v48, v49
  v_cvt_pk_bf16_f32 v109, v50, v51
  v_cvt_pk_bf16_f32 v110, v52, v53
  v_cvt_pk_bf16_f32 v111, v54, v55
  buffer_store_dwordx4 v[108:111], v183, s[28:31], s26 offen offset:0 sc1
  v_cvt_pk_bf16_f32 v112, v56, v57
  v_cvt_pk_bf16_f32 v113, v58, v59
  v_cvt_pk_bf16_f32 v114, v60, v61
  v_cvt_pk_bf16_f32 v115, v62, v63
  buffer_store_dwordx4 v[112:115], v183, s[28:31], s26 offen offset:1024 sc1
  v_cvt_pk_bf16_f32 v116, v64, v65
  v_cvt_pk_bf16_f32 v117, v66, v67
  v_cvt_pk_bf16_f32 v118, v68, v69
  v_cvt_pk_bf16_f32 v119, v70, v71
  buffer_store_dwordx4 v[116:119], v183, s[28:31], s26 offen offset:2048 sc1
  s_xor_b32 s3, s48, 3
  s_mul_i32 s3, s3, 36864
  s_add_u32 s3, s3, s49
  s_add_u32 s26, s3, 24576
  v_cvt_pk_bf16_f32 v120, v72, v73
  v_cvt_pk_bf16_f32 v121, v74, v75
  v_cvt_pk_bf16_f32 v122, v76, v77
  v_cvt_pk_bf16_f32 v123, v78, v79
  buffer_store_dwordx4 v[120:123], v183, s[28:31], s26 offen offset:0 sc1
  v_cvt_pk_bf16_f32 v124, v80, v81
  v_cvt_pk_bf16_f32 v125, v82, v83
  v_cvt_pk_bf16_f32 v126, v84, v85
  v_cvt_pk_bf16_f32 v127, v86, v87
  buffer_store_dwordx4 v[124:127], v183, s[28:31], s26 offen offset:1024 sc1
  v_cvt_pk_bf16_f32 v128, v88, v89
  v_cvt_pk_bf16_f32 v129, v90, v91
  v_cvt_pk_bf16_f32 v130, v92, v93
  v_cvt_pk_bf16_f32 v131, v94, v95
  buffer_store_dwordx4 v[128:131], v183, s[28:31], s26 offen offset:2048 sc1
  global_load_dword v186, v185, s[14:15] sc1
  s_waitcnt vmcnt(0)
  s_mov_b64 exec, 1
  global_store_dword v187, v235, s[14:15] sc1
  s_mov_b64 exec, -1
  v_cmp_ne_u32 vcc, v235, v186
  s_cbranch_vccnz .Lk1_o_68
.Lk1_k_69:
  s_mul_i32 s3, s48, 36864
  s_add_u32 s3, s3, s49
  s_mov_b32 s57, 0xffff0000
  s_add_u32 s16, s3, 0
  s_add_u32 s17, s3, 12288
  s_add_u32 s18, s3, 24576
  buffer_load_dwordx4 v[24:27], v183, s[28:31], s16 offen offset:0 sc1
  buffer_load_dwordx4 v[36:39], v183, s[28:31], s17 offen offset:0 sc1
  buffer_load_dwordx4 v[48:51], v183, s[28:31], s18 offen offset:0 sc1
  buffer_load_dwordx4 v[28:31], v183, s[28:31], s16 offen offset:1024 sc1
  buffer_load_dwordx4 v[40:43], v183, s[28:31], s17 offen offset:1024 sc1
  buffer_load_dwordx4 v[52:55], v183, s[28:31], s18 offen offset:1024 sc1
  buffer_load_dwordx4 v[32:35], v183, s[28:31], s16 offen offset:2048 sc1
  buffer_load_dwordx4 v[44:47], v183, s[28:31], s17 offen offset:2048 sc1
  buffer_load_dwordx4 v[56:59], v183, s[28:31], s18 offen offset:2048 sc1
  s_waitcnt vmcnt(6)
  v_lshlrev_b32 v64, 16, v24
  v_and_b32 v65, s57, v24
  v_add_f32 v0, v0, v64
  v_add_f32 v1, v1, v65
  v_lshlrev_b32 v64, 16, v25
  v_and_b32 v65, s57, v25
  v_add_f32 v2, v2, v64
  v_add_f32 v3, v3, v65
  v_lshlrev_b32 v64, 16, v26
  v_and_b32 v65, s57, v26
  v_add_f32 v4, v4, v64
  v_add_f32 v5, v5, v65
  v_lshlrev_b32 v64, 16, v27
  v_and_b32 v65, s57, v27
  v_add_f32 v6, v6, v64
  v_add_f32 v7, v7, v65
  v_lshlrev_b32 v64, 16, v36
  v_and_b32 v65, s57, v36
  v_add_f32 v0, v0, v64
  v_add_f32 v1, v1, v65
  v_lshlrev_b32 v64, 16, v37
  v_and_b32 v65, s57, v37
  v_add_f32 v2, v2, v64
  v_add_f32 v3, v3, v65
  v_lshlrev_b32 v64, 16, v38
  v_and_b32 v65, s57, v38
  v_add_f32 v4, v4, v64
  v_add_f32 v5, v5, v65
  v_lshlrev_b32 v64, 16, v39
  v_and_b32 v65, s57, v39
  v_add_f32 v6, v6, v64
  v_add_f32 v7, v7, v65
  v_lshlrev_b32 v64, 16, v48
  v_and_b32 v65, s57, v48
  v_add_f32 v0, v0, v64
  v_add_f32 v1, v1, v65
  v_lshlrev_b32 v64, 16, v49
  v_and_b32 v65, s57, v49
  v_add_f32 v2, v2, v64
  v_add_f32 v3, v3, v65
  v_lshlrev_b32 v64, 16, v50
  v_and_b32 v65, s57, v50
  v_add_f32 v4, v4, v64
  v_add_f32 v5, v5, v65
  v_lshlrev_b32 v64, 16, v51
  v_and_b32 v65, s57, v51
  v_add_f32 v6, v6, v64
  v_add_f32 v7, v7, v65
  v_cvt_pk_bf16_f32 v136, v0, v1
  v_cvt_pk_bf16_f32 v137, v2, v3
  v_cvt_pk_bf16_f32 v138, v4, v5
  v_cvt_pk_bf16_f32 v139, v6, v7
  s_nop 0
  v_permlane32_swap_b32 v136, v138
  v_permlane32_swap_b32 v137, v139
  s_nop 0
  v_permlane16_swap_b32 v136, v138
  v_permlane16_swap_b32 v137, v139
  buffer_store_dwordx4 v[136:139], v184, s[32:35], 0 offen offset:0 nt
  s_waitcnt vmcnt(4)
  v_lshlrev_b32 v64, 16, v28
  v_and_b32 v65, s57, v28
  v_add_f32 v8, v8, v64
  v_add_f32 v9, v9, v65
  v_lshlrev_b32 v64, 16, v29
  v_and_b32 v65, s57, v29
  v_add_f32 v10, v10, v64
  v_add_f32 v11, v11, v65
  v_lshlrev_b32 v64, 16, v30
  v_and_b32 v65, s57, v30
  v_add_f32 v12, v12, v64
  v_add_f32 v13, v13, v65
  v_lshlrev_b32 v64, 16, v31
  v_and_b32 v65, s57, v31
  v_add_f32 v14, v14, v64
  v_add_f32 v15, v15, v65
  v_lshlrev_b32 v64, 16, v40
  v_and_b32 v65, s57, v40
  v_add_f32 v8, v8, v64
  v_add_f32 v9, v9, v65
  v_lshlrev_b32 v64, 16, v41
  v_and_b32 v65, s57, v41
  v_add_f32 v10, v10, v64
  v_add_f32 v11, v11, v65
  v_lshlrev_b32 v64, 16, v42
  v_and_b32 v65, s57, v42
  v_add_f32 v12, v12, v64
  v_add_f32 v13, v13, v65
  v_lshlrev_b32 v64, 16, v43
  v_and_b32 v65, s57, v43
  v_add_f32 v14, v14, v64
  v_add_f32 v15, v15, v65
  v_lshlrev_b32 v64, 16, v52
  v_and_b32 v65, s57, v52
  v_add_f32 v8, v8, v64
  v_add_f32 v9, v9, v65
  v_lshlrev_b32 v64, 16, v53
  v_and_b32 v65, s57, v53
  v_add_f32 v10, v10, v64
  v_add_f32 v11, v11, v65
  v_lshlrev_b32 v64, 16, v54
  v_and_b32 v65, s57, v54
  v_add_f32 v12, v12, v64
  v_add_f32 v13, v13, v65
  v_lshlrev_b32 v64, 16, v55
  v_and_b32 v65, s57, v55
  v_add_f32 v14, v14, v64
  v_add_f32 v15, v15, v65
  v_cvt_pk_bf16_f32 v140, v8, v9
  v_cvt_pk_bf16_f32 v141, v10, v11
  v_cvt_pk_bf16_f32 v142, v12, v13
  v_cvt_pk_bf16_f32 v143, v14, v15
  s_nop 0
  v_permlane32_swap_b32 v140, v142
  v_permlane32_swap_b32 v141, v143
  s_nop 0
  v_permlane16_swap_b32 v140, v142
  v_permlane16_swap_b32 v141, v143
  buffer_store_dwordx4 v[140:143], v184, s[32:35], 0 offen offset:64 nt
  s_waitcnt vmcnt(2)
  v_lshlrev_b32 v64, 16, v32
  v_and_b32 v65, s57, v32
  v_add_f32 v16, v16, v64
  v_add_f32 v17, v17, v65
  v_lshlrev_b32 v64, 16, v33
  v_and_b32 v65, s57, v33
  v_add_f32 v18, v18, v64
  v_add_f32 v19, v19, v65
  v_lshlrev_b32 v64, 16, v34
  v_and_b32 v65, s57, v34
  v_add_f32 v20, v20, v64
  v_add_f32 v21, v21, v65
  v_lshlrev_b32 v64, 16, v35
  v_and_b32 v65, s57, v35
  v_add_f32 v22, v22, v64
  v_add_f32 v23, v23, v65
  v_lshlrev_b32 v64, 16, v44
  v_and_b32 v65, s57, v44
  v_add_f32 v16, v16, v64
  v_add_f32 v17, v17, v65
  v_lshlrev_b32 v64, 16, v45
  v_and_b32 v65, s57, v45
  v_add_f32 v18, v18, v64
  v_add_f32 v19, v19, v65
  v_lshlrev_b32 v64, 16, v46
  v_and_b32 v65, s57, v46
  v_add_f32 v20, v20, v64
  v_add_f32 v21, v21, v65
  v_lshlrev_b32 v64, 16, v47
  v_and_b32 v65, s57, v47
  v_add_f32 v22, v22, v64
  v_add_f32 v23, v23, v65
  v_lshlrev_b32 v64, 16, v56
  v_and_b32 v65, s57, v56
  v_add_f32 v16, v16, v64
  v_add_f32 v17, v17, v65
  v_lshlrev_b32 v64, 16, v57
  v_and_b32 v65, s57, v57
  v_add_f32 v18, v18, v64
  v_add_f32 v19, v19, v65
  v_lshlrev_b32 v64, 16, v58
  v_and_b32 v65, s57, v58
  v_add_f32 v20, v20, v64
  v_add_f32 v21, v21, v65
  v_lshlrev_b32 v64, 16, v59
  v_and_b32 v65, s57, v59
  v_add_f32 v22, v22, v64
  v_add_f32 v23, v23, v65
  v_cvt_pk_bf16_f32 v144, v16, v17
  v_cvt_pk_bf16_f32 v145, v18, v19
  v_cvt_pk_bf16_f32 v146, v20, v21
  v_cvt_pk_bf16_f32 v147, v22, v23
  s_nop 0
  v_permlane32_swap_b32 v144, v146
  v_permlane32_swap_b32 v145, v147
  s_nop 0
  v_permlane16_swap_b32 v144, v146
  v_permlane16_swap_b32 v145, v147
  buffer_store_dwordx4 v[144:147], v184, s[32:35], 0 offen offset:128 nt
  s_branch .Lk1_e_6
.Lk1_b_5:
  s_lshl_b32 s3, s2, 3
  s_add_u32 s3, s3, s87
  s_cmp_eq_u32 s3, 4
  s_cbranch_scc1 .Lk1_o_71
.Lk1_k_72:
  s_mov_b32 s58, 0
  s_and_b32 s58, s58, 7
  s_lshl_b32 s58, s58, 14
  s_lshl_b32 s3, s52, 5
  s_add_u32 s3, s3, s51
  s_lshl_b32 s3, s3, 17
  s_add_u32 s10, s10, s3
  s_addc_u32 s11, s11, 0
  s_mov_b32 s36, s10
  s_and_b32 s37, s11, 0xffff
  s_mov_b32 s38, 262144
  s_mov_b32 s39, 0x20000
  s_add_u32 s12, s12, s3
  s_addc_u32 s13, s13, 0
  s_mov_b32 s40, s12
  s_and_b32 s41, s13, 0xffff
  s_mov_b32 s42, 262144
  s_mov_b32 s43, 0x20000
  s_mul_i32 s3, s50, 72
  s_mul_i32 s26, s52, 9
  s_add_u32 s3, s3, s26
  s_lshl_b32 s3, s3, 7
  s_lshl_b32 s26, s51, 2
  s_add_u32 s3, s3, s26
  s_lshl_b32 s3, s3, 10
  s_add_u32 s24, s24, s3
  s_addc_u32 s25, s25, 0
  s_mov_b32 s44, s24
  s_and_b32 s45, s25, 0xffff
  s_mov_b32 s46, 1056768
  s_mov_b32 s47, 0x20000
  v_add_u32 v7, 0, v4
  v_lshrrev_b32 v9, 3, v7
  v_lshrrev_b32 v10, 2, v7
  v_xor_b32 v10, v10, v9
  v_and_b32 v10, 1, v10
  v_lshl_or_b32 v9, v10, 1, v9
  v_and_b32 v8, 3, v7
  v_lshl_or_b32 v8, v8, 2, v9
  v_xor_b32 v8, v8, v3
  v_lshlrev_b32 v8, 4, v8
  v_lshl_add_u32 v8, v4, 8, v8
  v_add_u32 v152, s59, v8
  v_add_u32 v7, 4, v4
  v_lshrrev_b32 v9, 3, v7
  v_lshrrev_b32 v10, 2, v7
  v_xor_b32 v10, v10, v9
  v_and_b32 v10, 1, v10
  v_lshl_or_b32 v9, v10, 1, v9
  v_and_b32 v8, 3, v7
  v_lshl_or_b32 v8, v8, 2, v9
  v_xor_b32 v8, v8, v3
  v_lshlrev_b32 v8, 4, v8
  v_lshl_add_u32 v8, v4, 8, v8
  v_add_u32 v153, s59, v8
  v_add_u32 v7, 8, v4
  v_lshrrev_b32 v9, 3, v7
  v_lshrrev_b32 v10, 2, v7
  v_xor_b32 v10, v10, v9
  v_and_b32 v10, 1, v10
  v_lshl_or_b32 v9, v10, 1, v9
  v_and_b32 v8, 3, v7
  v_lshl_or_b32 v8, v8, 2, v9
  v_xor_b32 v8, v8, v3
  v_lshlrev_b32 v8, 4, v8
  v_lshl_add_u32 v8, v4, 8, v8
  v_add_u32 v154, s59, v8
  v_add_u32 v7, 12, v4
  v_lshrrev_b32 v9, 3, v7
  v_lshrrev_b32 v10, 2, v7
  v_xor_b32 v10, v10, v9
  v_and_b32 v10, 1, v10
  v_lshl_or_b32 v9, v10, 1, v9
  v_and_b32 v8, 3, v7
  v_lshl_or_b32 v8, v8, 2, v9
  v_xor_b32 v8, v8, v3
  v_lshlrev_b32 v8, 4, v8
  v_lshl_add_u32 v8, v4, 8, v8
  v_add_u32 v155, s59, v8
  v_lshrrev_b32 v9, 3, v3
  v_lshrrev_b32 v10, 2, v3
  v_xor_b32 v10, v10, v9
  v_and_b32 v10, 1, v10
  v_lshl_or_b32 v9, v10, 1, v9
  v_and_b32 v8, 3, v3
  v_lshl_or_b32 v8, v8, 2, v9
  v_xor_b32 v8, v8, v4
  v_lshlrev_b32 v8, 4, v8
  v_lshl_add_u32 v8, v3, 8, v8
  v_add_u32 v161, s59, v8
  v_xor_b32 v162, 64, v161
  v_xor_b32 v163, 128, v161
  v_xor_b32 v164, 192, v161
  v_lshl_add_u32 v7, v4, 2, v5
  v_and_b32 v11, 15, v7
  v_lshrrev_b32 v9, 3, v11
  v_lshrrev_b32 v10, 2, v11
  v_xor_b32 v10, v10, v9
  v_and_b32 v10, 1, v10
  v_lshl_or_b32 v9, v10, 1, v9
  v_and_b32 v8, 3, v11
  v_lshl_or_b32 v8, v8, 2, v9
  v_lshrrev_b32 v9, 1, v6
  v_xor_b32 v8, v8, v9
  s_lshl_b32 s3, s4, 2
  v_xor_b32 v8, s3, v8
  v_lshlrev_b32 v8, 4, v8
  v_and_b32 v9, 1, v6
  v_lshl_or_b32 v8, v9, 3, v8
  v_lshl_add_u32 v8, v7, 8, v8
  v_add_u32 v8, s59, v8
  v_add_u32 v165, 32768, v8
  v_xor_b32 v166, 32, v165
  v_xor_b32 v167, 64, v165
  v_xor_b32 v168, 96, v165
  v_xor_b32 v169, 128, v165
  v_xor_b32 v170, 160, v165
  v_xor_b32 v171, 192, v165
  v_xor_b32 v172, 224, v165
  v_lshl_add_u32 v7, v4, 3, v5
  v_and_b32 v11, 15, v7
  v_lshrrev_b32 v9, 3, v11
  v_lshrrev_b32 v10, 2, v11
  v_xor_b32 v10, v10, v9
  v_and_b32 v10, 1, v10
  v_lshl_or_b32 v9, v10, 1, v9
  v_and_b32 v8, 3, v11
  v_lshl_or_b32 v8, v8, 2, v9
  v_lshrrev_b32 v9, 1, v6
  v_xor_b32 v8, v8, v9
  s_lshl_b32 s3, s4, 2
  v_xor_b32 v8, s3, v8
  v_lshlrev_b32 v8, 4, v8
  v_and_b32 v9, 1, v6
  v_lshl_or_b32 v8, v9, 3, v8
  v_lshl_add_u32 v8, v7, 8, v8
  v_add_u32 v173, 9216, v8
  v_xor_b32 v174, 32, v173
  v_sub_u32 v8, 4, v5
  v_and_b32 v8, 3, v8
  v_xor_b32 v8, v8, v4
  v_lshlrev_b32 v8, 4, v8
  v_lshl_add_u32 v8, v3, 6, v8
  v_add_u32 v175, 8192, v8
  v_lshlrev_b32 v176, 4, v191
  v_add_u32 v183, 51200, v173
  v_add_u32 v184, 51200, v174
  v_add_u32 v185, 51200, v175
  v_add_u32 v177, -1024, v187
  v_mov_b32 v135, 536870912
  s_waitcnt vmcnt(2)
  s_barrier
  s_add_u32 m0, s5, 102400
  s_nop 0
  buffer_load_dwordx4 v158, s[28:31], s53 offen  lds
  s_add_u32 m0, s5, 106496
  s_nop 0
  buffer_load_dwordx4 v159, s[28:31], s53 offen  lds
  s_cmp_eq_u32 s4, 2
  s_cbranch_scc0 .Lk1_s_73
  s_mov_b32 m0, 110592
  s_nop 0
  buffer_load_dwordx4 v160, s[28:31], s53 offen  lds
.Lk1_s_73:
  s_add_u32 s53, s53, 64
  s_cmp_eq_u32 s53, 1152
  s_cselect_b32 s53, 0, s53
  ds_read_b128 v[72:75], v185 offset:0
  ds_read_b64_tr_b16 v[76:77], v183 offset:0
  ds_read_b64_tr_b16 v[78:79], v184 offset:1024
  ds_read_b64_tr_b16 v[80:81], v184 offset:0
  ds_read_b64_tr_b16 v[82:83], v183 offset:1024
  ds_read_b64_tr_b16 v[64:65], v183 offset:8192
  ds_read_b64_tr_b16 v[66:67], v184 offset:9216
  ds_read_b64_tr_b16 v[68:69], v184 offset:8192
  ds_read_b64_tr_b16 v[70:71], v183 offset:9216
  s_add_u32 m0, s5, 0
  s_nop 0
  buffer_load_dwordx4 v158, s[28:31], s53 offen  lds
  s_add_u32 m0, s5, 4096
  s_nop 0
  buffer_load_dwordx4 v159, s[28:31], s53 offen  lds
  s_cmp_eq_u32 s4, 3
  s_cbranch_scc0 .Lk1_s_74
  s_mov_b32 m0, 8192
  s_nop 0
  buffer_load_dwordx4 v160, s[28:31], s53 offen  lds
.Lk1_s_74:
  s_add_u32 s53, s53, 64
  s_cmp_eq_u32 s53, 1152
  s_cselect_b32 s53, 0, s53
  s_waitcnt lgkmcnt(6)
  v_mfma_f32_16x16x32_bf16 v[136:139], v[76:79], v[72:75], 0
  s_waitcnt lgkmcnt(4)
  v_mfma_f32_16x16x32_bf16 v[140:143], v[80:83], v[72:75], 0
  s_waitcnt lgkmcnt(2)
  v_mfma_f32_16x16x32_bf16 v[144:147], v[64:67], v[72:75], 0
  s_waitcnt lgkmcnt(0)
  v_mfma_f32_16x16x32_bf16 v[148:151], v[68:71], v[72:75], 0
  s_waitcnt vmcnt(4)
  s_barrier
  ds_read_b128 v[72:75], v185 offset:25600
  ds_read_b64_tr_b16 v[76:77], v183 offset:25600
  ds_read_b64_tr_b16 v[78:79], v184 offset:26624
  ds_read_b64_tr_b16 v[80:81], v184 offset:25600
  ds_read_b64_tr_b16 v[82:83], v183 offset:26624
  ds_read_b64_tr_b16 v[64:65], v183 offset:33792
  ds_read_b64_tr_b16 v[66:67], v184 offset:34816
  ds_read_b64_tr_b16 v[68:69], v184 offset:33792
  ds_read_b64_tr_b16 v[70:71], v183 offset:34816
  s_add_u32 m0, s5, 25600
  s_nop 0
  buffer_load_dwordx4 v158, s[28:31], s53 offen  lds
  s_add_u32 m0, s5, 29696
  s_nop 0
  buffer_load_dwordx4 v159, s[28:31], s53 offen  lds
  s_cmp_eq_u32 s4, 0
  s_cbranch_scc0 .Lk1_s_75
  s_mov_b32 m0, 33792
  s_nop 0
  buffer_load_dwordx4 v160, s[28:31], s53 offen  lds
.Lk1_s_75:
  s_add_u32 s53, s53, 64
  s_cmp_eq_u32 s53, 1152
  s_cselect_b32 s53, 0, s53
  s_waitcnt lgkmcnt(6)
  v_mfma_f32_16x16x32_bf16 v[136:139], v[76:79], v[72:75], v[136:139]
  s_waitcnt lgkmcnt(4)
  v_mfma_f32_16x16x32_bf16 v[140:143], v[80:83], v[72:75], v[140:143]
  s_waitcnt lgkmcnt(2)
  v_mfma_f32_16x16x32_bf16 v[144:147], v[64:67], v[72:75], v[144:147]
  s_waitcnt lgkmcnt(0)
  v_mfma_f32_16x16x32_bf16 v[148:151], v[68:71], v[72:75], v[148:151]
  s_waitcnt vmcnt(4)
  s_barrier
  ds_read_b128 v[72:75], v185 offset:51200
  ds_read_b64_tr_b16 v[76:77], v183 offset:51200
  ds_read_b64_tr_b16 v[78:79], v184 offset:52224
  ds_read_b64_tr_b16 v[80:81], v184 offset:51200
  ds_read_b64_tr_b16 v[82:83], v183 offset:52224
  ds_read_b64_tr_b16 v[64:65], v183 offset:59392
  ds_read_b64_tr_b16 v[66:67], v184 offset:60416
  ds_read_b64_tr_b16 v[68:69], v184 offset:59392
  ds_read_b64_tr_b16 v[70:71], v183 offset:60416
  s_add_u32 m0, s5, 51200
  s_nop 0
  buffer_load_dwordx4 v158, s[28:31], s53 offen  lds
  s_add_u32 m0, s5, 55296
  s_nop 0
  buffer_load_dwordx4 v159, s[28:31], s53 offen  lds
  s_cmp_eq_u32 s4, 1
  s_cbranch_scc0 .Lk1_s_76
  s_mov_b32 m0, 59392
  s_nop 0
  buffer_load_dwordx4 v160, s[28:31], s53 offen  lds
.Lk1_s_76:
  s_add_u32 s53, s53, 64
  s_cmp_eq_u32 s53, 1152
  s_cselect_b32 s53, 0, s53
  s_waitcnt lgkmcnt(6)
  v_mfma_f32_16x16x32_bf16 v[136:139], v[76:79], v[72:75], v[136:139]
  s_waitcnt lgkmcnt(4)
  v_mfma_f32_16x16x32_bf16 v[140:143], v[80:83], v[72:75], v[140:143]
  s_waitcnt lgkmcnt(2)
  v_mfma_f32_16x16x32_bf16 v[144:147], v[64:67], v[72:75], v[144:147]
  s_waitcnt lgkmcnt(0)
  v_mfma_f32_16x16x32_bf16 v[148:151], v[68:71], v[72:75], v[148:151]
  s_waitcnt vmcnt(4)
  s_barrier
  ds_read_b128 v[72:75], v175 offset:0
  ds_read_b64_tr_b16 v[76:77], v173 offset:0
  ds_read_b64_tr_b16 v[78:79], v174 offset:1024
  ds_read_b64_tr_b16 v[80:81], v174 offset:0
  ds_read_b64_tr_b16 v[82:83], v173 offset:1024
  ds_read_b64_tr_b16 v[64:65], v173 offset:8192
  ds_read_b64_tr_b16 v[66:67], v174 offset:9216
  ds_read_b64_tr_b16 v[68:69], v174 offset:8192
  ds_read_b64_tr_b16 v[70:71], v173 offset:9216
  s_add_u32 m0, s5, 76800
  s_nop 0
  buffer_load_dwordx4 v158, s[28:31], s53 offen  lds
  s_add_u32 m0, s5, 80896
  s_nop 0
  buffer_load_dwordx4 v159, s[28:31], s53 offen  lds
  s_cmp_eq_u32 s4, 2
  s_cbranch_scc0 .Lk1_s_77
  s_mov_b32 m0, 84992
  s_nop 0
  buffer_load_dwordx4 v160, s[28:31], s53 offen  lds
.Lk1_s_77:
  s_add_u32 s53, s53, 64
  s_cmp_eq_u32 s53, 1152
  s_cselect_b32 s53, 0, s53
  s_mov_b32 s26, 65536
  buffer_load_dwordx4 v[192:195], v152, s[40:43], s26 offen offset:0 nt
  buffer_load_dwordx4 v[196:199], v153, s[40:43], s26 offen offset:1024 nt
  buffer_load_dwordx4 v[200:203], v154, s[40:43], s26 offen offset:2048 nt
  buffer_load_dwordx4 v[204:207], v155, s[40:43], s26 offen offset:3072 nt
  s_waitcnt lgkmcnt(6)
  v_mfma_f32_16x16x32_bf16 v[136:139], v[76:79], v[72:75], v[136:139]
  s_waitcnt lgkmcnt(4)
  v_mfma_f32_16x16x32_bf16 v[140:143], v[80:83], v[72:75], v[140:143]
  s_waitcnt lgkmcnt(2)
  v_mfma_f32_16x16x32_bf16 v[144:147], v[64:67], v[72:75], v[144:147]
  s_waitcnt lgkmcnt(0)
  v_mfma_f32_16x16x32_bf16 v[148:151], v[68:71], v[72:75], v[148:151]
  s_waitcnt vmcnt(8)
  s_barrier
  ds_read_b128 v[72:75], v175 offset:25600
  ds_read_b64_tr_b16 v[76:77], v173 offset:25600
  ds_read_b64_tr_b16 v[78:79], v174 offset:26624
  ds_read_b64_tr_b16 v[80:81], v174 offset:25600
  ds_read_b64_tr_b16 v[82:83], v173 offset:26624
  ds_read_b64_tr_b16 v[64:65], v173 offset:33792
  ds_read_b64_tr_b16 v[66:67], v174 offset:34816
  ds_read_b64_tr_b16 v[68:69], v174 offset:33792
  ds_read_b64_tr_b16 v[70:71], v173 offset:34816
  s_add_u32 m0, s5, 102400
  s_nop 0
  buffer_load_dwordx4 v158, s[28:31], s53 offen  lds
  s_add_u32 m0, s5, 106496
  s_nop 0
  buffer_load_dwordx4 v159, s[28:31], s53 offen  lds
  s_cmp_eq_u32 s4, 3
  s_cbranch_scc0 .Lk1_s_78
  s_mov_b32 m0, 110592
  s_nop 0
  buffer_load_dwordx4 v160, s[28:31], s53 offen  lds
.Lk1_s_78:
  s_add_u32 s53, s53, 64
  s_cmp_eq_u32 s53, 1152
  s_cselect_b32 s53, 0, s53
  s_waitcnt lgkmcnt(6)
  v_mfma_f32_16x16x32_bf16 v[136:139], v[76:79], v[72:75], v[136:139]
  s_waitcnt lgkmcnt(4)
  v_mfma_f32_16x16x32_bf16 v[140:143], v[80:83], v[72:75], v[140:143]
  s_waitcnt lgkmcnt(2)
  v_mfma_f32_16x16x32_bf16 v[144:147], v[64:67], v[72:75], v[144:147]
  s_waitcnt lgkmcnt(0)
  v_mfma_f32_16x16x32_bf16 v[148:151], v[68:71], v[72:75], v[148:151]
  s_waitcnt vmcnt(8)
  s_barrier
  ds_read_b128 v[72:75], v185 offset:0
  ds_read_b64_tr_b16 v[76:77], v183 offset:0
  ds_read_b64_tr_b16 v[78:79], v184 offset:1024
  ds_read_b64_tr_b16 v[80:81], v184 offset:0
  ds_read_b64_tr_b16 v[82:83], v183 offset:1024
  ds_read_b64_tr_b16 v[64:65], v183 offset:8192
  ds_read_b64_tr_b16 v[66:67], v184 offset:9216
  ds_read_b64_tr_b16 v[68:69], v184 offset:8192
  ds_read_b64_tr_b16 v[70:71], v183 offset:9216
  s_add_u32 m0, s5, 0
  s_nop 0
  buffer_load_dwordx4 v158, s[28:31], s53 offen  lds
  s_add_u32 m0, s5, 4096
  s_nop 0
  buffer_load_dwordx4 v159, s[28:31], s53 offen  lds
  s_cmp_eq_u32 s4, 0
  s_cbranch_scc0 .Lk1_s_79
  s_mov_b32 m0, 8192
  s_nop 0
  buffer_load_dwordx4 v160, s[28:31], s53 offen  lds
.Lk1_s_79:
  s_add_u32 s53, s53, 64
  s_cmp_eq_u32 s53, 1152
  s_cselect_b32 s53, 0, s53
  s_waitcnt lgkmcnt(6)
  v_mfma_f32_16x16x32_bf16 v[136:139], v[76:79], v[72:75], v[136:139]
  s_waitcnt lgkmcnt(4)
  v_mfma_f32_16x16x32_bf16 v[140:143], v[80:83], v[72:75], v[140:143]
  s_waitcnt lgkmcnt(2)
  v_mfma_f32_16x16x32_bf16 v[144:147], v[64:67], v[72:75], v[144:147]
  s_waitcnt lgkmcnt(0)
  v_mfma_f32_16x16x32_bf16 v[148:151], v[68:71], v[72:75], v[148:151]
  s_waitcnt vmcnt(8)
  s_barrier
  ds_read_b128 v[72:75], v185 offset:25600
  ds_read_b64_tr_b16 v[76:77], v183 offset:25600
  ds_read_b64_tr_b16 v[78:79], v184 offset:26624
  ds_read_b64_tr_b16 v[80:81], v184 offset:25600
  ds_read_b64_tr_b16 v[82:83], v183 offset:26624
  ds_read_b64_tr_b16 v[64:65], v183 offset:33792
  ds_read_b64_tr_b16 v[66:67], v184 offset:34816
  ds_read_b64_tr_b16 v[68:69], v184 offset:33792
  ds_read_b64_tr_b16 v[70:71], v183 offset:34816
  s_add_u32 m0, s5, 25600
  s_nop 0
  buffer_load_dwordx4 v158, s[28:31], s53 offen  lds
  s_add_u32 m0, s5, 29696
  s_nop 0
  buffer_load_dwordx4 v159, s[28:31], s53 offen  lds
  s_cmp_eq_u32 s4, 1
  s_cbranch_scc0 .Lk1_s_80
  s_mov_b32 m0, 33792
  s_nop 0
  buffer_load_dwordx4 v160, s[28:31], s53 offen  lds
.Lk1_s_80:
  s_add_u32 s53, s53, 64
  s_cmp_eq_u32 s53, 1152
  s_cselect_b32 s53, 0, s53
  s_mov_b32 s26, 98304
  buffer_load_dwordx4 v[208:211], v152, s[40:43], s26 offen offset:0 nt
  buffer_load_dwordx4 v[212:215], v153, s[40:43], s26 offen offset:1024 nt
  buffer_load_dwordx4 v[216:219], v154, s[40:43], s26 offen offset:2048 nt
  buffer_load_dwordx4 v[220:223], v155, s[40:43], s26 offen offset:3072 nt
  s_waitcnt lgkmcnt(6)
  v_mfma_f32_16x16x32_bf16 v[136:139], v[76:79], v[72:75], v[136:139]
  s_waitcnt lgkmcnt(4)
  v_mfma_f32_16x16x32_bf16 v[140:143], v[80:83], v[72:75], v[140:143]
  s_waitcnt lgkmcnt(2)
  v_mfma_f32_16x16x32_bf16 v[144:147], v[64:67], v[72:75], v[144:147]
  s_waitcnt lgkmcnt(0)
  v_mfma_f32_16x16x32_bf16 v[148:151], v[68:71], v[72:75], v[148:151]
  s_waitcnt vmcnt(8)
  s_barrier
  ds_read_b128 v[72:75], v185 offset:51200
  ds_read_b64_tr_b16 v[76:77], v183 offset:51200
  ds_read_b64_tr_b16 v[78:79], v184 offset:52224
  ds_read_b64_tr_b16 v[80:81], v184 offset:51200
  ds_read_b64_tr_b16 v[82:83], v183 offset:52224
  ds_read_b64_tr_b16 v[64:65], v183 offset:59392
  ds_read_b64_tr_b16 v[66:67], v184 offset:60416
  ds_read_b64_tr_b16 v[68:69], v184 offset:59392
  ds_read_b64_tr_b16 v[70:71], v183 offset:60416
  s_add_u32 m0, s5, 51200
  s_nop 0
  buffer_load_dwordx4 v158, s[28:31], s53 offen  lds
  s_add_u32 m0, s5, 55296
  s_nop 0
  buffer_load_dwordx4 v159, s[28:31], s53 offen  lds
  s_cmp_eq_u32 s4, 2
  s_cbranch_scc0 .Lk1_s_81
  s_mov_b32 m0, 59392
  s_nop 0
  buffer_load_dwordx4 v160, s[28:31], s53 offen  lds
.Lk1_s_81:
  s_add_u32 s53, s53, 64
  s_cmp_eq_u32 s53, 1152
  s_cselect_b32 s53, 0, s53
  s_waitcnt lgkmcnt(6)
  v_mfma_f32_16x16x32_bf16 v[136:139], v[76:79], v[72:75], v[136:139]
  s_waitcnt lgkmcnt(4)
  v_mfma_f32_16x16x32_bf16 v[140:143], v[80:83], v[72:75], v[140:143]
  s_waitcnt lgkmcnt(2)
  v_mfma_f32_16x16x32_bf16 v[144:147], v[64:67], v[72:75], v[144:147]
  s_waitcnt lgkmcnt(0)
  v_mfma_f32_16x16x32_bf16 v[148:151], v[68:71], v[72:75], v[148:151]
  s_waitcnt vmcnt(8)
  s_barrier
  ds_read_b128 v[72:75], v175 offset:0
  ds_read_b64_tr_b16 v[76:77], v173 offset:0
  ds_read_b64_tr_b16 v[78:79], v174 offset:1024
  ds_read_b64_tr_b16 v[80:81], v174 offset:0
  ds_read_b64_tr_b16 v[82:83], v173 offset:1024
  ds_read_b64_tr_b16 v[64:65], v173 offset:8192
  ds_read_b64_tr_b16 v[66:67], v174 offset:9216
  ds_read_b64_tr_b16 v[68:69], v174 offset:8192
  ds_read_b64_tr_b16 v[70:71], v173 offset:9216
  s_add_u32 m0, s5, 76800
  s_nop 0
  buffer_load_dwordx4 v158, s[28:31], s53 offen  lds
  s_add_u32 m0, s5, 80896
  s_nop 0
  buffer_load_dwordx4 v159, s[28:31], s53 offen  lds
  s_cmp_eq_u32 s4, 3
  s_cbranch_scc0 .Lk1_s_82
  s_mov_b32 m0, 84992
  s_nop 0
  buffer_load_dwordx4 v160, s[28:31], s53 offen  lds
.Lk1_s_82:
  s_add_u32 s53, s53, 64
  s_cmp_eq_u32 s53, 1152
  s_cselect_b32 s53, 0, s53
  s_waitcnt lgkmcnt(6)
  v_mfma_f32_16x16x32_bf16 v[136:139], v[76:79], v[72:75], v[136:139]
  s_waitcnt lgkmcnt(4)
  v_mfma_f32_16x16x32_bf16 v[140:143], v[80:83], v[72:75], v[140:143]
  s_waitcnt lgkmcnt(2)
  v_mfma_f32_16x16x32_bf16 v[144:147], v[64:67], v[72:75], v[144:147]
  s_waitcnt lgkmcnt(0)
  v_mfma_f32_16x16x32_bf16 v[148:151], v[68:71], v[72:75], v[148:151]
  s_waitcnt vmcnt(8)
  s_barrier
  ds_read_b128 v[72:75], v175 offset:25600
  ds_read_b64_tr_b16 v[76:77], v173 offset:25600
  ds_read_b64_tr_b16 v[78:79], v174 offset:26624
  ds_read_b64_tr_b16 v[80:81], v174 offset:25600
  ds_read_b64_tr_b16 v[82:83], v173 offset:26624
  ds_read_b64_tr_b16 v[64:65], v173 offset:33792
  ds_read_b64_tr_b16 v[66:67], v174 offset:34816
  ds_read_b64_tr_b16 v[68:69], v174 offset:33792
  ds_read_b64_tr_b16 v[70:71], v173 offset:34816
  s_add_u32 m0, s5, 102400
  s_nop 0
  buffer_load_dwordx4 v158, s[28:31], s53 offen  lds
  s_add_u32 m0, s5, 106496
  s_nop 0
  buffer_load_dwordx4 v159, s[28:31], s53 offen  lds
  s_cmp_eq_u32 s4, 0
  s_cbranch_scc0 .Lk1_s_83
  s_mov_b32 m0, 110592
  s_nop 0
  buffer_load_dwordx4 v160, s[28:31], s53 offen  lds
.Lk1_s_83:
  s_add_u32 s53, s53, 64
  s_cmp_eq_u32 s53, 1152
  s_cselect_b32 s53, 0, s53
  s_mov_b32 s26, 196608
  buffer_load_dwordx4 v[224:227], v152, s[40:43], s26 offen offset:0 nt
  buffer_load_dwordx4 v[228:231], v153, s[40:43], s26 offen offset:1024 nt
  buffer_load_dwordx4 v[232:235], v154, s[40:43], s26 offen offset:2048 nt
  buffer_load_dwordx4 v[236:239], v155, s[40:43], s26 offen offset:3072 nt
  s_waitcnt lgkmcnt(6)
  v_mfma_f32_16x16x32_bf16 v[136:139], v[76:79], v[72:75], v[136:139]
  s_waitcnt lgkmcnt(4)
  v_mfma_f32_16x16x32_bf16 v[140:143], v[80:83], v[72:75], v[140:143]
  s_waitcnt lgkmcnt(2)
  v_mfma_f32_16x16x32_bf16 v[144:147], v[64:67], v[72:75], v[144:147]
  s_waitcnt lgkmcnt(0)
  v_mfma_f32_16x16x32_bf16 v[148:151], v[68:71], v[72:75], v[148:151]
  s_waitcnt vmcnt(8)
  s_barrier
  ds_read_b128 v[72:75], v185 offset:0
  ds_read_b64_tr_b16 v[76:77], v183 offset:0
  ds_read_b64_tr_b16 v[78:79], v184 offset:1024
  ds_read_b64_tr_b16 v[80:81], v184 offset:0
  ds_read_b64_tr_b16 v[82:83], v183 offset:1024
  ds_read_b64_tr_b16 v[64:65], v183 offset:8192
  ds_read_b64_tr_b16 v[66:67], v184 offset:9216
  ds_read_b64_tr_b16 v[68:69], v184 offset:8192
  ds_read_b64_tr_b16 v[70:71], v183 offset:9216
  s_add_u32 m0, s5, 0
  s_nop 0
  buffer_load_dwordx4 v158, s[28:31], s53 offen  lds
  s_add_u32 m0, s5, 4096
  s_nop 0
  buffer_load_dwordx4 v159, s[28:31], s53 offen  lds
  s_cmp_eq_u32 s4, 1
  s_cbranch_scc0 .Lk1_s_84
  s_mov_b32 m0, 8192
  s_nop 0
  buffer_load_dwordx4 v160, s[28:31], s53 offen  lds
.Lk1_s_84:
  s_add_u32 s53, s53, 64
  s_cmp_eq_u32 s53, 1152
  s_cselect_b32 s53, 0, s53
  s_waitcnt lgkmcnt(6)
  v_mfma_f32_16x16x32_bf16 v[136:139], v[76:79], v[72:75], v[136:139]
  s_waitcnt lgkmcnt(4)
  v_mfma_f32_16x16x32_bf16 v[140:143], v[80:83], v[72:75], v[140:143]
  s_waitcnt lgkmcnt(2)
  v_mfma_f32_16x16x32_bf16 v[144:147], v[64:67], v[72:75], v[144:147]
  s_waitcnt lgkmcnt(0)
  v_mfma_f32_16x16x32_bf16 v[148:151], v[68:71], v[72:75], v[148:151]
  s_waitcnt vmcnt(8)
  s_barrier
  ds_read_b128 v[72:75], v185 offset:25600
  ds_read_b64_tr_b16 v[76:77], v183 offset:25600
  ds_read_b64_tr_b16 v[78:79], v184 offset:26624
  ds_read_b64_tr_b16 v[80:81], v184 offset:25600
  ds_read_b64_tr_b16 v[82:83], v183 offset:26624
  ds_read_b64_tr_b16 v[64:65], v183 offset:33792
  ds_read_b64_tr_b16 v[66:67], v184 offset:34816
  ds_read_b64_tr_b16 v[68:69], v184 offset:33792
  ds_read_b64_tr_b16 v[70:71], v183 offset:34816
  s_add_u32 m0, s5, 25600
  s_nop 0
  buffer_load_dwordx4 v158, s[28:31], s53 offen  lds
  s_add_u32 m0, s5, 29696
  s_nop 0
  buffer_load_dwordx4 v159, s[28:31], s53 offen  lds
  s_cmp_eq_u32 s4, 2
  s_cbranch_scc0 .Lk1_s_85
  s_mov_b32 m0, 33792
  s_nop 0
  buffer_load_dwordx4 v160, s[28:31], s53 offen  lds
.Lk1_s_85:
  s_add_u32 s53, s53, 64
  s_cmp_eq_u32 s53, 1152
  s_cselect_b32 s53, 0, s53
  s_waitcnt lgkmcnt(6)
  v_mfma_f32_16x16x32_bf16 v[136:139], v[76:79], v[72:75], v[136:139]
  s_waitcnt lgkmcnt(4)
  v_mfma_f32_16x16x32_bf16 v[140:143], v[80:83], v[72:75], v[140:143]
  s_waitcnt lgkmcnt(2)
  v_mfma_f32_16x16x32_bf16 v[144:147], v[64:67], v[72:75], v[144:147]
  s_waitcnt lgkmcnt(0)
  v_mfma_f32_16x16x32_bf16 v[148:151], v[68:71], v[72:75], v[148:151]
  s_waitcnt vmcnt(8)
  s_barrier
  ds_read_b128 v[72:75], v185 offset:51200
  ds_read_b64_tr_b16 v[76:77], v183 offset:51200
  ds_read_b64_tr_b16 v[78:79], v184 offset:52224
  ds_read_b64_tr_b16 v[80:81], v184 offset:51200
  ds_read_b64_tr_b16 v[82:83], v183 offset:52224
  ds_read_b64_tr_b16 v[64:65], v183 offset:59392
  ds_read_b64_tr_b16 v[66:67], v184 offset:60416
  ds_read_b64_tr_b16 v[68:69], v184 offset:59392
  ds_read_b64_tr_b16 v[70:71], v183 offset:60416
  s_add_u32 m0, s5, 51200
  s_nop 0
  buffer_load_dwordx4 v158, s[28:31], s53 offen  lds
  s_add_u32 m0, s5, 55296
  s_nop 0
  buffer_load_dwordx4 v159, s[28:31], s53 offen  lds
  s_cmp_eq_u32 s4, 3
  s_cbranch_scc0 .Lk1_s_86
  s_mov_b32 m0, 59392
  s_nop 0
  buffer_load_dwordx4 v160, s[28:31], s53 offen  lds
.Lk1_s_86:
  s_add_u32 s53, s53, 64
  s_cmp_eq_u32 s53, 1152
  s_cselect_b32 s53, 0, s53
  s_mov_b32 s26, 229376
  buffer_load_dwordx4 v[240:243], v152, s[40:43], s26 offen offset:0 nt
  buffer_load_dwordx4 v[244:247], v153, s[40:43], s26 offen offset:1024 nt
  buffer_load_dwordx4 v[248:251], v154, s[40:43], s26 offen offset:2048 nt
  buffer_load_dwordx4 v[252:255], v155, s[40:43], s26 offen offset:3072 nt
  s_waitcnt lgkmcnt(6)
  v_mfma_f32_16x16x32_bf16 v[136:139], v[76:79], v[72:75], v[136:139]
  s_waitcnt lgkmcnt(4)
  v_mfma_f32_16x16x32_bf16 v[140:143], v[80:83], v[72:75], v[140:143]
  s_waitcnt lgkmcnt(2)
  v_mfma_f32_16x16x32_bf16 v[144:147], v[64:67], v[72:75], v[144:147]
  s_waitcnt lgkmcnt(0)
  v_mfma_f32_16x16x32_bf16 v[148:151], v[68:71], v[72:75], v[148:151]
  s_waitcnt vmcnt(8)
  s_barrier
  ds_read_b128 v[72:75], v175 offset:0
  ds_read_b64_tr_b16 v[76:77], v173 offset:0
  ds_read_b64_tr_b16 v[78:79], v174 offset:1024
  ds_read_b64_tr_b16 v[80:81], v174 offset:0
  ds_read_b64_tr_b16 v[82:83], v173 offset:1024
  ds_read_b64_tr_b16 v[64:65], v173 offset:8192
  ds_read_b64_tr_b16 v[66:67], v174 offset:9216
  ds_read_b64_tr_b16 v[68:69], v174 offset:8192
  ds_read_b64_tr_b16 v[70:71], v173 offset:9216
  s_add_u32 m0, s5, 76800
  s_nop 0
  buffer_load_dwordx4 v158, s[28:31], s53 offen  lds
  s_add_u32 m0, s5, 80896
  s_nop 0
  buffer_load_dwordx4 v159, s[28:31], s53 offen  lds
  s_cmp_eq_u32 s4, 0
  s_cbranch_scc0 .Lk1_s_87
  s_mov_b32 m0, 84992
  s_nop 0
  buffer_load_dwordx4 v160, s[28:31], s53 offen  lds
.Lk1_s_87:
  s_add_u32 s53, s53, 64
  s_cmp_eq_u32 s53, 1152
  s_cselect_b32 s53, 0, s53
  s_waitcnt lgkmcnt(6)
  v_mfma_f32_16x16x32_bf16 v[136:139], v[76:79], v[72:75], v[136:139]
  s_waitcnt lgkmcnt(4)
  v_mfma_f32_16x16x32_bf16 v[140:143], v[80:83], v[72:75], v[140:143]
  s_waitcnt lgkmcnt(2)
  v_mfma_f32_16x16x32_bf16 v[144:147], v[64:67], v[72:75], v[144:147]
  s_waitcnt lgkmcnt(0)
  v_mfma_f32_16x16x32_bf16 v[148:151], v[68:71], v[72:75], v[148:151]
  s_waitcnt vmcnt(8)
  s_barrier
  ds_read_b128 v[72:75], v175 offset:25600
  ds_read_b64_tr_b16 v[76:77], v173 offset:25600
  ds_read_b64_tr_b16 v[78:79], v174 offset:26624
  ds_read_b64_tr_b16 v[80:81], v174 offset:25600
  ds_read_b64_tr_b16 v[82:83], v173 offset:26624
  ds_read_b64_tr_b16 v[64:65], v173 offset:33792
  ds_read_b64_tr_b16 v[66:67], v174 offset:34816
  ds_read_b64_tr_b16 v[68:69], v174 offset:33792
  ds_read_b64_tr_b16 v[70:71], v173 offset:34816
  s_add_u32 m0, s5, 102400
  s_nop 0
  buffer_load_dwordx4 v158, s[28:31], s53 offen  lds
  s_add_u32 m0, s5, 106496
  s_nop 0
  buffer_load_dwordx4 v159, s[28:31], s53 offen  lds
  s_cmp_eq_u32 s4, 1
  s_cbranch_scc0 .Lk1_s_88
  s_mov_b32 m0, 110592
  s_nop 0
  buffer_load_dwordx4 v160, s[28:31], s53 offen  lds
.Lk1_s_88:
  s_add_u32 s53, s53, 64
  s_cmp_eq_u32 s53, 1152
  s_cselect_b32 s53, 0, s53
  s_waitcnt lgkmcnt(6)
  v_mfma_f32_16x16x32_bf16 v[136:139], v[76:79], v[72:75], v[136:139]
  s_waitcnt lgkmcnt(4)
  v_mfma_f32_16x16x32_bf16 v[140:143], v[80:83], v[72:75], v[140:143]
  s_waitcnt lgkmcnt(2)
  v_mfma_f32_16x16x32_bf16 v[144:147], v[64:67], v[72:75], v[144:147]
  s_waitcnt lgkmcnt(0)
  v_mfma_f32_16x16x32_bf16 v[148:151], v[68:71], v[72:75], v[148:151]
  s_waitcnt vmcnt(8)
  s_barrier
  ds_read_b128 v[72:75], v185 offset:0
  ds_read_b64_tr_b16 v[76:77], v183 offset:0
  ds_read_b64_tr_b16 v[78:79], v184 offset:1024
  ds_read_b64_tr_b16 v[80:81], v184 offset:0
  ds_read_b64_tr_b16 v[82:83], v183 offset:1024
  ds_read_b64_tr_b16 v[64:65], v183 offset:8192
  ds_read_b64_tr_b16 v[66:67], v184 offset:9216
  ds_read_b64_tr_b16 v[68:69], v184 offset:8192
  ds_read_b64_tr_b16 v[70:71], v183 offset:9216
  s_add_u32 m0, s59, 0
  s_xor_b32 s26, s58, 0
  buffer_load_dwordx4 v152, s[36:39], s26 offen offset:0 nt lds
  buffer_load_dwordx4 v153, s[36:39], s26 offen offset:1024 nt lds
  buffer_load_dwordx4 v154, s[36:39], s26 offen offset:2048 nt lds
  buffer_load_dwordx4 v155, s[36:39], s26 offen offset:3072 nt lds
  s_waitcnt lgkmcnt(6)
  v_mfma_f32_16x16x32_bf16 v[136:139], v[76:79], v[72:75], v[136:139]
  s_waitcnt lgkmcnt(4)
  v_mfma_f32_16x16x32_bf16 v[140:143], v[80:83], v[72:75], v[140:143]
  s_waitcnt lgkmcnt(2)
  v_mfma_f32_16x16x32_bf16 v[144:147], v[64:67], v[72:75], v[144:147]
  s_waitcnt lgkmcnt(0)
  v_mfma_f32_16x16x32_bf16 v[148:151], v[68:71], v[72:75], v[148:151]
  s_waitcnt vmcnt(6)
  s_barrier
  ds_read_b128 v[72:75], v185 offset:25600
  ds_read_b64_tr_b16 v[76:77], v183 offset:25600
  ds_read_b64_tr_b16 v[78:79], v184 offset:26624
  ds_read_b64_tr_b16 v[80:81], v184 offset:25600
  ds_read_b64_tr_b16 v[82:83], v183 offset:26624
  ds_read_b64_tr_b16 v[64:65], v183 offset:33792
  ds_read_b64_tr_b16 v[66:67], v184 offset:34816
  ds_read_b64_tr_b16 v[68:69], v184 offset:33792
  ds_read_b64_tr_b16 v[70:71], v183 offset:34816
  s_add_u32 m0, s59, 16384
  s_xor_b32 s26, s58, 16384
  buffer_load_dwordx4 v152, s[36:39], s26 offen offset:0 nt lds
  buffer_load_dwordx4 v153, s[36:39], s26 offen offset:1024 nt lds
  buffer_load_dwordx4 v154, s[36:39], s26 offen offset:2048 nt lds
  buffer_load_dwordx4 v155, s[36:39], s26 offen offset:3072 nt lds
  s_add_u32 m0, s59, 32768
  s_xor_b32 s26, s58, 0
  buffer_load_dwordx4 v152, s[40:43], s26 offen offset:0 nt lds
  buffer_load_dwordx4 v153, s[40:43], s26 offen offset:1024 nt lds
  buffer_load_dwordx4 v154, s[40:43], s26 offen offset:2048 nt lds
  buffer_load_dwordx4 v155, s[40:43], s26 offen offset:3072 nt lds
  s_waitcnt lgkmcnt(6)
  v_mfma_f32_16x16x32_bf16 v[136:139], v[76:79], v[72:75], v[136:139]
  s_waitcnt lgkmcnt(4)
  v_mfma_f32_16x16x32_bf16 v[140:143], v[80:83], v[72:75], v[140:143]
  s_waitcnt lgkmcnt(2)
  v_mfma_f32_16x16x32_bf16 v[144:147], v[64:67], v[72:75], v[144:147]
  s_waitcnt lgkmcnt(0)
  v_mfma_f32_16x16x32_bf16 v[148:151], v[68:71], v[72:75], v[148:151]
  s_waitcnt vmcnt(12)
  s_barrier
  ds_read_b128 v[72:75], v185 offset:51200
  ds_read_b64_tr_b16 v[76:77], v183 offset:51200
  ds_read_b64_tr_b16 v[78:79], v184 offset:52224
  ds_read_b64_tr_b16 v[80:81], v184 offset:51200
  ds_read_b64_tr_b16 v[82:83], v183 offset:52224
  ds_read_b64_tr_b16 v[64:65], v183 offset:59392
  ds_read_b64_tr_b16 v[66:67], v184 offset:60416
  ds_read_b64_tr_b16 v[68:69], v184 offset:59392
  ds_read_b64_tr_b16 v[70:71], v183 offset:60416
  s_waitcnt lgkmcnt(6)
  v_mfma_f32_16x16x32_bf16 v[136:139], v[76:79], v[72:75], v[136:139]
  s_waitcnt lgkmcnt(4)
  v_mfma_f32_16x16x32_bf16 v[140:143], v[80:83], v[72:75], v[140:143]
  s_waitcnt lgkmcnt(2)
  v_mfma_f32_16x16x32_bf16 v[144:147], v[64:67], v[72:75], v[144:147]
  s_waitcnt lgkmcnt(0)
  v_mfma_f32_16x16x32_bf16 v[148:151], v[68:71], v[72:75], v[148:151]
  s_barrier
  s_waitcnt vmcnt(8)
  v_mov_b32 v190, 19
  ds_write_b32 v186, v190 offset:1024
  s_add_u32 m0, s59, 65536
  s_xor_b32 s26, s58, 32768
  buffer_load_dwordx4 v152, s[36:39], s26 offen offset:0 nt lds
  buffer_load_dwordx4 v153, s[36:39], s26 offen offset:1024 nt lds
  buffer_load_dwordx4 v154, s[36:39], s26 offen offset:2048 nt lds
  buffer_load_dwordx4 v155, s[36:39], s26 offen offset:3072 nt lds
  s_waitcnt vmcnt(8)
  v_mov_b32 v190, 20
  ds_write_b32 v186, v190 offset:1024
  s_add_u32 m0, s59, 49152
  s_xor_b32 s26, s58, 16384
  buffer_load_dwordx4 v152, s[40:43], s26 offen offset:0 nt lds
  buffer_load_dwordx4 v153, s[40:43], s26 offen offset:1024 nt lds
  buffer_load_dwordx4 v154, s[40:43], s26 offen offset:2048 nt lds
  buffer_load_dwordx4 v155, s[40:43], s26 offen offset:3072 nt lds
  s_waitcnt vmcnt(8)
  v_mov_b32 v190, 21
  ds_write_b32 v186, v190 offset:1024
  s_add_u32 m0, s59, 81920
  s_xor_b32 s26, s58, 49152
  buffer_load_dwordx4 v152, s[36:39], s26 offen offset:0 nt lds
  buffer_load_dwordx4 v153, s[36:39], s26 offen offset:1024 nt lds
  buffer_load_dwordx4 v154, s[36:39], s26 offen offset:2048 nt lds
  buffer_load_dwordx4 v155, s[36:39], s26 offen offset:3072 nt lds
  s_add_u32 m0, s59, 98304
  s_xor_b32 s26, s58, 32768
  buffer_load_dwordx4 v152, s[40:43], s26 offen offset:0 nt lds
  buffer_load_dwordx4 v153, s[40:43], s26 offen offset:1024 nt lds
  buffer_load_dwordx4 v154, s[40:43], s26 offen offset:2048 nt lds
  buffer_load_dwordx4 v155, s[40:43], s26 offen offset:3072 nt lds
  v_mul_f32 v136, s7, v136
  v_mul_f32 v137, s7, v137
  v_mul_f32 v138, s7, v138
  v_mul_f32 v139, s7, v139
  v_mul_f32 v140, s7, v140
  v_mul_f32 v141, s7, v141
  v_mul_f32 v142, s7, v142
  v_mul_f32 v143, s7, v143
  v_mul_f32 v144, s7, v144
  v_mul_f32 v145, s7, v145
  v_mul_f32 v146, s7, v146
  v_mul_f32 v147, s7, v147
  v_mul_f32 v148, s7, v148
  v_mul_f32 v149, s7, v149
  v_mul_f32 v150, s7, v150
  v_mul_f32 v151, s7, v151
  s_add_u32 s3, s5, 131072
  v_add_u32 v180, s3, v176
  v_cvt_pk_bf16_f32 v72, v136, v137
  v_cvt_pk_bf16_f32 v73, v138, v139
  v_cvt_pk_bf16_f32 v74, v140, v141
  v_cvt_pk_bf16_f32 v75, v142, v143
  s_nop 0
  v_permlane32_swap_b32 v72, v74
  v_permlane32_swap_b32 v73, v75
  s_nop 0
  v_permlane16_swap_b32 v72, v74
  v_permlane16_swap_b32 v73, v75
  ds_write_b128 v180, v[72:75] offset:0
  v_cvt_pk_bf16_f32 v76, v144, v145
  v_cvt_pk_bf16_f32 v77, v146, v147
  v_cvt_pk_bf16_f32 v78, v148, v149
  v_cvt_pk_bf16_f32 v79, v150, v151
  s_nop 0
  v_permlane32_swap_b32 v76, v78
  v_permlane32_swap_b32 v77, v79
  s_nop 0
  v_permlane16_swap_b32 v76, v78
  v_permlane16_swap_b32 v77, v79
  ds_write_b128 v180, v[76:79] offset:4096
  s_mov_b32 s89, 0x42800000
  s_waitcnt lgkmcnt(0)
  v_mov_b32 v190, 1001
  ds_write_b32 v186, v190 offset:0
  ds_read_b32 v189, v177
  s_waitcnt lgkmcnt(0)
  v_cmp_gt_u32 vcc, 1001, v189
  s_cbranch_vccnz .Lk1_o_89
.Lk1_k_90:
  v_add_u32 v180, 131072, v176
  ds_read_b128 v[32:35], v180 offset:0
  ds_read_b128 v[36:39], v180 offset:1024
  ds_read_b128 v[40:43], v180 offset:2048
  ds_read_b128 v[44:47], v180 offset:3072
  ds_read_b128 v[48:51], v180 offset:4096
  ds_read_b128 v[52:55], v180 offset:5120
  ds_read_b128 v[56:59], v180 offset:6144
  ds_read_b128 v[60:63], v180 offset:7168
  s_waitcnt lgkmcnt(0)
  s_mov_b32 s98, 21
  v_mov_b32 v0, 0
  v_mov_b32 v1, 0
  v_mov_b32 v2, 0
  v_mov_b32 v3, 0
  v_mov_b32 v4, 0
  v_mov_b32 v5, 0
  v_mov_b32 v6, 0
  v_mov_b32 v7, 0
  v_mov_b32 v8, 0
  v_mov_b32 v9, 0
  v_mov_b32 v10, 0
  v_mov_b32 v11, 0
  v_mov_b32 v12, 0
  v_mov_b32 v13, 0
  v_mov_b32 v14, 0
  v_mov_b32 v15, 0
  v_mov_b32 v16, 0
  v_mov_b32 v17, 0
  v_mov_b32 v18, 0
  v_mov_b32 v19, 0
  v_mov_b32 v20, 0
  v_mov_b32 v21, 0
  v_mov_b32 v22, 0
  v_mov_b32 v23, 0
  v_mov_b32 v24, 0
  v_mov_b32 v25, 0
  v_mov_b32 v26, 0
  v_mov_b32 v27, 0
  v_mov_b32 v28, 0
  v_mov_b32 v29, 0
  v_mov_b32 v30, 0
  v_mov_b32 v31, 0
  v_mov_b32 v156, 0xf149f2ca
  v_mov_b32 v179, 0
  v_mov_b32 v178, 0
  s_mov_b32 s7, 0x42800000
  ds_read_b128 v[72:75], v161 offset:0
  ds_read_b128 v[76:79], v162 offset:0
  ds_read_b128 v[80:83], v163 offset:0
  ds_read_b128 v[84:87], v164 offset:0
  ds_read_b128 v[88:91], v161 offset:16384
  ds_read_b128 v[92:95], v162 offset:16384
  ds_read_b128 v[96:99], v163 offset:16384
  ds_read_b128 v[100:103], v164 offset:16384
  s_waitcnt lgkmcnt(7)
  v_mfma_f32_16x16x32_bf16 v[64:67], v[72:75], v[32:35], 0
  s_waitcnt lgkmcnt(3)
  v_mfma_f32_16x16x32_bf16 v[68:71], v[88:91], v[32:35], 0
  v_mfma_f32_16x16x32_bf16 v[64:67], v[76:79], v[36:39], v[64:67]
  s_waitcnt lgkmcnt(2)
  v_mfma_f32_16x16x32_bf16 v[68:71], v[92:95], v[36:39], v[68:71]
  v_mfma_f32_16x16x32_bf16 v[64:67], v[80:83], v[40:43], v[64:67]
  s_waitcnt lgkmcnt(1)
  v_mfma_f32_16x16x32_bf16 v[68:71], v[96:99], v[40:43], v[68:71]
  v_mfma_f32_16x16x32_bf16 v[64:67], v[84:87], v[44:47], v[64:67]
  s_waitcnt lgkmcnt(0)
  v_mfma_f32_16x16x32_bf16 v[68:71], v[100:103], v[44:47], v[68:71]
  v_xor_b32 v161, 0x10000, v161
  v_xor_b32 v162, 0x10000, v162
  v_xor_b32 v163, 0x10000, v163
  v_xor_b32 v164, 0x10000, v164
  s_nop 1
  v_max3_f32 v156, v156, v64, v65
  v_max3_f32 v156, v156, v66, v67
  v_max3_f32 v156, v156, v68, v69
  v_max3_f32 v156, v156, v70, v71
  v_cmp_lt_f32 vcc, s7, abs(v156)
  s_cbranch_vccnz .Lk1_o_92
.Lk1_k_93:
  v_exp_f32 v64, v64
  v_exp_f32 v65, v65
  v_exp_f32 v66, v66
  v_exp_f32 v67, v67
  v_exp_f32 v68, v68
  v_exp_f32 v69, v69
  v_exp_f32 v70, v70
  v_exp_f32 v71, v71
  v_add_f32 v179, v179, v64
  v_add_f32 v179, v179, v65
  v_add_f32 v179, v179, v66
  v_add_f32 v179, v179, v67
  v_add_f32 v179, v179, v68
  v_add_f32 v179, v179, v69
  v_add_f32 v179, v179, v70
  v_add_f32 v179, v179, v71
  v_cvt_pk_bf16_f32 v64, v64, v65
  v_cvt_pk_bf16_f32 v65, v66, v67
  v_cvt_pk_bf16_f32 v66, v68, v69
  v_cvt_pk_bf16_f32 v67, v70, v71
  s_load_dwordx2 s[8:9], s[0:1], 32
  s_load_dwordx2 s[10:11], s[0:1], 72
  s_load_dwordx2 s[12:13], s[0:1], 96
  v_mov_b32 v158, 0
  global_load_dword v159, v158, s[82:83] sc1
  s_lshl_b32 s3, s50, 3
  s_add_u32 s3, s3, s52
  s_lshl_b32 s3, s3, 4
  s_lshr_b32 s26, s51, 1
  s_add_u32 s3, s3, s26
  s_lshl_b32 s3, s3, 7
  s_add_u32 s3, s3, 33554432
  v_mov_b32 v157, s3
  s_mov_b32 s20, 22
  s_mov_b32 s21, 19
  s_mov_b32 s22, 65536
  s_mov_b32 s23, s59
  s_mov_b32 s18, 32768
  s_add_u32 s19, s59, 65536
  s_waitcnt lgkmcnt(0)
  s_mov_b32 s27, 0
.Lk1_loop_94:
  ds_read_b32 v189, v188
  s_waitcnt vmcnt(12)
  s_add_u32 s24, s20, 0
  s_max_u32 s98, s98, s24
  v_mov_b32 v190, s98
  ds_write_b32 v186, v190 offset:1024
  s_add_u32 s25, s21, 1
  s_waitcnt lgkmcnt(1)
  v_cmp_gt_u32 vcc, s25, v189
  s_cbranch_vccnz .Lk1_o_95
.Lk1_k_96:
  s_add_u32 m0, s23, 0
  s_add_u32 s26, s22, 0
  buffer_load_dwordx4 v152, s[36:39], s26 offen offset:0 nt lds
  buffer_load_dwordx4 v153, s[36:39], s26 offen offset:1024 nt lds
  buffer_load_dwordx4 v154, s[36:39], s26 offen offset:2048 nt lds
  buffer_load_dwordx4 v155, s[36:39], s26 offen offset:3072 nt lds
  ds_read_b32 v189, v188
  s_waitcnt vmcnt(12)
  s_add_u32 s24, s20, 1
  s_max_u32 s98, s98, s24
  v_mov_b32 v190, s98
  ds_write_b32 v186, v190 offset:1024
  ds_read_b64_tr_b16 v[72:73], v165
  ds_read_b64_tr_b16 v[74:75], v165 offset:16384
  ds_read_b64_tr_b16 v[76:77], v166
  ds_read_b64_tr_b16 v[78:79], v166 offset:16384
  ds_read_b64_tr_b16 v[80:81], v167
  ds_read_b64_tr_b16 v[82:83], v167 offset:16384
  ds_read_b64_tr_b16 v[84:85], v168
  ds_read_b64_tr_b16 v[86:87], v168 offset:16384
  ds_read_b64_tr_b16 v[88:89], v169
  ds_read_b64_tr_b16 v[90:91], v169 offset:16384
  ds_read_b64_tr_b16 v[92:93], v170
  ds_read_b64_tr_b16 v[94:95], v170 offset:16384
  s_add_u32 s25, s21, 0
  s_waitcnt lgkmcnt(13)
  v_cmp_gt_u32 vcc, s25, v189
  s_cbranch_vccnz .Lk1_o_99
.Lk1_k_100:
  s_add_u32 m0, s19, 49152
  s_add_u32 s26, s18, 16384
  buffer_load_dwordx4 v152, s[40:43], s26 offen offset:0 nt lds
  buffer_load_dwordx4 v153, s[40:43], s26 offen offset:1024 nt lds
  buffer_load_dwordx4 v154, s[40:43], s26 offen offset:2048 nt lds
  buffer_load_dwordx4 v155, s[40:43], s26 offen offset:3072 nt lds
  s_waitcnt lgkmcnt(10)
  v_mfma_f32_16x16x32_bf16 v[0:3], v[72:75], v[64:67], v[0:3]
  ds_read_b64_tr_b16 v[96:97], v171
  ds_read_b64_tr_b16 v[98:99], v171 offset:16384
  s_waitcnt lgkmcnt(10)
  v_mfma_f32_16x16x32_bf16 v[4:7], v[76:79], v[64:67], v[4:7]
  ds_read_b64_tr_b16 v[100:101], v172
  ds_read_b64_tr_b16 v[102:103], v172 offset:16384
  s_waitcnt lgkmcnt(10)
  v_mfma_f32_16x16x32_bf16 v[8:11], v[80:83], v[64:67], v[8:11]
  s_waitcnt lgkmcnt(8)
  v_mfma_f32_16x16x32_bf16 v[12:15], v[84:87], v[64:67], v[12:15]
  s_waitcnt lgkmcnt(6)
  v_mfma_f32_16x16x32_bf16 v[16:19], v[88:91], v[64:67], v[16:19]
  s_waitcnt lgkmcnt(4)
  v_mfma_f32_16x16x32_bf16 v[20:23], v[92:95], v[64:67], v[20:23]
  s_waitcnt lgkmcnt(2)
  v_mfma_f32_16x16x32_bf16 v[24:27], v[96:99], v[64:67], v[24:27]
  s_waitcnt lgkmcnt(0)
  v_mfma_f32_16x16x32_bf16 v[28:31], v[100:103], v[64:67], v[28:31]
  v_xor_b32 v165, 0x10000, v165
  v_xor_b32 v166, 0x10000, v166
  v_xor_b32 v167, 0x10000, v167
  v_xor_b32 v168, 0x10000, v168
  v_xor_b32 v169, 0x10000, v169
  v_xor_b32 v170, 0x10000, v170
  v_xor_b32 v171, 0x10000, v171
  v_xor_b32 v172, 0x10000, v172
  s_cmp_eq_u32 s27, 3
  s_cbranch_scc1 .Lk1_o_103
.Lk1_k_104:
  ds_read_b32 v189, v188
  s_waitcnt vmcnt(12)
  s_add_u32 s24, s20, 2
  s_max_u32 s98, s98, s24
  v_mov_b32 v190, s98
  ds_write_b32 v186, v190 offset:1024
  ds_read_b128 v[72:75], v161 offset:0
  ds_read_b128 v[76:79], v162 offset:0
  ds_read_b128 v[80:83], v163 offset:0
  ds_read_b128 v[84:87], v164 offset:0
  ds_read_b128 v[88:91], v161 offset:16384
  ds_read_b128 v[92:95], v162 offset:16384
  ds_read_b128 v[96:99], v163 offset:16384
  ds_read_b128 v[100:103], v164 offset:16384
  s_add_u32 s25, s21, 1
  s_waitcnt lgkmcnt(9)
  v_cmp_gt_u32 vcc, s25, v189
  s_cbranch_vccnz .Lk1_o_105
.Lk1_k_106:
  s_add_u32 m0, s23, 16384
  s_add_u32 s26, s22, 16384
  buffer_load_dwordx4 v152, s[36:39], s26 offen offset:0 nt lds
  buffer_load_dwordx4 v153, s[36:39], s26 offen offset:1024 nt lds
  buffer_load_dwordx4 v154, s[36:39], s26 offen offset:2048 nt lds
  buffer_load_dwordx4 v155, s[36:39], s26 offen offset:3072 nt lds
  s_waitcnt lgkmcnt(7)
  v_mfma_f32_16x16x32_bf16 v[64:67], v[72:75], v[32:35], 0
  s_waitcnt lgkmcnt(3)
  v_mfma_f32_16x16x32_bf16 v[68:71], v[88:91], v[32:35], 0
  v_mfma_f32_16x16x32_bf16 v[64:67], v[76:79], v[36:39], v[64:67]
  s_waitcnt lgkmcnt(2)
  v_mfma_f32_16x16x32_bf16 v[68:71], v[92:95], v[36:39], v[68:71]
  v_mfma_f32_16x16x32_bf16 v[64:67], v[80:83], v[40:43], v[64:67]
  s_waitcnt lgkmcnt(1)
  v_mfma_f32_16x16x32_bf16 v[68:71], v[96:99], v[40:43], v[68:71]
  v_mfma_f32_16x16x32_bf16 v[64:67], v[84:87], v[44:47], v[64:67]
  s_waitcnt lgkmcnt(0)
  v_mfma_f32_16x16x32_bf16 v[68:71], v[100:103], v[44:47], v[68:71]
  v_xor_b32 v161, 0x10000, v161
  v_xor_b32 v162, 0x10000, v162
  v_xor_b32 v163, 0x10000, v163
  v_xor_b32 v164, 0x10000, v164
  s_nop 1
  v_max3_f32 v156, v156, v64, v65
  v_max3_f32 v156, v156, v66, v67
  v_max3_f32 v156, v156, v68, v69
  v_max3_f32 v156, v156, v70, v71
  v_cmp_lt_f32 vcc, s7, abs(v156)
  s_cbranch_vccnz .Lk1_o_109
.Lk1_k_110:
  v_exp_f32 v64, v64
  v_exp_f32 v65, v65
  v_exp_f32 v66, v66
  v_exp_f32 v67, v67
  v_exp_f32 v68, v68
  v_exp_f32 v69, v69
  v_exp_f32 v70, v70
  v_exp_f32 v71, v71
  v_add_f32 v179, v179, v64
  v_add_f32 v179, v179, v65
  v_add_f32 v179, v179, v66
  v_add_f32 v179, v179, v67
  v_add_f32 v179, v179, v68
  v_add_f32 v179, v179, v69
  v_add_f32 v179, v179, v70
  v_add_f32 v179, v179, v71
  v_cvt_pk_bf16_f32 v64, v64, v65
  v_cvt_pk_bf16_f32 v65, v66, v67
  v_cvt_pk_bf16_f32 v66, v68, v69
  v_cvt_pk_bf16_f32 v67, v70, v71
  ds_read_b32 v189, v188
  s_waitcnt vmcnt(12)
  s_add_u32 s24, s20, 3
  s_max_u32 s98, s98, s24
  v_mov_b32 v190, s98
  ds_write_b32 v186, v190 offset:1024
  s_add_u32 s25, s21, 2
  s_waitcnt lgkmcnt(1)
  v_cmp_gt_u32 vcc, s25, v189
  s_cbranch_vccnz .Lk1_o_111
.Lk1_k_112:
  s_mov_b32 s3, 51
  s_bitcmp1_b32 s3, s27
  s_cbranch_scc1 .Lk1_o_115
  s_add_u32 m0, s23, 32768
  s_add_u32 s26, s22, 0
  buffer_load_dwordx4 v152, s[40:43], s26 offen offset:0 nt lds
  buffer_load_dwordx4 v153, s[40:43], s26 offen offset:1024 nt lds
  buffer_load_dwordx4 v154, s[40:43], s26 offen offset:2048 nt lds
  buffer_load_dwordx4 v155, s[40:43], s26 offen offset:3072 nt lds
.Lk1_k_116:
  s_cmp_eq_u32 s27, 3
  s_cbranch_scc1 .Lk1_o_121
.Lk1_k_122:
  s_add_u32 s20, s20, 4
  s_add_u32 s21, s21, 3
  s_mov_b32 s18, s22
  s_add_u32 s22, s22, 32768
  s_xor_b32 s23, s23, 65536
  s_xor_b32 s19, s19, 65536
  s_add_u32 s27, s27, 1
  s_cmp_lt_u32 s27, 6
  s_cbranch_scc1 .Lk1_loop_94
  s_waitcnt vmcnt(12)
  s_add_u32 s24, s20, 0
  s_max_u32 s98, s98, s24
  v_mov_b32 v190, s98
  ds_write_b32 v186, v190 offset:1024
  v_cmp_eq_u32 vcc, 0, v159
  s_cbranch_vccnz .Lk1_o_126
.Lk1_k_127:
  s_cmp_eq_u32 s4, 0
  s_cbranch_scc0 .Lk1_s_129
  s_lshr_b32 s3, s2, 3
  v_mov_b32 v132, s3
.Lk1_s_129:
  ds_read_b32 v189, v188
  s_waitcnt vmcnt(8)
  s_add_u32 s24, s20, 1
  s_max_u32 s98, s98, s24
  v_mov_b32 v190, s98
  ds_write_b32 v186, v190 offset:1024
  s_add_u32 s25, s21, 0
  s_waitcnt lgkmcnt(1)
  v_cmp_gt_u32 vcc, s25, v189
  s_cbranch_vccnz .Lk1_o_130
.Lk1_k_131:
  s_add_u32 m0, s19, 49152
  s_add_u32 s26, s18, 16384
  buffer_load_dwordx4 v152, s[40:43], s26 offen offset:0 nt lds
  buffer_load_dwordx4 v153, s[40:43], s26 offen offset:1024 nt lds
  buffer_load_dwordx4 v154, s[40:43], s26 offen offset:2048 nt lds
  buffer_load_dwordx4 v155, s[40:43], s26 offen offset:3072 nt lds
  s_waitcnt lgkmcnt(0)
  v_mov_b32 v190, 1003
  ds_write_b32 v186, v190 offset:0
  ds_read_b32 v189, v177
  s_waitcnt lgkmcnt(0)
  v_cmp_gt_u32 vcc, 1003, v189
  s_cbranch_vccnz .Lk1_o_134
.Lk1_k_135:
  s_cmp_eq_u32 s4, 0
  s_cbranch_scc0 .Lk1_s_137
  s_mov_b64 exec, 1
  global_store_dword v157, v159, s[12:13] offset:64 sc1
  s_mov_b64 exec, -1
.Lk1_s_137:
  ds_read_b64_tr_b16 v[72:73], v165
  ds_read_b64_tr_b16 v[74:75], v165 offset:16384
  ds_read_b64_tr_b16 v[76:77], v166
  ds_read_b64_tr_b16 v[78:79], v166 offset:16384
  ds_read_b64_tr_b16 v[80:81], v167
  ds_read_b64_tr_b16 v[82:83], v167 offset:16384
  ds_read_b64_tr_b16 v[84:85], v168
  ds_read_b64_tr_b16 v[86:87], v168 offset:16384
  ds_read_b64_tr_b16 v[88:89], v169
  ds_read_b64_tr_b16 v[90:91], v169 offset:16384
  ds_read_b64_tr_b16 v[92:93], v170
  ds_read_b64_tr_b16 v[94:95], v170 offset:16384
  s_waitcnt lgkmcnt(10)
  v_mfma_f32_16x16x32_bf16 v[0:3], v[72:75], v[64:67], v[0:3]
  ds_read_b64_tr_b16 v[96:97], v171
  ds_read_b64_tr_b16 v[98:99], v171 offset:16384
  s_waitcnt lgkmcnt(10)
  v_mfma_f32_16x16x32_bf16 v[4:7], v[76:79], v[64:67], v[4:7]
  ds_read_b64_tr_b16 v[100:101], v172
  ds_read_b64_tr_b16 v[102:103], v172 offset:16384
  s_waitcnt lgkmcnt(10)
  v_mfma_f32_16x16x32_bf16 v[8:11], v[80:83], v[64:67], v[8:11]
  s_waitcnt lgkmcnt(8)
  v_mfma_f32_16x16x32_bf16 v[12:15], v[84:87], v[64:67], v[12:15]
  s_waitcnt lgkmcnt(6)
  v_mfma_f32_16x16x32_bf16 v[16:19], v[88:91], v[64:67], v[16:19]
  s_waitcnt lgkmcnt(4)
  v_mfma_f32_16x16x32_bf16 v[20:23], v[92:95], v[64:67], v[20:23]
  s_waitcnt lgkmcnt(2)
  v_mfma_f32_16x16x32_bf16 v[24:27], v[96:99], v[64:67], v[24:27]
  s_waitcnt lgkmcnt(0)
  v_mfma_f32_16x16x32_bf16 v[28:31], v[100:103], v[64:67], v[28:31]
  v_xor_b32 v165, 0x10000, v165
  v_xor_b32 v166, 0x10000, v166
  v_xor_b32 v167, 0x10000, v167
  v_xor_b32 v168, 0x10000, v168
  v_xor_b32 v169, 0x10000, v169
  v_xor_b32 v170, 0x10000, v170
  v_xor_b32 v171, 0x10000, v171
  v_xor_b32 v172, 0x10000, v172
  s_waitcnt vmcnt(8)
  s_add_u32 s24, s20, 2
  s_max_u32 s98, s98, s24
  v_mov_b32 v190, s98
  ds_write_b32 v186, v190 offset:1024
  s_cmp_eq_u32 s4, 0
  s_cbranch_scc0 .Lk1_s_138
  s_waitcnt vmcnt(5)
  v_mov_b32 v133, v159
  v_mov_b32 v180, 162816
  s_mov_b64 exec, 1
  ds_write_b64 v180, v[132:133]
  s_mov_b64 exec, -1
.Lk1_s_138:
  ds_read_b128 v[72:75], v161 offset:0
  ds_read_b128 v[76:79], v162 offset:0
  ds_read_b128 v[80:83], v163 offset:0
  ds_read_b128 v[84:87], v164 offset:0
  ds_read_b128 v[88:91], v161 offset:16384
  ds_read_b128 v[92:95], v162 offset:16384
  ds_read_b128 v[96:99], v163 offset:16384
  ds_read_b128 v[100:103], v164 offset:16384
  s_waitcnt lgkmcnt(7)
  v_mfma_f32_16x16x32_bf16 v[64:67], v[72:75], v[32:35], 0
  s_waitcnt lgkmcnt(3)
  v_mfma_f32_16x16x32_bf16 v[68:71], v[88:91], v[32:35], 0
  v_mfma_f32_16x16x32_bf16 v[64:67], v[76:79], v[36:39], v[64:67]
  s_waitcnt lgkmcnt(2)
  v_mfma_f32_16x16x32_bf16 v[68:71], v[92:95], v[36:39], v[68:71]
  v_mfma_f32_16x16x32_bf16 v[64:67], v[80:83], v[40:43], v[64:67]
  s_waitcnt lgkmcnt(1)
  v_mfma_f32_16x16x32_bf16 v[68:71], v[96:99], v[40:43], v[68:71]
  v_mfma_f32_16x16x32_bf16 v[64:67], v[84:87], v[44:47], v[64:67]
  s_waitcnt lgkmcnt(0)
  v_mfma_f32_16x16x32_bf16 v[68:71], v[100:103], v[44:47], v[68:71]
  v_xor_b32 v161, 0x10000, v161
  v_xor_b32 v162, 0x10000, v162
  v_xor_b32 v163, 0x10000, v163
  v_xor_b32 v164, 0x10000, v164
  s_nop 1
  v_max3_f32 v156, v156, v64, v65
  v_max3_f32 v156, v156, v66, v67
  v_max3_f32 v156, v156, v68, v69
  v_max3_f32 v156, v156, v70, v71
  v_cmp_lt_f32 vcc, s7, abs(v156)
  s_cbranch_vccnz .Lk1_o_139
.Lk1_k_140:
  v_exp_f32 v64, v64
  v_exp_f32 v65, v65
  v_exp_f32 v66, v66
  v_exp_f32 v67, v67
  v_exp_f32 v68, v68
  v_exp_f32 v69, v69
  v_exp_f32 v70, v70
  v_exp_f32 v71, v71
  v_add_f32 v179, v179, v64
  v_add_f32 v179, v179, v65
  v_add_f32 v179, v179, v66
  v_add_f32 v179, v179, v67
  v_add_f32 v179, v179, v68
  v_add_f32 v179, v179, v69
  v_add_f32 v179, v179, v70
  v_add_f32 v179, v179, v71
  v_cvt_pk_bf16_f32 v64, v64, v65
  v_cvt_pk_bf16_f32 v65, v66, v67
  v_cvt_pk_bf16_f32 v66, v68, v69
  v_cvt_pk_bf16_f32 v67, v70, v71
  v_mov_b32 v190, 1004
  ds_write_b32 v186, v190 offset:0
  ds_read_b32 v189, v177
  s_waitcnt lgkmcnt(0)
  v_cmp_gt_u32 vcc, 1004, v189
  s_cbranch_vccnz .Lk1_o_141
.Lk1_k_142:
  v_mov_b32 v180, 162816
  ds_read_b32 v180, v180
  s_waitcnt lgkmcnt(0)
  v_readfirstlane_b32 s79, v180
  s_and_b32 s48, s2, 3
  s_bfe_u32 s50, s2, 0x10002
  s_nop 1
  s_min_u32 s49, s79, 27
  s_mul_i32 s51, s49, 43
  s_lshr_b32 s51, s51, 7
  s_mul_i32 s3, s51, 3
  s_sub_u32 s52, s49, s3
  s_mul_i32 s53, s50, 27
  s_add_u32 s53, s53, s49
  v_add_u32 v208, 0, v191
  v_mul_u32_u24 v209, 2731, v208
  v_lshrrev_b32 v209, 16, v209
  v_mul_u32_u24 v210, 24, v209
  v_sub_u32 v210, v208, v210
  v_bfe_u32 v211, v209, 1, 2
  v_lshlrev_b32 v211, 1, v211
  v_xor_b32 v210, v210, v211
  v_lshlrev_b32 v210, 4, v210
  s_lshl_b32 s3, s4, 3
  v_add_u32 v209, s3, v209
  v_mul_u32_u24 v209, 1152, v209
  v_add_u32 v200, v209, v210
  v_add_u32 v208, 64, v191
  v_mul_u32_u24 v209, 2731, v208
  v_lshrrev_b32 v209, 16, v209
  v_mul_u32_u24 v210, 24, v209
  v_sub_u32 v210, v208, v210
  v_bfe_u32 v211, v209, 1, 2
  v_lshlrev_b32 v211, 1, v211
  v_xor_b32 v210, v210, v211
  v_lshlrev_b32 v210, 4, v210
  s_lshl_b32 s3, s4, 3
  v_add_u32 v209, s3, v209
  v_mul_u32_u24 v209, 1152, v209
  v_add_u32 v201, v209, v210
  v_add_u32 v208, 128, v191
  v_mul_u32_u24 v209, 2731, v208
  v_lshrrev_b32 v209, 16, v209
  v_mul_u32_u24 v210, 24, v209
  v_sub_u32 v210, v208, v210
  v_bfe_u32 v211, v209, 1, 2
  v_lshlrev_b32 v211, 1, v211
  v_xor_b32 v210, v210, v211
  v_lshlrev_b32 v210, 4, v210
  s_lshl_b32 s3, s4, 3
  v_add_u32 v209, s3, v209
  v_mul_u32_u24 v209, 1152, v209
  v_add_u32 v202, v209, v210
  s_xor_b32 s3, s4, s48
  s_lshl_b32 s3, s3, 18
  v_lshlrev_b32 v208, 4, v191
  v_add_u32 v203, s3, v208
  v_add_u32 v204, 131072, v203
  s_mul_i32 s14, s4, 3072
  s_lshl_b32 s15, s4, 11
  s_add_u32 s15, s15, 49152
  s_cmp_eq_u32 s50, 0
  s_cselect_b64 s[16:17], s[8:9], s[10:11]
  s_mul_i32 s3, s48, 1179648
  s_mul_i32 s26, s52, 384
  s_add_u32 s3, s3, s26
  s_add_u32 s16, s16, s3
  s_addc_u32 s17, s17, 0
  s_mov_b32 s36, s16
  s_and_b32 s37, s17, 0xffff
  s_mov_b32 s38, 1178880
  s_mov_b32 s39, 0x20000
  s_mul_i32 s3, s50, 72
  s_lshl_b32 s26, s51, 3
  s_add_u32 s3, s3, s26
  s_lshl_b32 s3, s3, 2
  s_add_u32 s3, s3, s48
  s_lshl_b32 s3, s3, 15
  s_add_u32 s16, s12, s3
  s_addc_u32 s17, s13, 0
  s_mov_b32 s40, s16
  s_and_b32 s41, s17, 0xffff
  s_mov_b32 s42, 950272
  s_mov_b32 s43, 0x20000
  s_lshl_b32 s3, s51, 3
  s_add_u32 s26, s3, 7
  s_mul_i32 s3, s3, 57
  s_lshr_b32 s3, s3, 9
  s_mul_i32 s26, s26, 57
  s_lshr_b32 s26, s26, 9
  s_min_u32 s3, s3, 7
  s_min_u32 s26, s26, 7
  v_mov_b32 v208, s3
  v_mov_b32 v209, s26
  v_and_b32 v210, 4, v191
  v_cmp_eq_u32 vcc, 0, v210
  s_nop 1
  v_cndmask_b32 v208, v209, v208, vcc
  s_lshl_b32 s3, s50, 5
  s_add_u32 s3, s3, s48
  s_lshl_b32 s3, s3, 2
  v_lshlrev_b32 v208, 4, v208
  v_and_b32 v209, 3, v191
  v_add3_u32 v208, v208, v209, s3
  v_lshlrev_b32 v208, 7, v208
  v_add_u32 v205, 33554496, v208
  s_mov_b32 s54, 0
  s_mov_b32 s55, 0
  global_load_dword v206, v205, s[12:13] sc1
  s_waitcnt vmcnt(5)
  s_add_u32 s24, s20, 3
  s_max_u32 s98, s98, s24
  v_mov_b32 v190, s98
  ds_write_b32 v186, v190 offset:1024
  s_waitcnt vmcnt(0)
  s_max_u32 s98, s98, 50
  v_mov_b32 v190, s98
  ds_write_b32 v186, v190 offset:1024
  v_lshlrev_b32 v160, 7, v191
  s_lshl_b32 s3, s4, 13
  v_add_u32 v160, s3, v160
  s_and_b32 s3, s2, 127
  s_mul_i32 s3, s3, 36864
  s_cmp_lt_u32 s2, 128
  s_cselect_b64 s[8:9], s[8:9], s[10:11]
  s_add_u32 s8, s8, s3
  s_addc_u32 s9, s9, 0
  s_mov_b32 s28, s8
  s_and_b32 s29, s9, 0xffff
  s_mov_b32 s30, 36864
  s_mov_b32 s31, 0x20000
  s_mov_b32 s26, 32768
  buffer_load_dword v250, v160, s[28:31], 0 offen
  buffer_load_dword v251, v160, s[28:31], s26 offen
  ds_read_b64_tr_b16 v[72:73], v165
  ds_read_b64_tr_b16 v[74:75], v165 offset:16384
  ds_read_b64_tr_b16 v[76:77], v166
  ds_read_b64_tr_b16 v[78:79], v166 offset:16384
  ds_read_b64_tr_b16 v[80:81], v167
  ds_read_b64_tr_b16 v[82:83], v167 offset:16384
  ds_read_b64_tr_b16 v[84:85], v168
  ds_read_b64_tr_b16 v[86:87], v168 offset:16384
  ds_read_b64_tr_b16 v[88:89], v169
  ds_read_b64_tr_b16 v[90:91], v169 offset:16384
  ds_read_b64_tr_b16 v[92:93], v170
  ds_read_b64_tr_b16 v[94:95], v170 offset:16384
  s_waitcnt lgkmcnt(10)
  v_mfma_f32_16x16x32_bf16 v[0:3], v[72:75], v[64:67], v[0:3]
  ds_read_b64_tr_b16 v[96:97], v171
  ds_read_b64_tr_b16 v[98:99], v171 offset:16384
  s_waitcnt lgkmcnt(10)
  v_mfma_f32_16x16x32_bf16 v[4:7], v[76:79], v[64:67], v[4:7]
  ds_read_b64_tr_b16 v[100:101], v172
  ds_read_b64_tr_b16 v[102:103], v172 offset:16384
  s_waitcnt lgkmcnt(10)
  v_mfma_f32_16x16x32_bf16 v[8:11], v[80:83], v[64:67], v[8:11]
  s_waitcnt lgkmcnt(8)
  v_mfma_f32_16x16x32_bf16 v[12:15], v[84:87], v[64:67], v[12:15]
  s_waitcnt lgkmcnt(6)
  v_mfma_f32_16x16x32_bf16 v[16:19], v[88:91], v[64:67], v[16:19]
  s_waitcnt lgkmcnt(4)
  v_mfma_f32_16x16x32_bf16 v[20:23], v[92:95], v[64:67], v[20:23]
  s_waitcnt lgkmcnt(2)
  v_mfma_f32_16x16x32_bf16 v[24:27], v[96:99], v[64:67], v[24:27]
  s_waitcnt lgkmcnt(0)
  v_mfma_f32_16x16x32_bf16 v[28:31], v[100:103], v[64:67], v[28:31]
  v_xor_b32 v165, 0x10000, v165
  v_xor_b32 v166, 0x10000, v166
  v_xor_b32 v167, 0x10000, v167
  v_xor_b32 v168, 0x10000, v168
  v_xor_b32 v169, 0x10000, v169
  v_xor_b32 v170, 0x10000, v170
  v_xor_b32 v171, 0x10000, v171
  v_xor_b32 v172, 0x10000, v172
  v_mov_b32 v180, v179
  s_nop 1
  v_permlane32_swap_b32 v179, v180
  v_add_f32 v179, v179, v180
  v_mov_b32 v180, v179
  s_nop 1
  v_permlane16_swap_b32 v179, v180
  v_add_f32 v179, v179, v180
  s_xor_b32 s3, s4, 1
  s_mul_i32 s3, s3, 6144
  s_add_u32 s3, s3, 131072
  v_add_u32 v180, s3, v176
  ds_write_b128 v180, v[8:11] offset:0
  ds_write_b128 v180, v[12:15] offset:1024
  s_xor_b32 s3, s4, 2
  s_mul_i32 s3, s3, 6144
  s_add_u32 s3, s3, 133120
  v_add_u32 v180, s3, v176
  ds_write_b128 v180, v[16:19] offset:0
  ds_write_b128 v180, v[20:23] offset:1024
  s_xor_b32 s3, s4, 3
  s_mul_i32 s3, s3, 6144
  s_add_u32 s3, s3, 135168
  v_add_u32 v180, s3, v176
  ds_write_b128 v180, v[24:27] offset:0
  ds_write_b128 v180, v[28:31] offset:1024
  v_lshrrev_b32 v122, 1, v176
  s_lshl_b32 s3, s4, 9
  s_add_u32 s3, s3, 155648
  v_add_u32 v122, s3, v122
  ds_write_b64 v122, v[178:179]
  v_mov_b32 v112, v0
  v_mov_b32 v113, v1
  v_mov_b32 v114, v2
  v_mov_b32 v115, v3
  v_mov_b32 v116, v4
  v_mov_b32 v117, v5
  v_mov_b32 v118, v6
  v_mov_b32 v119, v7
  v_mov_b32 v120, v178
  v_mov_b32 v121, v179
  s_waitcnt lgkmcnt(0)
  v_mov_b32 v190, 1005
  ds_write_b32 v186, v190 offset:0
  s_waitcnt lgkmcnt(0)
  s_cmp_lt_u32 s79, 27
  s_cbranch_scc0 .Lk1_s_144
  ds_read_b32 v189, v188
  s_waitcnt lgkmcnt(0)
  v_cmp_gt_u32 vcc, 41, v189
  s_cbranch_vccnz .Lk1_o_145
.Lk1_k_146:
  v_cmp_ne_u32 vcc, v159, v206
  s_cbranch_vccnz .Lk1_o_148
.Lk1_k_149:
  s_and_b32 s56, s54, 31
  s_add_u32 s54, s54, 1
  s_and_b32 s3, s54, 4
  s_bitcmp1_b32 s54, 6
  s_cselect_b32 s57, 4, 0
  s_xor_b32 s3, s3, s57
  s_add_u32 s54, s54, s3
  s_cmp_eq_u32 s54, 32
  s_cselect_b32 s54, 68, s54
  s_mul_i32 s56, s56, 36864
  s_add_u32 m0, s14, 0
  s_nop 0
  buffer_load_dwordx4 v200, s[36:39], s56 offen lds
  s_add_u32 m0, s14, 1024
  s_nop 0
  buffer_load_dwordx4 v201, s[36:39], s56 offen lds
  s_add_u32 m0, s14, 2048
  s_nop 0
  buffer_load_dwordx4 v202, s[36:39], s56 offen lds
  s_and_b32 s56, s55, 31
  s_add_u32 s55, s55, 1
  s_and_b32 s3, s55, 4
  s_bitcmp1_b32 s55, 6
  s_cselect_b32 s57, 4, 0
  s_xor_b32 s3, s3, s57
  s_add_u32 s55, s55, s3
  s_cmp_eq_u32 s55, 32
  s_cselect_b32 s55, 68, s55
  s_lshl_b32 s56, s56, 10
  s_add_u32 m0, s15, 0
  s_nop 0
  buffer_load_dwordx4 v203, s[40:43], s56 offen sc1 lds
  s_add_u32 m0, s15, 1024
  s_nop 0
  buffer_load_dwordx4 v204, s[40:43], s56 offen sc1 lds
  s_and_b32 s56, s54, 31
  s_add_u32 s54, s54, 1
  s_and_b32 s3, s54, 4
  s_bitcmp1_b32 s54, 6
  s_cselect_b32 s57, 4, 0
  s_xor_b32 s3, s3, s57
  s_add_u32 s54, s54, s3
  s_cmp_eq_u32 s54, 32
  s_cselect_b32 s54, 68, s54
  s_mul_i32 s56, s56, 36864
  s_add_u32 m0, s14, 12288
  s_nop 0
  buffer_load_dwordx4 v200, s[36:39], s56 offen lds
  s_add_u32 m0, s14, 13312
  s_nop 0
  buffer_load_dwordx4 v201, s[36:39], s56 offen lds
  s_add_u32 m0, s14, 14336
  s_nop 0
  buffer_load_dwordx4 v202, s[36:39], s56 offen lds
  s_and_b32 s56, s55, 31
  s_add_u32 s55, s55, 1
  s_and_b32 s3, s55, 4
  s_bitcmp1_b32 s55, 6
  s_cselect_b32 s57, 4, 0
  s_xor_b32 s3, s3, s57
  s_add_u32 s55, s55, s3
  s_cmp_eq_u32 s55, 32
  s_cselect_b32 s55, 68, s55
  s_lshl_b32 s56, s56, 10
  s_add_u32 m0, s15, 8192
  s_nop 0
  buffer_load_dwordx4 v203, s[40:43], s56 offen sc1 lds
  s_add_u32 m0, s15, 9216
  s_nop 0
  buffer_load_dwordx4 v204, s[40:43], s56 offen sc1 lds
  s_and_b32 s56, s54, 31
  s_add_u32 s54, s54, 1
  s_and_b32 s3, s54, 4
  s_bitcmp1_b32 s54, 6
  s_cselect_b32 s57, 4, 0
  s_xor_b32 s3, s3, s57
  s_add_u32 s54, s54, s3
  s_cmp_eq_u32 s54, 32
  s_cselect_b32 s54, 68, s54
  s_mul_i32 s56, s56, 36864
  s_add_u32 m0, s14, 24576
  s_nop 0
  buffer_load_dwordx4 v200, s[36:39], s56 offen lds
  s_add_u32 m0, s14, 25600
  s_nop 0
  buffer_load_dwordx4 v201, s[36:39], s56 offen lds
  s_add_u32 m0, s14, 26624
  s_nop 0
  buffer_load_dwordx4 v202, s[36:39], s56 offen lds
  s_and_b32 s56, s55, 31
  s_add_u32 s55, s55, 1
  s_and_b32 s3, s55, 4
  s_bitcmp1_b32 s55, 6
  s_cselect_b32 s57, 4, 0
  s_xor_b32 s3, s3, s57
  s_add_u32 s55, s55, s3
  s_cmp_eq_u32 s55, 32
  s_cselect_b32 s55, 68, s55
  s_lshl_b32 s56, s56, 10
  s_add_u32 m0, s15, 16384
  s_nop 0
  buffer_load_dwordx4 v203, s[40:43], s56 offen sc1 lds
  s_add_u32 m0, s15, 17408
  s_nop 0
  buffer_load_dwordx4 v204, s[40:43], s56 offen sc1 lds
  s_and_b32 s56, s54, 31
  s_add_u32 s54, s54, 1
  s_and_b32 s3, s54, 4
  s_bitcmp1_b32 s54, 6
  s_cselect_b32 s57, 4, 0
  s_xor_b32 s3, s3, s57
  s_add_u32 s54, s54, s3
  s_cmp_eq_u32 s54, 32
  s_cselect_b32 s54, 68, s54
  s_mul_i32 s56, s56, 36864
  s_add_u32 m0, s14, 36864
  s_nop 0
  buffer_load_dwordx4 v200, s[36:39], s56 offen lds
  s_add_u32 m0, s14, 37888
  s_nop 0
  buffer_load_dwordx4 v201, s[36:39], s56 offen lds
  s_add_u32 m0, s14, 38912
  s_nop 0
  buffer_load_dwordx4 v202, s[36:39], s56 offen lds
  s_and_b32 s56, s55, 31
  s_add_u32 s55, s55, 1
  s_and_b32 s3, s55, 4
  s_bitcmp1_b32 s55, 6
  s_cselect_b32 s57, 4, 0
  s_xor_b32 s3, s3, s57
  s_add_u32 s55, s55, s3
  s_cmp_eq_u32 s55, 32
  s_cselect_b32 s55, 68, s55
  s_lshl_b32 s56, s56, 10
  s_add_u32 m0, s15, 24576
  s_nop 0
  buffer_load_dwordx4 v203, s[40:43], s56 offen sc1 lds
  s_add_u32 m0, s15, 25600
  s_nop 0
  buffer_load_dwordx4 v204, s[40:43], s56 offen sc1 lds
.Lk1_s_144:
  ds_read_b32 v189, v177
  s_waitcnt lgkmcnt(0)
  v_cmp_gt_u32 vcc, 1005, v189
  s_cbranch_vccnz .Lk1_o_151
.Lk1_k_152:
  s_mul_i32 s3, s4, 6144
  s_add_u32 s3, s3, 131072
  v_add_u32 v180, s3, v176
  v_xor_b32 v189, 512, v122
  ds_read_b64 v[74:75], v189
  v_xor_b32 v189, 1024, v122
  ds_read_b64 v[76:77], v189
  v_xor_b32 v189, 1536, v122
  ds_read_b64 v[78:79], v189
  ds_read_b128 v[88:91], v180 offset:0
  ds_read_b128 v[92:95], v180 offset:1024
  ds_read_b128 v[96:99], v180 offset:2048
  ds_read_b128 v[100:103], v180 offset:3072
  ds_read_b128 v[104:107], v180 offset:4096
  ds_read_b128 v[108:111], v180 offset:5120
  v_mov_b32 v72, v120
  v_mov_b32 v73, v121
  s_waitcnt lgkmcnt(6)
  v_max3_f32 v124, v72, v74, v76
  v_max_f32 v124, v124, v78
  v_sub_f32 v128, v72, v124
  v_sub_f32 v129, v74, v124
  v_sub_f32 v130, v76, v124
  v_sub_f32 v131, v78, v124
  v_exp_f32 v128, v128
  v_exp_f32 v129, v129
  v_exp_f32 v130, v130
  v_exp_f32 v131, v131
  v_mul_f32 v125, v128, v73
  v_fma_f32 v125, v129, v75, v125
  v_fma_f32 v125, v130, v77, v125
  v_fma_f32 v125, v131, v79, v125
  v_rcp_f32 v125, v125
  s_nop 0
  v_mul_f32 v128, v128, v125
  v_mul_f32 v129, v129, v125
  v_mul_f32 v130, v130, v125
  v_mul_f32 v131, v131, v125
  v_mul_f32 v112, v112, v128
  v_mul_f32 v113, v113, v128
  v_mul_f32 v114, v114, v128
  v_mul_f32 v115, v115, v128
  v_mul_f32 v116, v116, v128
  v_mul_f32 v117, v117, v128
  v_mul_f32 v118, v118, v128
  v_mul_f32 v119, v119, v128
  s_waitcnt lgkmcnt(4)
  v_fma_f32 v112, v88, v129, v112
  v_fma_f32 v113, v89, v129, v113
  v_fma_f32 v114, v90, v129, v114
  v_fma_f32 v115, v91, v129, v115
  v_fma_f32 v116, v92, v129, v116
  v_fma_f32 v117, v93, v129, v117
  v_fma_f32 v118, v94, v129, v118
  v_fma_f32 v119, v95, v129, v119
  s_waitcnt lgkmcnt(2)
  v_fma_f32 v112, v96, v130, v112
  v_fma_f32 v113, v97, v130, v113
  v_fma_f32 v114, v98, v130, v114
  v_fma_f32 v115, v99, v130, v115
  v_fma_f32 v116, v100, v130, v116
  v_fma_f32 v117, v101, v130, v117
  v_fma_f32 v118, v102, v130, v118
  v_fma_f32 v119, v103, v130, v119
  s_waitcnt lgkmcnt(0)
  v_fma_f32 v112, v104, v131, v112
  v_fma_f32 v113, v105, v131, v113
  v_fma_f32 v114, v106, v131, v114
  v_fma_f32 v115, v107, v131, v115
  v_fma_f32 v116, v108, v131, v116
  v_fma_f32 v117, v109, v131, v117
  v_fma_f32 v118, v110, v131, v118
  v_fma_f32 v119, v111, v131, v119
  v_cvt_pk_bf16_f32 v124, v112, v113
  v_cvt_pk_bf16_f32 v125, v114, v115
  v_cvt_pk_bf16_f32 v126, v116, v117
  v_cvt_pk_bf16_f32 v127, v118, v119
  s_add_u32 s26, s5, 1052672
  buffer_store_dwordx4 v[124:127], v176, s[44:47], s26 offen sc1
  s_cmp_ge_u32 s79, 27
  s_cbranch_scc1 .Lk1_o_154
.Lk1_k_155:
  s_waitcnt vmcnt(16)
  s_barrier
  s_mov_b32 s27, 0
.Lk1_loop_157:
  s_waitcnt vmcnt(10)
  s_barrier
  s_cmp_eq_u32 s27, 7
  s_cselect_b32 s59, 536870912, 0
  v_add_u32 v200, s59, v200
  v_add_u32 v201, s59, v201
  v_add_u32 v202, s59, v202
  v_add_u32 v203, s59, v203
  v_add_u32 v204, s59, v204
  s_and_b32 s56, s54, 31
  s_add_u32 s54, s54, 1
  s_and_b32 s3, s54, 4
  s_bitcmp1_b32 s54, 6
  s_cselect_b32 s57, 4, 0
  s_xor_b32 s3, s3, s57
  s_add_u32 s54, s54, s3
  s_cmp_eq_u32 s54, 32
  s_cselect_b32 s54, 68, s54
  s_mul_i32 s56, s56, 36864
  s_add_u32 m0, s14, 0
  s_nop 0
  buffer_load_dwordx4 v200, s[36:39], s56 offen lds
  s_add_u32 m0, s14, 1024
  s_nop 0
  buffer_load_dwordx4 v201, s[36:39], s56 offen lds
  s_add_u32 m0, s14, 2048
  s_nop 0
  buffer_load_dwordx4 v202, s[36:39], s56 offen lds
  v_cmp_ne_u32 vcc, v159, v206
  s_cbranch_vccnz .Lk1_o_158
.Lk1_k_159:
  s_and_b32 s56, s55, 31
  s_add_u32 s55, s55, 1
  s_and_b32 s3, s55, 4
  s_bitcmp1_b32 s55, 6
  s_cselect_b32 s57, 4, 0
  s_xor_b32 s3, s3, s57
  s_add_u32 s55, s55, s3
  s_cmp_eq_u32 s55, 32
  s_cselect_b32 s55, 68, s55
  s_lshl_b32 s56, s56, 10
  s_add_u32 m0, s15, 0
  s_nop 0
  buffer_load_dwordx4 v203, s[40:43], s56 offen sc1 lds
  s_add_u32 m0, s15, 1024
  s_nop 0
  buffer_load_dwordx4 v204, s[40:43], s56 offen sc1 lds
  s_waitcnt vmcnt(10)
  s_barrier
  s_cmp_eq_u32 s27, 2
  s_cselect_b32 s57, 64, 0
  v_subrev_u32 v205, s57, v205
  global_load_dword v206, v205, s[12:13] sc1
  s_and_b32 s56, s54, 31
  s_add_u32 s54, s54, 1
  s_and_b32 s3, s54, 4
  s_bitcmp1_b32 s54, 6
  s_cselect_b32 s57, 4, 0
  s_xor_b32 s3, s3, s57
  s_add_u32 s54, s54, s3
  s_cmp_eq_u32 s54, 32
  s_cselect_b32 s54, 68, s54
  s_mul_i32 s56, s56, 36864
  s_add_u32 m0, s14, 12288
  s_nop 0
  buffer_load_dwordx4 v200, s[36:39], s56 offen lds
  s_add_u32 m0, s14, 13312
  s_nop 0
  buffer_load_dwordx4 v201, s[36:39], s56 offen lds
  s_add_u32 m0, s14, 14336
  s_nop 0
  buffer_load_dwordx4 v202, s[36:39], s56 offen lds
  s_and_b32 s56, s55, 31
  s_add_u32 s55, s55, 1
  s_and_b32 s3, s55, 4
  s_bitcmp1_b32 s55, 6
  s_cselect_b32 s57, 4, 0
  s_xor_b32 s3, s3, s57
  s_add_u32 s55, s55, s3
  s_cmp_eq_u32 s55, 32
  s_cselect_b32 s55, 68, s55
  s_lshl_b32 s56, s56, 10
  s_add_u32 m0, s15, 8192
  s_nop 0
  buffer_load_dwordx4 v203, s[40:43], s56 offen sc1 lds
  s_add_u32 m0, s15, 9216
  s_nop 0
  buffer_load_dwordx4 v204, s[40:43], s56 offen sc1 lds
  s_waitcnt vmcnt(11)
  s_barrier
  s_and_b32 s56, s54, 31
  s_add_u32 s54, s54, 1
  s_and_b32 s3, s54, 4
  s_bitcmp1_b32 s54, 6
  s_cselect_b32 s57, 4, 0
  s_xor_b32 s3, s3, s57
  s_add_u32 s54, s54, s3
  s_cmp_eq_u32 s54, 32
  s_cselect_b32 s54, 68, s54
  s_mul_i32 s56, s56, 36864
  s_add_u32 m0, s14, 24576
  s_nop 0
  buffer_load_dwordx4 v200, s[36:39], s56 offen lds
  s_add_u32 m0, s14, 25600
  s_nop 0
  buffer_load_dwordx4 v201, s[36:39], s56 offen lds
  s_add_u32 m0, s14, 26624
  s_nop 0
  buffer_load_dwordx4 v202, s[36:39], s56 offen lds
  s_and_b32 s56, s55, 31
  s_add_u32 s55, s55, 1
  s_and_b32 s3, s55, 4
  s_bitcmp1_b32 s55, 6
  s_cselect_b32 s57, 4, 0
  s_xor_b32 s3, s3, s57
  s_add_u32 s55, s55, s3
  s_cmp_eq_u32 s55, 32
  s_cselect_b32 s55, 68, s55
  s_lshl_b32 s56, s56, 10
  s_add_u32 m0, s15, 16384
  s_nop 0
  buffer_load_dwordx4 v203, s[40:43], s56 offen sc1 lds
  s_add_u32 m0, s15, 17408
  s_nop 0
  buffer_load_dwordx4 v204, s[40:43], s56 offen sc1 lds
  s_waitcnt vmcnt(11)
  s_barrier
  s_lshl_b32 s3, s27, 2
  s_add_u32 s3, s3, s4
  s_cmp_eq_u32 s3, 0
  s_cbranch_scc1 .Lk1_o_161
.Lk1_k_162:
  s_and_b32 s56, s54, 31
  s_add_u32 s54, s54, 1
  s_and_b32 s3, s54, 4
  s_bitcmp1_b32 s54, 6
  s_cselect_b32 s57, 4, 0
  s_xor_b32 s3, s3, s57
  s_add_u32 s54, s54, s3
  s_cmp_eq_u32 s54, 32
  s_cselect_b32 s54, 68, s54
  s_mul_i32 s56, s56, 36864
  s_add_u32 m0, s14, 36864
  s_nop 0
  buffer_load_dwordx4 v200, s[36:39], s56 offen lds
  s_add_u32 m0, s14, 37888
  s_nop 0
  buffer_load_dwordx4 v201, s[36:39], s56 offen lds
  s_add_u32 m0, s14, 38912
  s_nop 0
  buffer_load_dwordx4 v202, s[36:39], s56 offen lds
  s_and_b32 s56, s55, 31
  s_add_u32 s55, s55, 1
  s_and_b32 s3, s55, 4
  s_bitcmp1_b32 s55, 6
  s_cselect_b32 s57, 4, 0
  s_xor_b32 s3, s3, s57
  s_add_u32 s55, s55, s3
  s_cmp_eq_u32 s55, 32
  s_cselect_b32 s55, 68, s55
  s_lshl_b32 s56, s56, 10
  s_add_u32 m0, s15, 24576
  s_nop 0
  buffer_load_dwordx4 v203, s[40:43], s56 offen sc1 lds
  s_add_u32 m0, s15, 25600
  s_nop 0
  buffer_load_dwordx4 v204, s[40:43], s56 offen sc1 lds
  s_add_u32 s27, s27, 1
  s_cmp_lt_u32 s27, 8
  s_cbranch_scc1 .Lk1_loop_157
.Lk1_e_6:
.Lk1_fin:
.Lk1_end:
  s_endpgm
.Lk1_o_7:
.Lk1_sp_9:
  s_sleep 3
  ds_read_b32 v189, v187
  s_waitcnt lgkmcnt(0)
  v_cmp_gt_u32 vcc, 19, v189
  s_nop 0
  s_cbranch_vccnz .Lk1_sp_9
  s_branch .Lk1_k_8
.Lk1_o_11:
  v_mov_b32 v224, v192
  v_mov_b32 v225, v193
  v_mov_b32 v226, v194
  v_mov_b32 v227, v195
  v_mov_b32 v228, v196
  v_mov_b32 v229, v197
  v_mov_b32 v230, v198
  v_mov_b32 v231, v199
  v_mov_b32 v232, v200
  v_mov_b32 v233, v201
  v_mov_b32 v234, v202
  v_mov_b32 v235, v203
  v_mov_b32 v236, v204
  v_mov_b32 v237, v205
  v_mov_b32 v238, v206
  v_mov_b32 v239, v207
  v_mov_b32 v240, v208
  v_mov_b32 v241, v209
  v_mov_b32 v242, v210
  v_mov_b32 v243, v211
  v_mov_b32 v244, v212
  v_mov_b32 v245, v213
  v_mov_b32 v246, v214
  v_mov_b32 v247, v215
  v_mov_b32 v248, v216
  v_mov_b32 v249, v217
  v_mov_b32 v250, v218
  v_mov_b32 v251, v219
  v_mov_b32 v252, v220
  v_mov_b32 v253, v221
  v_mov_b32 v254, v222
  v_mov_b32 v255, v223
  v_mov_b32 v184, 0xf149f2ca
  v_mov_b32 v185, 0xf149f2ca
  s_branch .Lk1_k_12
.Lk1_o_21:
  v_mbcnt_lo_u32_b32 v189, -1, 0
  v_mbcnt_hi_u32_b32 v189, -1, v189
  v_lshlrev_b32 v189, 4, v189
  buffer_store_dwordx4 v[192:195], v189, s[44:47], s88 offen offset:0 sc1
  buffer_store_dwordx4 v[196:199], v189, s[44:47], s88 offen offset:1024 sc1
  s_branch .Lk1_k_22
.Lk1_o_23:
.Lk1_sp_25:
  s_sleep 3
  ds_read_b32 v189, v187
  s_waitcnt lgkmcnt(0)
  v_cmp_gt_u32 vcc, s90, v189
  s_nop 0
  s_cbranch_vccnz .Lk1_sp_25
  s_branch .Lk1_k_24
.Lk1_o_26:
.Lk1_sp_28:
  s_sleep 3
  ds_read_b32 v189, v187
  s_waitcnt lgkmcnt(0)
  v_cmp_gt_u32 vcc, s91, v189
  s_nop 0
  s_cbranch_vccnz .Lk1_sp_28
  s_branch .Lk1_k_27
.Lk1_o_29:
  v_mbcnt_lo_u32_b32 v189, -1, 0
  v_mbcnt_hi_u32_b32 v189, -1, v189
  v_lshlrev_b32 v189, 4, v189
  buffer_store_dwordx4 v[200:203], v189, s[44:47], s88 offen offset:2048 sc1
  buffer_store_dwordx4 v[204:207], v189, s[44:47], s88 offen offset:3072 sc1
  s_branch .Lk1_k_30
.Lk1_o_31:
  v_mbcnt_lo_u32_b32 v189, -1, 0
  v_mbcnt_hi_u32_b32 v189, -1, v189
  v_lshlrev_b32 v189, 4, v189
  buffer_store_dwordx4 v[208:211], v189, s[44:47], s99 offen offset:0 sc1
  buffer_store_dwordx4 v[212:215], v189, s[44:47], s99 offen offset:1024 sc1
  s_branch .Lk1_k_32
.Lk1_o_33:
.Lk1_sp_35:
  s_sleep 3
  ds_read_b32 v189, v187
  s_waitcnt lgkmcnt(0)
  v_cmp_gt_u32 vcc, s92, v189
  s_nop 0
  s_cbranch_vccnz .Lk1_sp_35
  s_branch .Lk1_k_34
.Lk1_o_36:
  s_waitcnt vmcnt(0)
  s_branch .Lk1_k_37
.Lk1_o_15:
.Lk1_sp_17:
  s_sleep 3
  ds_read_b32 v189, v187
  s_waitcnt lgkmcnt(0)
  v_cmp_gt_u32 vcc, s91, v189
  s_nop 0
  s_cbranch_vccnz .Lk1_sp_17
  s_branch .Lk1_k_16
.Lk1_o_18:
.Lk1_sp_20:
  s_sleep 3
  ds_read_b32 v189, v187
  s_waitcnt lgkmcnt(0)
  v_cmp_gt_u32 vcc, s92, v189
  s_nop 0
  s_cbranch_vccnz .Lk1_sp_20
  s_branch .Lk1_k_19
.Lk1_o_13:
  s_waitcnt lgkmcnt(2)
  v_mfma_f32_16x16x32_bf16 v[64:67], v[128:131], v[0:3], 0
  v_mfma_f32_16x16x32_bf16 v[72:75], v[128:131], v[4:7], 0
  ds_read_b128 v[136:139], v162 offset:0
  v_mul_f32 v192, s85, v192
  v_mul_f32 v193, s85, v193
  v_mul_f32 v194, s85, v194
  v_mul_f32 v195, s85, v195
  s_waitcnt lgkmcnt(1)
  v_mfma_f32_16x16x32_bf16 v[64:67], v[132:135], v[8:11], v[64:67]
  v_mfma_f32_16x16x32_bf16 v[72:75], v[132:135], v[12:15], v[72:75]
  ds_read_b128 v[140:143], v163 offset:0
  v_mul_f32 v196, s85, v196
  v_mul_f32 v197, s85, v197
  v_mul_f32 v198, s85, v198
  v_mul_f32 v199, s85, v199
  s_waitcnt lgkmcnt(1)
  v_mfma_f32_16x16x32_bf16 v[64:67], v[136:139], v[16:19], v[64:67]
  v_mfma_f32_16x16x32_bf16 v[72:75], v[136:139], v[20:23], v[72:75]
  ds_read_b128 v[144:147], v160 offset:4096
  v_mul_f32 v200, s85, v200
  v_mul_f32 v201, s85, v201
  v_mul_f32 v202, s85, v202
  v_mul_f32 v203, s85, v203
  s_waitcnt lgkmcnt(1)
  v_mfma_f32_16x16x32_bf16 v[64:67], v[140:143], v[24:27], v[64:67]
  v_mfma_f32_16x16x32_bf16 v[72:75], v[140:143], v[28:31], v[72:75]
  ds_read_b128 v[148:151], v161 offset:4096
  v_mul_f32 v204, s85, v204
  v_mul_f32 v205, s85, v205
  v_mul_f32 v206, s85, v206
  v_mul_f32 v207, s85, v207
  s_waitcnt lgkmcnt(1)
  v_mfma_f32_16x16x32_bf16 v[68:71], v[144:147], v[0:3], 0
  v_mfma_f32_16x16x32_bf16 v[76:79], v[144:147], v[4:7], 0
  ds_read_b128 v[128:131], v162 offset:4096
  v_mul_f32 v208, s85, v208
  v_mul_f32 v209, s85, v209
  v_mul_f32 v210, s85, v210
  v_mul_f32 v211, s85, v211
  s_waitcnt lgkmcnt(1)
  v_mfma_f32_16x16x32_bf16 v[68:71], v[148:151], v[8:11], v[68:71]
  v_mfma_f32_16x16x32_bf16 v[76:79], v[148:151], v[12:15], v[76:79]
  ds_read_b128 v[132:135], v163 offset:4096
  v_mul_f32 v212, s85, v212
  v_mul_f32 v213, s85, v213
  v_mul_f32 v214, s85, v214
  v_mul_f32 v215, s85, v215
  s_waitcnt lgkmcnt(1)
  v_mfma_f32_16x16x32_bf16 v[68:71], v[128:131], v[16:19], v[68:71]
  v_mfma_f32_16x16x32_bf16 v[76:79], v[128:131], v[20:23], v[76:79]
  ds_read_b128 v[136:139], v160 offset:8192
  v_mul_f32 v216, s85, v216
  v_mul_f32 v217, s85, v217
  v_mul_f32 v218, s85, v218
  v_mul_f32 v219, s85, v219
  s_waitcnt lgkmcnt(1)
  v_mfma_f32_16x16x32_bf16 v[68:71], v[132:135], v[24:27], v[68:71]
  v_mfma_f32_16x16x32_bf16 v[76:79], v[132:135], v[28:31], v[76:79]
  ds_read_b128 v[140:143], v161 offset:8192
  v_mul_f32 v220, s85, v220
  v_mul_f32 v221, s85, v221
  v_mul_f32 v222, s85, v222
  v_mul_f32 v223, s85, v223
  s_waitcnt lgkmcnt(1)
  v_mfma_f32_16x16x32_bf16 v[80:83], v[136:139], v[0:3], 0
  v_max3_f32 v184, v184, v64, v65
  v_mfma_f32_16x16x32_bf16 v[88:91], v[136:139], v[4:7], 0
  ds_read_b128 v[144:147], v162 offset:8192
  v_mul_f32 v224, s85, v224
  v_mul_f32 v225, s85, v225
  v_mul_f32 v226, s85, v226
  v_mul_f32 v227, s85, v227
  s_waitcnt lgkmcnt(1)
  v_mfma_f32_16x16x32_bf16 v[80:83], v[140:143], v[8:11], v[80:83]
  v_max3_f32 v184, v184, v66, v67
  v_mfma_f32_16x16x32_bf16 v[88:91], v[140:143], v[12:15], v[88:91]
  ds_read_b128 v[148:151], v163 offset:8192
  v_mul_f32 v228, s85, v228
  v_mul_f32 v229, s85, v229
  v_mul_f32 v230, s85, v230
  v_mul_f32 v231, s85, v231
  s_waitcnt lgkmcnt(1)
  v_mfma_f32_16x16x32_bf16 v[80:83], v[144:147], v[16:19], v[80:83]
  v_max3_f32 v184, v184, v68, v69
  v_mfma_f32_16x16x32_bf16 v[88:91], v[144:147], v[20:23], v[88:91]
  ds_read_b128 v[128:131], v160 offset:12288
  v_mul_f32 v232, s85, v232
  v_mul_f32 v233, s85, v233
  v_mul_f32 v234, s85, v234
  v_mul_f32 v235, s85, v235
  s_waitcnt lgkmcnt(1)
  v_mfma_f32_16x16x32_bf16 v[80:83], v[148:151], v[24:27], v[80:83]
  v_max3_f32 v184, v184, v70, v71
  v_mfma_f32_16x16x32_bf16 v[88:91], v[148:151], v[28:31], v[88:91]
  ds_read_b128 v[132:135], v161 offset:12288
  v_mul_f32 v236, s85, v236
  v_mul_f32 v237, s85, v237
  v_mul_f32 v238, s85, v238
  v_mul_f32 v239, s85, v239
  s_waitcnt lgkmcnt(1)
  v_mfma_f32_16x16x32_bf16 v[84:87], v[128:131], v[0:3], 0
  v_max3_f32 v185, v185, v72, v73
  v_mfma_f32_16x16x32_bf16 v[92:95], v[128:131], v[4:7], 0
  ds_read_b128 v[136:139], v162 offset:12288
  v_mul_f32 v240, s85, v240
  v_mul_f32 v241, s85, v241
  v_mul_f32 v242, s85, v242
  v_mul_f32 v243, s85, v243
  s_waitcnt lgkmcnt(1)
  v_mfma_f32_16x16x32_bf16 v[84:87], v[132:135], v[8:11], v[84:87]
  v_max3_f32 v185, v185, v74, v75
  v_mfma_f32_16x16x32_bf16 v[92:95], v[132:135], v[12:15], v[92:95]
  ds_read_b128 v[140:143], v163 offset:12288
  v_mul_f32 v244, s85, v244
  v_mul_f32 v245, s85, v245
  v_mul_f32 v246, s85, v246
  v_mul_f32 v247, s85, v247
  s_waitcnt lgkmcnt(1)
  v_mfma_f32_16x16x32_bf16 v[84:87], v[136:139], v[16:19], v[84:87]
  v_max3_f32 v185, v185, v76, v77
  v_mfma_f32_16x16x32_bf16 v[92:95], v[136:139], v[20:23], v[92:95]
  v_mul_f32 v248, s85, v248
  v_mul_f32 v249, s85, v249
  v_mul_f32 v250, s85, v250
  v_mul_f32 v251, s85, v251
  s_waitcnt lgkmcnt(0)
  v_mfma_f32_16x16x32_bf16 v[84:87], v[140:143], v[24:27], v[84:87]
  v_max3_f32 v185, v185, v78, v79
  v_mfma_f32_16x16x32_bf16 v[92:95], v[140:143], v[28:31], v[92:95]
  v_mul_f32 v252, s85, v252
  v_mul_f32 v253, s85, v253
  v_mul_f32 v254, s85, v254
  v_mul_f32 v255, s85, v255
  v_max3_f32 v184, v184, v80, v81
  v_cvt_pk_bf16_f32 v192, v192, v193
  v_cvt_pk_bf16_f32 v193, v194, v195
  v_cvt_pk_bf16_f32 v194, v200, v201
  v_cvt_pk_bf16_f32 v195, v202, v203
  v_max3_f32 v184, v184, v82, v83
  v_cvt_pk_bf16_f32 v196, v196, v197
  v_cvt_pk_bf16_f32 v197, v198, v199
  v_cvt_pk_bf16_f32 v198, v204, v205
  v_cvt_pk_bf16_f32 v199, v206, v207
  v_max3_f32 v184, v184, v84, v85
  v_cvt_pk_bf16_f32 v200, v208, v209
  v_cvt_pk_bf16_f32 v201, v210, v211
  v_cvt_pk_bf16_f32 v202, v216, v217
  v_cvt_pk_bf16_f32 v203, v218, v219
  v_max3_f32 v184, v184, v86, v87
  ds_read_b32 v189, v187
  v_cvt_pk_bf16_f32 v204, v212, v213
  v_cvt_pk_bf16_f32 v205, v214, v215
  v_cvt_pk_bf16_f32 v206, v220, v221
  v_cvt_pk_bf16_f32 v207, v222, v223
  v_max3_f32 v185, v185, v88, v89
  v_cvt_pk_bf16_f32 v208, v224, v225
  v_cvt_pk_bf16_f32 v209, v226, v227
  v_cvt_pk_bf16_f32 v210, v232, v233
  v_cvt_pk_bf16_f32 v211, v234, v235
  v_max3_f32 v185, v185, v90, v91
  s_waitcnt lgkmcnt(0)
  v_cmp_gt_u32 vcc, s91, v189
  s_cbranch_vccnz .Lk1_o_15
.Lk1_k_16:
  v_cvt_pk_bf16_f32 v212, v228, v229
  v_cvt_pk_bf16_f32 v213, v230, v231
  v_cvt_pk_bf16_f32 v214, v236, v237
  v_cvt_pk_bf16_f32 v215, v238, v239
  v_exp_f32 v64, v64
  ds_read_b128 v[128:131], v160 offset:16384
  v_max3_f32 v185, v185, v92, v93
  v_cvt_pk_bf16_f32 v216, v240, v241
  v_cvt_pk_bf16_f32 v217, v242, v243
  v_cvt_pk_bf16_f32 v218, v248, v249
  v_cvt_pk_bf16_f32 v219, v250, v251
  v_exp_f32 v65, v65
  ds_read_b128 v[132:135], v161 offset:16384
  v_max3_f32 v185, v185, v94, v95
  v_cvt_pk_bf16_f32 v220, v244, v245
  v_cvt_pk_bf16_f32 v221, v246, v247
  v_cvt_pk_bf16_f32 v222, v252, v253
  v_cvt_pk_bf16_f32 v223, v254, v255
  s_waitcnt lgkmcnt(1)
  v_mfma_f32_16x16x32_bf16 v[96:99], v[128:131], v[0:3], 0
  v_exp_f32 v66, v66
  v_mfma_f32_16x16x32_bf16 v[104:107], v[128:131], v[4:7], 0
  ds_read_b128 v[136:139], v162 offset:16384
  v_cvt_pk_bf16_f32 v64, v64, v65
  v_permlane32_swap_b32 v192, v194
  v_permlane32_swap_b32 v193, v195
  v_permlane32_swap_b32 v196, v198
  v_permlane32_swap_b32 v197, v199
  s_waitcnt lgkmcnt(1)
  v_mfma_f32_16x16x32_bf16 v[96:99], v[132:135], v[8:11], v[96:99]
  v_exp_f32 v67, v67
  v_mfma_f32_16x16x32_bf16 v[104:107], v[132:135], v[12:15], v[104:107]
  ds_read_b128 v[140:143], v163 offset:16384
  v_permlane32_swap_b32 v200, v202
  v_permlane32_swap_b32 v201, v203
  v_permlane32_swap_b32 v204, v206
  v_permlane32_swap_b32 v205, v207
  s_waitcnt lgkmcnt(1)
  v_mfma_f32_16x16x32_bf16 v[96:99], v[136:139], v[16:19], v[96:99]
  v_exp_f32 v68, v68
  v_mfma_f32_16x16x32_bf16 v[104:107], v[136:139], v[20:23], v[104:107]
  ds_read_b128 v[144:147], v160 offset:20480
  v_cvt_pk_bf16_f32 v65, v66, v67
  v_permlane32_swap_b32 v208, v210
  v_permlane32_swap_b32 v209, v211
  v_permlane32_swap_b32 v212, v214
  v_permlane32_swap_b32 v213, v215
  s_waitcnt lgkmcnt(1)
  v_mfma_f32_16x16x32_bf16 v[96:99], v[140:143], v[24:27], v[96:99]
  v_exp_f32 v69, v69
  v_mfma_f32_16x16x32_bf16 v[104:107], v[140:143], v[28:31], v[104:107]
  ds_read_b128 v[148:151], v161 offset:20480
  v_permlane32_swap_b32 v216, v218
  v_permlane32_swap_b32 v217, v219
  v_permlane32_swap_b32 v220, v222
  v_permlane32_swap_b32 v221, v223
  s_waitcnt lgkmcnt(1)
  v_mfma_f32_16x16x32_bf16 v[100:103], v[144:147], v[0:3], 0
  v_exp_f32 v70, v70
  v_mfma_f32_16x16x32_bf16 v[108:111], v[144:147], v[4:7], 0
  ds_read_b128 v[128:131], v162 offset:20480
  v_cvt_pk_bf16_f32 v66, v68, v69
  v_permlane16_swap_b32 v192, v194
  v_permlane16_swap_b32 v193, v195
  v_permlane16_swap_b32 v196, v198
  v_permlane16_swap_b32 v197, v199
  s_waitcnt lgkmcnt(1)
  v_mfma_f32_16x16x32_bf16 v[100:103], v[148:151], v[8:11], v[100:103]
  v_exp_f32 v71, v71
  v_mfma_f32_16x16x32_bf16 v[108:111], v[148:151], v[12:15], v[108:111]
  ds_read_b128 v[132:135], v163 offset:20480
  v_permlane16_swap_b32 v200, v202
  v_permlane16_swap_b32 v201, v203
  v_permlane16_swap_b32 v204, v206
  v_permlane16_swap_b32 v205, v207
  s_waitcnt lgkmcnt(1)
  v_mfma_f32_16x16x32_bf16 v[100:103], v[128:131], v[16:19], v[100:103]
  v_exp_f32 v72, v72
  v_mfma_f32_16x16x32_bf16 v[108:111], v[128:131], v[20:23], v[108:111]
  ds_read_b128 v[136:139], v160 offset:24576
  v_cvt_pk_bf16_f32 v67, v70, v71
  v_permlane16_swap_b32 v208, v210
  v_permlane16_swap_b32 v209, v211
  v_permlane16_swap_b32 v212, v214
  v_permlane16_swap_b32 v213, v215
  s_waitcnt lgkmcnt(1)
  v_mfma_f32_16x16x32_bf16 v[100:103], v[132:135], v[24:27], v[100:103]
  v_exp_f32 v73, v73
  v_mfma_f32_16x16x32_bf16 v[108:111], v[132:135], v[28:31], v[108:111]
  ds_read_b128 v[140:143], v161 offset:24576
  v_permlane16_swap_b32 v216, v218
  v_permlane16_swap_b32 v217, v219
  v_permlane16_swap_b32 v220, v222
  v_permlane16_swap_b32 v221, v223
  s_waitcnt lgkmcnt(1)
  v_mfma_f32_16x16x32_bf16 v[112:115], v[136:139], v[0:3], 0
  v_exp_f32 v74, v74
  v_mfma_f32_16x16x32_bf16 v[120:123], v[136:139], v[4:7], 0
  ds_read_b128 v[144:147], v162 offset:24576
  v_max3_f32 v184, v184, v96, v97
  v_cvt_pk_bf16_f32 v72, v72, v73
  s_waitcnt lgkmcnt(1)
  v_mfma_f32_16x16x32_bf16 v[112:115], v[140:143], v[8:11], v[112:115]
  v_exp_f32 v75, v75
  v_mfma_f32_16x16x32_bf16 v[120:123], v[140:143], v[12:15], v[120:123]
  ds_read_b128 v[148:151], v163 offset:24576
  v_max3_f32 v184, v184, v98, v99
  s_waitcnt lgkmcnt(1)
  v_mfma_f32_16x16x32_bf16 v[112:115], v[144:147], v[16:19], v[112:115]
  v_exp_f32 v76, v76
  v_mfma_f32_16x16x32_bf16 v[120:123], v[144:147], v[20:23], v[120:123]
  ds_read_b128 v[128:131], v160 offset:28672
  v_max3_f32 v184, v184, v100, v101
  v_cvt_pk_bf16_f32 v73, v74, v75
  s_waitcnt lgkmcnt(1)
  v_mfma_f32_16x16x32_bf16 v[112:115], v[148:151], v[24:27], v[112:115]
  v_exp_f32 v77, v77
  v_mfma_f32_16x16x32_bf16 v[120:123], v[148:151], v[28:31], v[120:123]
  ds_read_b128 v[132:135], v161 offset:28672
  v_max3_f32 v184, v184, v102, v103
  s_waitcnt lgkmcnt(1)
  v_mfma_f32_16x16x32_bf16 v[116:119], v[128:131], v[0:3], 0
  v_exp_f32 v78, v78
  v_mfma_f32_16x16x32_bf16 v[124:127], v[128:131], v[4:7], 0
  ds_read_b128 v[136:139], v162 offset:28672
  v_max3_f32 v185, v185, v104, v105
  v_cvt_pk_bf16_f32 v74, v76, v77
  s_waitcnt lgkmcnt(1)
  v_mfma_f32_16x16x32_bf16 v[116:119], v[132:135], v[8:11], v[116:119]
  v_exp_f32 v79, v79
  v_mfma_f32_16x16x32_bf16 v[124:127], v[132:135], v[12:15], v[124:127]
  ds_read_b128 v[140:143], v163 offset:28672
  v_max3_f32 v185, v185, v106, v107
  s_waitcnt lgkmcnt(1)
  v_mfma_f32_16x16x32_bf16 v[116:119], v[136:139], v[16:19], v[116:119]
  v_exp_f32 v80, v80
  v_mfma_f32_16x16x32_bf16 v[124:127], v[136:139], v[20:23], v[124:127]
  v_max3_f32 v185, v185, v108, v109
  v_cvt_pk_bf16_f32 v75, v78, v79
  s_waitcnt lgkmcnt(0)
  v_mfma_f32_16x16x32_bf16 v[116:119], v[140:143], v[24:27], v[116:119]
  v_exp_f32 v81, v81
  v_mfma_f32_16x16x32_bf16 v[124:127], v[140:143], v[28:31], v[124:127]
  v_max3_f32 v185, v185, v110, v111
  v_exp_f32 v82, v82
  v_max3_f32 v184, v184, v112, v113
  v_cvt_pk_bf16_f32 v80, v80, v81
  v_mov_b32 v224, v0
  v_mov_b32 v225, v1
  v_mov_b32 v226, v2
  v_mov_b32 v227, v3
  v_exp_f32 v83, v83
  v_max3_f32 v184, v184, v114, v115
  v_mov_b32 v228, v4
  v_mov_b32 v229, v5
  v_mov_b32 v230, v6
  v_mov_b32 v231, v7
  v_exp_f32 v84, v84
  v_max3_f32 v184, v184, v116, v117
  v_cvt_pk_bf16_f32 v81, v82, v83
  v_mov_b32 v232, v8
  v_mov_b32 v233, v9
  v_mov_b32 v234, v10
  v_mov_b32 v235, v11
  v_exp_f32 v85, v85
  ds_read_b32 v189, v187
  v_max3_f32 v184, v184, v118, v119
  v_mov_b32 v236, v12
  v_mov_b32 v237, v13
  v_mov_b32 v238, v14
  v_mov_b32 v239, v15
  v_exp_f32 v86, v86
  v_max3_f32 v185, v185, v120, v121
  v_cvt_pk_bf16_f32 v82, v84, v85
  v_mov_b32 v240, v16
  v_mov_b32 v241, v17
  v_mov_b32 v242, v18
  v_mov_b32 v243, v19
  v_exp_f32 v87, v87
  s_waitcnt lgkmcnt(0)
  v_cmp_gt_u32 vcc, s92, v189
  s_cbranch_vccnz .Lk1_o_18
.Lk1_k_19:
  v_max3_f32 v185, v185, v122, v123
  v_mov_b32 v244, v20
  v_mov_b32 v245, v21
  v_mov_b32 v246, v22
  v_mov_b32 v247, v23
  v_exp_f32 v88, v88
  ds_read_b64_tr_b16 v[128:129], v168 offset:0
  ds_read_b64_tr_b16 v[130:131], v168 offset:4096
  v_max3_f32 v185, v185, v124, v125
  v_cvt_pk_bf16_f32 v83, v86, v87
  v_mov_b32 v248, v24
  v_mov_b32 v249, v25
  v_mov_b32 v250, v26
  v_mov_b32 v251, v27
  v_exp_f32 v89, v89
  v_mov_b32 v190, s94
  ds_write_b32 v186, v190 offset:0
  ds_read_b64_tr_b16 v[132:133], v169 offset:0
  ds_read_b64_tr_b16 v[134:135], v169 offset:4096
  v_max3_f32 v185, v185, v126, v127
  v_mov_b32 v252, v28
  v_mov_b32 v253, v29
  v_mov_b32 v254, v30
  v_mov_b32 v255, v31
  s_branch .Lk1_k_14
.Lk1_o_38:
  v_rcp_f32 v176, v152
  v_rcp_f32 v177, v156
  v_mov_b32 v188, 0
  v_mov_b32 v191, 0
  s_mov_b32 s7, 0x42800000
  s_branch .Lk1_k_39
.Lk1_o_60:
  v_mbcnt_lo_u32_b32 v189, -1, 0
  v_mbcnt_hi_u32_b32 v189, -1, v189
  v_lshlrev_b32 v189, 4, v189
  buffer_store_dwordx4 v[216:219], v189, s[44:47], s99 offen offset:2048 sc1
  buffer_store_dwordx4 v[220:223], v189, s[44:47], s99 offen offset:3072 sc1
  s_branch .Lk1_k_61
.Lk1_o_56:
  v_mbcnt_lo_u32_b32 v189, -1, 0
  v_mbcnt_hi_u32_b32 v189, -1, v189
  v_lshlrev_b32 v189, 4, v189
  buffer_store_dwordx4 v[216:219], v189, s[44:47], s99 offen offset:2048 sc1
  buffer_store_dwordx4 v[220:223], v189, s[44:47], s99 offen offset:3072 sc1
  s_branch .Lk1_k_57
.Lk1_o_58:
  v_mbcnt_lo_u32_b32 v189, -1, 0
  v_mbcnt_hi_u32_b32 v189, -1, v189
  v_lshlrev_b32 v189, 4, v189
  buffer_store_dwordx4 v[216:219], v189, s[44:47], s99 offen offset:2048 sc1
  buffer_store_dwordx4 v[220:223], v189, s[44:47], s99 offen offset:3072 sc1
  s_branch .Lk1_k_59
.Lk1_o_52:
  s_cmp_eq_u32 s27, 4
  s_cbranch_scc0 .Lk1_b_54
  v_mul_f32 v0, v0, v176
  v_mul_f32 v1, v1, v176
  v_mul_f32 v2, v2, v176
  v_mul_f32 v3, v3, v176
  v_mul_f32 v4, v4, v176
  v_mul_f32 v5, v5, v176
  v_mul_f32 v6, v6, v176
  v_mul_f32 v7, v7, v176
  v_cvt_pk_bf16_f32 v192, v0, v1
  v_cvt_pk_bf16_f32 v193, v2, v3
  v_cvt_pk_bf16_f32 v194, v4, v5
  v_cvt_pk_bf16_f32 v195, v6, v7
  v_mul_f32 v32, v32, v177
  v_mul_f32 v33, v33, v177
  v_mul_f32 v34, v34, v177
  v_mul_f32 v35, v35, v177
  v_mul_f32 v36, v36, v177
  v_mul_f32 v37, v37, v177
  v_mul_f32 v38, v38, v177
  v_mul_f32 v39, v39, v177
  v_cvt_pk_bf16_f32 v208, v32, v33
  v_cvt_pk_bf16_f32 v209, v34, v35
  v_cvt_pk_bf16_f32 v210, v36, v37
  v_cvt_pk_bf16_f32 v211, v38, v39
  s_waitcnt lgkmcnt(3)
  v_mfma_f32_16x16x32_bf16 v[0:3], v[128:131], v[64:67], 0
  v_exp_f32 v90, v90
  v_mfma_f32_16x16x32_bf16 v[32:35], v[128:131], v[72:75], 0
  ds_read_b64_tr_b16 v[136:137], v170 offset:0
  ds_read_b64_tr_b16 v[138:139], v170 offset:4096
  v_cvt_pk_bf16_f32 v88, v88, v89
  s_waitcnt lgkmcnt(2)
  v_mfma_f32_16x16x32_bf16 v[4:7], v[132:135], v[64:67], 0
  v_exp_f32 v91, v91
  v_mfma_f32_16x16x32_bf16 v[36:39], v[132:135], v[72:75], 0
  v_mov_b32 v190, s95
  ds_write_b32 v186, v190 offset:0
  ds_read_b64_tr_b16 v[140:141], v171 offset:0
  ds_read_b64_tr_b16 v[142:143], v171 offset:4096
  v_mul_f32 v8, v8, v176
  v_mul_f32 v9, v9, v176
  v_mul_f32 v10, v10, v176
  v_mul_f32 v11, v11, v176
  v_mul_f32 v12, v12, v176
  v_mul_f32 v13, v13, v176
  v_mul_f32 v14, v14, v176
  v_mul_f32 v15, v15, v176
  v_cvt_pk_bf16_f32 v196, v8, v9
  v_cvt_pk_bf16_f32 v197, v10, v11
  v_cvt_pk_bf16_f32 v198, v12, v13
  v_cvt_pk_bf16_f32 v199, v14, v15
  v_mul_f32 v40, v40, v177
  v_mul_f32 v41, v41, v177
  v_mul_f32 v42, v42, v177
  v_mul_f32 v43, v43, v177
  v_mul_f32 v44, v44, v177
  v_mul_f32 v45, v45, v177
  v_mul_f32 v46, v46, v177
  v_mul_f32 v47, v47, v177
  v_cvt_pk_bf16_f32 v212, v40, v41
  v_cvt_pk_bf16_f32 v213, v42, v43
  v_cvt_pk_bf16_f32 v214, v44, v45
  v_cvt_pk_bf16_f32 v215, v46, v47
  s_waitcnt lgkmcnt(3)
  v_mfma_f32_16x16x32_bf16 v[8:11], v[136:139], v[64:67], 0
  v_exp_f32 v92, v92
  v_mfma_f32_16x16x32_bf16 v[40:43], v[136:139], v[72:75], 0
  v_mfma_f32_16x16x32_bf16 v[152:155], v[164:167], v[64:67], 0
  ds_read_b64_tr_b16 v[144:145], v172 offset:0
  ds_read_b64_tr_b16 v[146:147], v172 offset:4096
  v_cvt_pk_bf16_f32 v89, v90, v91
  v_xor_b32 v160, 0x10000, v160
  s_waitcnt lgkmcnt(2)
  v_mfma_f32_16x16x32_bf16 v[12:15], v[140:143], v[64:67], 0
  v_exp_f32 v93, v93
  v_mfma_f32_16x16x32_bf16 v[44:47], v[140:143], v[72:75], 0
  ds_read_b64_tr_b16 v[148:149], v173 offset:0
  ds_read_b64_tr_b16 v[150:151], v173 offset:4096
  v_mul_f32 v16, v16, v176
  v_mul_f32 v17, v17, v176
  v_mul_f32 v18, v18, v176
  v_mul_f32 v19, v19, v176
  v_mul_f32 v20, v20, v176
  v_mul_f32 v21, v21, v176
  v_mul_f32 v22, v22, v176
  v_mul_f32 v23, v23, v176
  v_cvt_pk_bf16_f32 v200, v16, v17
  v_cvt_pk_bf16_f32 v201, v18, v19
  v_cvt_pk_bf16_f32 v202, v20, v21
  v_cvt_pk_bf16_f32 v203, v22, v23
  v_mul_f32 v48, v48, v177
  v_mul_f32 v49, v49, v177
  v_mul_f32 v50, v50, v177
  v_mul_f32 v51, v51, v177
  v_mul_f32 v52, v52, v177
  v_mul_f32 v53, v53, v177
  v_mul_f32 v54, v54, v177
  v_mul_f32 v55, v55, v177
  v_cvt_pk_bf16_f32 v216, v48, v49
  v_cvt_pk_bf16_f32 v217, v50, v51
  v_cvt_pk_bf16_f32 v218, v52, v53
  v_cvt_pk_bf16_f32 v219, v54, v55
  v_xor_b32 v161, 0x10000, v161
  s_waitcnt lgkmcnt(2)
  v_mfma_f32_16x16x32_bf16 v[16:19], v[144:147], v[64:67], 0
  v_exp_f32 v94, v94
  v_mfma_f32_16x16x32_bf16 v[48:51], v[144:147], v[72:75], 0
  ds_read_b64_tr_b16 v[128:129], v174 offset:0
  ds_read_b64_tr_b16 v[130:131], v174 offset:4096
  v_cvt_pk_bf16_f32 v90, v92, v93
  v_xor_b32 v162, 0x10000, v162
  s_waitcnt lgkmcnt(2)
  v_mfma_f32_16x16x32_bf16 v[20:23], v[148:151], v[64:67], 0
  v_exp_f32 v95, v95
  v_mfma_f32_16x16x32_bf16 v[52:55], v[148:151], v[72:75], 0
  v_mfma_f32_16x16x32_bf16 v[156:159], v[164:167], v[72:75], 0
  ds_read_b64_tr_b16 v[132:133], v175 offset:0
  ds_read_b64_tr_b16 v[134:135], v175 offset:4096
  v_mul_f32 v24, v24, v176
  v_mul_f32 v25, v25, v176
  v_mul_f32 v26, v26, v176
  v_mul_f32 v27, v27, v176
  v_mul_f32 v28, v28, v176
  v_mul_f32 v29, v29, v176
  v_mul_f32 v30, v30, v176
  v_mul_f32 v31, v31, v176
  v_cvt_pk_bf16_f32 v204, v24, v25
  v_cvt_pk_bf16_f32 v205, v26, v27
  v_cvt_pk_bf16_f32 v206, v28, v29
  v_cvt_pk_bf16_f32 v207, v30, v31
  v_mul_f32 v56, v56, v177
  v_mul_f32 v57, v57, v177
  v_mul_f32 v58, v58, v177
  v_mul_f32 v59, v59, v177
  v_mul_f32 v60, v60, v177
  v_mul_f32 v61, v61, v177
  v_mul_f32 v62, v62, v177
  v_mul_f32 v63, v63, v177
  v_cvt_pk_bf16_f32 v220, v56, v57
  v_cvt_pk_bf16_f32 v221, v58, v59
  v_cvt_pk_bf16_f32 v222, v60, v61
  v_cvt_pk_bf16_f32 v223, v62, v63
  v_xor_b32 v163, 0x10000, v163
  s_waitcnt lgkmcnt(2)
  v_mfma_f32_16x16x32_bf16 v[24:27], v[128:131], v[64:67], 0
  v_exp_f32 v96, v96
  v_mfma_f32_16x16x32_bf16 v[56:59], v[128:131], v[72:75], 0
  ds_read_b64_tr_b16 v[136:137], v168 offset:8192
  ds_read_b64_tr_b16 v[138:139], v168 offset:12288
  v_cvt_pk_bf16_f32 v91, v94, v95
  s_cmp_eq_u32 s27, 5
  s_cbranch_scc1 .Lk1_o_56
.Lk1_k_57:
  s_waitcnt lgkmcnt(2)
  v_mfma_f32_16x16x32_bf16 v[28:31], v[132:135], v[64:67], 0
  v_exp_f32 v97, v97
  v_mfma_f32_16x16x32_bf16 v[60:63], v[132:135], v[72:75], 0
  ds_read_b64_tr_b16 v[140:141], v169 offset:8192
  ds_read_b64_tr_b16 v[142:143], v169 offset:12288
  s_branch .Lk1_e_55
.Lk1_b_54:
  s_waitcnt lgkmcnt(3)
  v_mfma_f32_16x16x32_bf16 v[0:3], v[128:131], v[64:67], 0
  v_exp_f32 v90, v90
  v_mfma_f32_16x16x32_bf16 v[32:35], v[128:131], v[72:75], 0
  ds_read_b64_tr_b16 v[136:137], v170 offset:0
  ds_read_b64_tr_b16 v[138:139], v170 offset:4096
  v_cvt_pk_bf16_f32 v88, v88, v89
  s_waitcnt lgkmcnt(2)
  v_mfma_f32_16x16x32_bf16 v[4:7], v[132:135], v[64:67], 0
  v_exp_f32 v91, v91
  v_mfma_f32_16x16x32_bf16 v[36:39], v[132:135], v[72:75], 0
  v_mov_b32 v190, s95
  ds_write_b32 v186, v190 offset:0
  ds_read_b64_tr_b16 v[140:141], v171 offset:0
  ds_read_b64_tr_b16 v[142:143], v171 offset:4096
  s_waitcnt lgkmcnt(3)
  v_mfma_f32_16x16x32_bf16 v[8:11], v[136:139], v[64:67], 0
  v_exp_f32 v92, v92
  v_mfma_f32_16x16x32_bf16 v[40:43], v[136:139], v[72:75], 0
  v_mfma_f32_16x16x32_bf16 v[152:155], v[164:167], v[64:67], 0
  ds_read_b64_tr_b16 v[144:145], v172 offset:0
  ds_read_b64_tr_b16 v[146:147], v172 offset:4096
  v_cvt_pk_bf16_f32 v89, v90, v91
  v_xor_b32 v160, 0x10000, v160
  s_waitcnt lgkmcnt(2)
  v_mfma_f32_16x16x32_bf16 v[12:15], v[140:143], v[64:67], 0
  v_exp_f32 v93, v93
  v_mfma_f32_16x16x32_bf16 v[44:47], v[140:143], v[72:75], 0
  ds_read_b64_tr_b16 v[148:149], v173 offset:0
  ds_read_b64_tr_b16 v[150:151], v173 offset:4096
  v_xor_b32 v161, 0x10000, v161
  s_waitcnt lgkmcnt(2)
  v_mfma_f32_16x16x32_bf16 v[16:19], v[144:147], v[64:67], 0
  v_exp_f32 v94, v94
  v_mfma_f32_16x16x32_bf16 v[48:51], v[144:147], v[72:75], 0
  ds_read_b64_tr_b16 v[128:129], v174 offset:0
  ds_read_b64_tr_b16 v[130:131], v174 offset:4096
  v_cvt_pk_bf16_f32 v90, v92, v93
  v_xor_b32 v162, 0x10000, v162
  s_waitcnt lgkmcnt(2)
  v_mfma_f32_16x16x32_bf16 v[20:23], v[148:151], v[64:67], 0
  v_exp_f32 v95, v95
  v_mfma_f32_16x16x32_bf16 v[52:55], v[148:151], v[72:75], 0
  v_mfma_f32_16x16x32_bf16 v[156:159], v[164:167], v[72:75], 0
  ds_read_b64_tr_b16 v[132:133], v175 offset:0
  ds_read_b64_tr_b16 v[134:135], v175 offset:4096
  v_xor_b32 v163, 0x10000, v163
  s_waitcnt lgkmcnt(2)
  v_mfma_f32_16x16x32_bf16 v[24:27], v[128:131], v[64:67], 0
  v_exp_f32 v96, v96
  v_mfma_f32_16x16x32_bf16 v[56:59], v[128:131], v[72:75], 0
  ds_read_b64_tr_b16 v[136:137], v168 offset:8192
  ds_read_b64_tr_b16 v[138:139], v168 offset:12288
  v_cvt_pk_bf16_f32 v91, v94, v95
  s_cmp_eq_u32 s27, 5
  s_cbranch_scc1 .Lk1_o_58
.Lk1_k_59:
  s_waitcnt lgkmcnt(2)
  v_mfma_f32_16x16x32_bf16 v[28:31], v[132:135], v[64:67], 0
  v_exp_f32 v97, v97
  v_mfma_f32_16x16x32_bf16 v[60:63], v[132:135], v[72:75], 0
  ds_read_b64_tr_b16 v[140:141], v169 offset:8192
  ds_read_b64_tr_b16 v[142:143], v169 offset:12288
.Lk1_e_55:
  s_branch .Lk1_k_53
.Lk1_o_62:
.Lk1_sp_64:
  s_sleep 3
  ds_read_b32 v189, v187
  s_waitcnt lgkmcnt(0)
  v_cmp_gt_u32 vcc, s93, v189
  s_nop 0
  s_cbranch_vccnz .Lk1_sp_64
  s_branch .Lk1_k_63
.Lk1_o_47:
  v_mbcnt_lo_u32_b32 v189, -1, 0
  v_mbcnt_hi_u32_b32 v189, -1, v189
  v_lshlrev_b32 v189, 4, v189
  buffer_store_dwordx4 v[216:219], v189, s[44:47], s99 offen offset:2048 sc1
  buffer_store_dwordx4 v[220:223], v189, s[44:47], s99 offen offset:3072 sc1
  s_branch .Lk1_k_48
.Lk1_o_45:
  v_mbcnt_lo_u32_b32 v189, -1, 0
  v_mbcnt_hi_u32_b32 v189, -1, v189
  v_lshlrev_b32 v189, 4, v189
  buffer_store_dwordx4 v[216:219], v189, s[44:47], s99 offen offset:2048 sc1
  buffer_store_dwordx4 v[220:223], v189, s[44:47], s99 offen offset:3072 sc1
  s_branch .Lk1_k_46
.Lk1_o_43:
  s_waitcnt lgkmcnt(2)
  v_mfma_f32_16x16x32_bf16 v[0:3], v[128:131], v[64:67], 0
  v_mfma_f32_16x16x32_bf16 v[32:35], v[128:131], v[72:75], 0
  ds_read_b64_tr_b16 v[136:137], v170 offset:0
  ds_read_b64_tr_b16 v[138:139], v170 offset:4096
  s_waitcnt lgkmcnt(2)
  v_mfma_f32_16x16x32_bf16 v[4:7], v[132:135], v[64:67], 0
  v_mfma_f32_16x16x32_bf16 v[36:39], v[132:135], v[72:75], 0
  v_mov_b32 v190, s95
  ds_write_b32 v186, v190 offset:0
  ds_read_b64_tr_b16 v[140:141], v171 offset:0
  ds_read_b64_tr_b16 v[142:143], v171 offset:4096
  s_waitcnt lgkmcnt(3)
  v_mfma_f32_16x16x32_bf16 v[8:11], v[136:139], v[64:67], 0
  v_mfma_f32_16x16x32_bf16 v[40:43], v[136:139], v[72:75], 0
  v_mfma_f32_16x16x32_bf16 v[152:155], v[164:167], v[64:67], 0
  ds_read_b64_tr_b16 v[144:145], v172 offset:0
  ds_read_b64_tr_b16 v[146:147], v172 offset:4096
  v_xor_b32 v160, 0x10000, v160
  s_waitcnt lgkmcnt(2)
  v_mfma_f32_16x16x32_bf16 v[12:15], v[140:143], v[64:67], 0
  v_mfma_f32_16x16x32_bf16 v[44:47], v[140:143], v[72:75], 0
  ds_read_b64_tr_b16 v[148:149], v173 offset:0
  ds_read_b64_tr_b16 v[150:151], v173 offset:4096
  v_xor_b32 v161, 0x10000, v161
  s_waitcnt lgkmcnt(2)
  v_mfma_f32_16x16x32_bf16 v[16:19], v[144:147], v[64:67], 0
  v_mfma_f32_16x16x32_bf16 v[48:51], v[144:147], v[72:75], 0
  ds_read_b64_tr_b16 v[128:129], v174 offset:0
  ds_read_b64_tr_b16 v[130:131], v174 offset:4096
  v_xor_b32 v162, 0x10000, v162
  s_waitcnt lgkmcnt(2)
  v_mfma_f32_16x16x32_bf16 v[20:23], v[148:151], v[64:67], 0
  v_mfma_f32_16x16x32_bf16 v[52:55], v[148:151], v[72:75], 0
  v_mfma_f32_16x16x32_bf16 v[156:159], v[164:167], v[72:75], 0
  ds_read_b64_tr_b16 v[132:133], v175 offset:0
  ds_read_b64_tr_b16 v[134:135], v175 offset:4096
  v_xor_b32 v163, 0x10000, v163
  s_waitcnt lgkmcnt(2)
  v_mfma_f32_16x16x32_bf16 v[24:27], v[128:131], v[64:67], 0
  v_mfma_f32_16x16x32_bf16 v[56:59], v[128:131], v[72:75], 0
  ds_read_b64_tr_b16 v[136:137], v168 offset:8192
  ds_read_b64_tr_b16 v[138:139], v168 offset:12288
  s_cmp_eq_u32 s27, 5
  s_cbranch_scc1 .Lk1_o_45
.Lk1_k_46:
  s_waitcnt lgkmcnt(2)
  v_mfma_f32_16x16x32_bf16 v[28:31], v[132:135], v[64:67], 0
  v_mfma_f32_16x16x32_bf16 v[60:63], v[132:135], v[72:75], 0
  ds_read_b64_tr_b16 v[140:141], v169 offset:8192
  ds_read_b64_tr_b16 v[142:143], v169 offset:12288
  s_branch .Lk1_k_44
.Lk1_o_49:
.Lk1_sp_51:
  s_sleep 3
  ds_read_b32 v189, v187
  s_waitcnt lgkmcnt(0)
  v_cmp_gt_u32 vcc, s93, v189
  s_nop 0
  s_cbranch_vccnz .Lk1_sp_51
  s_branch .Lk1_k_50
.Lk1_o_40:
  s_cmp_eq_u32 s27, 4
  s_cbranch_scc0 .Lk1_s_42
  v_pk_mul_f32 v[0:1], v[0:1], v[176:177] op_sel_hi:[1,0]
  v_pk_mul_f32 v[2:3], v[2:3], v[176:177] op_sel_hi:[1,0]
  v_pk_mul_f32 v[4:5], v[4:5], v[176:177] op_sel_hi:[1,0]
  v_pk_mul_f32 v[6:7], v[6:7], v[176:177] op_sel_hi:[1,0]
  v_cvt_pk_bf16_f32 v192, v0, v1
  v_cvt_pk_bf16_f32 v193, v2, v3
  v_cvt_pk_bf16_f32 v194, v4, v5
  v_cvt_pk_bf16_f32 v195, v6, v7
  v_pk_mul_f32 v[32:33], v[32:33], v[176:177] op_sel:[0,1]
  v_pk_mul_f32 v[34:35], v[34:35], v[176:177] op_sel:[0,1]
  v_pk_mul_f32 v[36:37], v[36:37], v[176:177] op_sel:[0,1]
  v_pk_mul_f32 v[38:39], v[38:39], v[176:177] op_sel:[0,1]
  v_cvt_pk_bf16_f32 v208, v32, v33
  v_cvt_pk_bf16_f32 v209, v34, v35
  v_cvt_pk_bf16_f32 v210, v36, v37
  v_cvt_pk_bf16_f32 v211, v38, v39
  v_pk_mul_f32 v[8:9], v[8:9], v[176:177] op_sel_hi:[1,0]
  v_pk_mul_f32 v[10:11], v[10:11], v[176:177] op_sel_hi:[1,0]
  v_pk_mul_f32 v[12:13], v[12:13], v[176:177] op_sel_hi:[1,0]
  v_pk_mul_f32 v[14:15], v[14:15], v[176:177] op_sel_hi:[1,0]
  v_cvt_pk_bf16_f32 v196, v8, v9
  v_cvt_pk_bf16_f32 v197, v10, v11
  v_cvt_pk_bf16_f32 v198, v12, v13
  v_cvt_pk_bf16_f32 v199, v14, v15
  v_pk_mul_f32 v[40:41], v[40:41], v[176:177] op_sel:[0,1]
  v_pk_mul_f32 v[42:43], v[42:43], v[176:177] op_sel:[0,1]
  v_pk_mul_f32 v[44:45], v[44:45], v[176:177] op_sel:[0,1]
  v_pk_mul_f32 v[46:47], v[46:47], v[176:177] op_sel:[0,1]
  v_cvt_pk_bf16_f32 v212, v40, v41
  v_cvt_pk_bf16_f32 v213, v42, v43
  v_cvt_pk_bf16_f32 v214, v44, v45
  v_cvt_pk_bf16_f32 v215, v46, v47
  v_pk_mul_f32 v[16:17], v[16:17], v[176:177] op_sel_hi:[1,0]
  v_pk_mul_f32 v[18:19], v[18:19], v[176:177] op_sel_hi:[1,0]
  v_pk_mul_f32 v[20:21], v[20:21], v[176:177] op_sel_hi:[1,0]
  v_pk_mul_f32 v[22:23], v[22:23], v[176:177] op_sel_hi:[1,0]
  v_cvt_pk_bf16_f32 v200, v16, v17
  v_cvt_pk_bf16_f32 v201, v18, v19
  v_cvt_pk_bf16_f32 v202, v20, v21
  v_cvt_pk_bf16_f32 v203, v22, v23
  v_pk_mul_f32 v[48:49], v[48:49], v[176:177] op_sel:[0,1]
  v_pk_mul_f32 v[50:51], v[50:51], v[176:177] op_sel:[0,1]
  v_pk_mul_f32 v[52:53], v[52:53], v[176:177] op_sel:[0,1]
  v_pk_mul_f32 v[54:55], v[54:55], v[176:177] op_sel:[0,1]
  v_cvt_pk_bf16_f32 v216, v48, v49
  v_cvt_pk_bf16_f32 v217, v50, v51
  v_cvt_pk_bf16_f32 v218, v52, v53
  v_cvt_pk_bf16_f32 v219, v54, v55
  v_pk_mul_f32 v[24:25], v[24:25], v[176:177] op_sel_hi:[1,0]
  v_pk_mul_f32 v[26:27], v[26:27], v[176:177] op_sel_hi:[1,0]
  v_pk_mul_f32 v[28:29], v[28:29], v[176:177] op_sel_hi:[1,0]
  v_pk_mul_f32 v[30:31], v[30:31], v[176:177] op_sel_hi:[1,0]
  v_cvt_pk_bf16_f32 v204, v24, v25
  v_cvt_pk_bf16_f32 v205, v26, v27
  v_cvt_pk_bf16_f32 v206, v28, v29
  v_cvt_pk_bf16_f32 v207, v30, v31
  v_pk_mul_f32 v[56:57], v[56:57], v[176:177] op_sel:[0,1]
  v_pk_mul_f32 v[58:59], v[58:59], v[176:177] op_sel:[0,1]
  v_pk_mul_f32 v[60:61], v[60:61], v[176:177] op_sel:[0,1]
  v_pk_mul_f32 v[62:63], v[62:63], v[176:177] op_sel:[0,1]
  v_cvt_pk_bf16_f32 v220, v56, v57
  v_cvt_pk_bf16_f32 v221, v58, v59
  v_cvt_pk_bf16_f32 v222, v60, v61
  v_cvt_pk_bf16_f32 v223, v62, v63
.Lk1_s_42:
  s_waitcnt lgkmcnt(0)
  ds_read_b128 v[128:131], v160 offset:0
  ds_read_b128 v[132:135], v161 offset:0
  s_waitcnt lgkmcnt(1)
  v_mfma_f32_16x16x32_bf16 v[64:67], v[128:131], v[224:227], 0
  v_mfma_f32_16x16x32_bf16 v[72:75], v[128:131], v[228:231], 0
  ds_read_b128 v[136:139], v162 offset:0
  s_waitcnt lgkmcnt(1)
  v_mfma_f32_16x16x32_bf16 v[64:67], v[132:135], v[232:235], v[64:67]
  v_mfma_f32_16x16x32_bf16 v[72:75], v[132:135], v[236:239], v[72:75]
  ds_read_b128 v[140:143], v163 offset:0
  s_waitcnt lgkmcnt(1)
  v_mfma_f32_16x16x32_bf16 v[64:67], v[136:139], v[240:243], v[64:67]
  v_mfma_f32_16x16x32_bf16 v[72:75], v[136:139], v[244:247], v[72:75]
  ds_read_b128 v[144:147], v160 offset:4096
  s_waitcnt lgkmcnt(1)
  v_mfma_f32_16x16x32_bf16 v[64:67], v[140:143], v[248:251], v[64:67]
  v_mfma_f32_16x16x32_bf16 v[72:75], v[140:143], v[252:255], v[72:75]
  ds_read_b128 v[148:151], v161 offset:4096
  s_waitcnt lgkmcnt(1)
  v_mfma_f32_16x16x32_bf16 v[68:71], v[144:147], v[224:227], 0
  v_mfma_f32_16x16x32_bf16 v[76:79], v[144:147], v[228:231], 0
  ds_read_b128 v[128:131], v162 offset:4096
  s_waitcnt lgkmcnt(1)
  v_mfma_f32_16x16x32_bf16 v[68:71], v[148:151], v[232:235], v[68:71]
  v_mfma_f32_16x16x32_bf16 v[76:79], v[148:151], v[236:239], v[76:79]
  ds_read_b128 v[132:135], v163 offset:4096
  s_waitcnt lgkmcnt(1)
  v_mfma_f32_16x16x32_bf16 v[68:71], v[128:131], v[240:243], v[68:71]
  v_mfma_f32_16x16x32_bf16 v[76:79], v[128:131], v[244:247], v[76:79]
  ds_read_b128 v[136:139], v160 offset:8192
  s_waitcnt lgkmcnt(1)
  v_mfma_f32_16x16x32_bf16 v[68:71], v[132:135], v[248:251], v[68:71]
  v_mfma_f32_16x16x32_bf16 v[76:79], v[132:135], v[252:255], v[76:79]
  ds_read_b128 v[140:143], v161 offset:8192
  s_waitcnt lgkmcnt(1)
  v_mfma_f32_16x16x32_bf16 v[80:83], v[136:139], v[224:227], 0
  v_mfma_f32_16x16x32_bf16 v[88:91], v[136:139], v[228:231], 0
  ds_read_b128 v[144:147], v162 offset:8192
  s_waitcnt lgkmcnt(1)
  v_mfma_f32_16x16x32_bf16 v[80:83], v[140:143], v[232:235], v[80:83]
  v_mfma_f32_16x16x32_bf16 v[88:91], v[140:143], v[236:239], v[88:91]
  ds_read_b128 v[148:151], v163 offset:8192
  s_waitcnt lgkmcnt(1)
  v_mfma_f32_16x16x32_bf16 v[80:83], v[144:147], v[240:243], v[80:83]
  v_mfma_f32_16x16x32_bf16 v[88:91], v[144:147], v[244:247], v[88:91]
  ds_read_b128 v[128:131], v160 offset:12288
  s_waitcnt lgkmcnt(1)
  v_mfma_f32_16x16x32_bf16 v[80:83], v[148:151], v[248:251], v[80:83]
  v_mfma_f32_16x16x32_bf16 v[88:91], v[148:151], v[252:255], v[88:91]
  ds_read_b128 v[132:135], v161 offset:12288
  s_waitcnt lgkmcnt(1)
  v_mfma_f32_16x16x32_bf16 v[84:87], v[128:131], v[224:227], 0
  v_mfma_f32_16x16x32_bf16 v[92:95], v[128:131], v[228:231], 0
  ds_read_b128 v[136:139], v162 offset:12288
  s_waitcnt lgkmcnt(1)
  v_mfma_f32_16x16x32_bf16 v[84:87], v[132:135], v[232:235], v[84:87]
  v_mfma_f32_16x16x32_bf16 v[92:95], v[132:135], v[236:239], v[92:95]
  ds_read_b128 v[140:143], v163 offset:12288
  s_waitcnt lgkmcnt(1)
  v_mfma_f32_16x16x32_bf16 v[84:87], v[136:139], v[240:243], v[84:87]
  v_mfma_f32_16x16x32_bf16 v[92:95], v[136:139], v[244:247], v[92:95]
  s_waitcnt lgkmcnt(0)
  v_mfma_f32_16x16x32_bf16 v[84:87], v[140:143], v[248:251], v[84:87]
  v_mfma_f32_16x16x32_bf16 v[92:95], v[140:143], v[252:255], v[92:95]
  ds_read_b128 v[128:131], v160 offset:16384
  ds_read_b128 v[132:135], v161 offset:16384
  s_waitcnt lgkmcnt(1)
  v_mfma_f32_16x16x32_bf16 v[96:99], v[128:131], v[224:227], 0
  v_mfma_f32_16x16x32_bf16 v[104:107], v[128:131], v[228:231], 0
  ds_read_b128 v[136:139], v162 offset:16384
  s_waitcnt lgkmcnt(1)
  v_mfma_f32_16x16x32_bf16 v[96:99], v[132:135], v[232:235], v[96:99]
  v_mfma_f32_16x16x32_bf16 v[104:107], v[132:135], v[236:239], v[104:107]
  ds_read_b128 v[140:143], v163 offset:16384
  s_waitcnt lgkmcnt(1)
  v_mfma_f32_16x16x32_bf16 v[96:99], v[136:139], v[240:243], v[96:99]
  v_mfma_f32_16x16x32_bf16 v[104:107], v[136:139], v[244:247], v[104:107]
  ds_read_b128 v[144:147], v160 offset:20480
  s_waitcnt lgkmcnt(1)
  v_mfma_f32_16x16x32_bf16 v[96:99], v[140:143], v[248:251], v[96:99]
  v_mfma_f32_16x16x32_bf16 v[104:107], v[140:143], v[252:255], v[104:107]
  ds_read_b128 v[148:151], v161 offset:20480
  s_waitcnt lgkmcnt(1)
  v_mfma_f32_16x16x32_bf16 v[100:103], v[144:147], v[224:227], 0
  v_mfma_f32_16x16x32_bf16 v[108:111], v[144:147], v[228:231], 0
  ds_read_b128 v[128:131], v162 offset:20480
  s_waitcnt lgkmcnt(1)
  v_mfma_f32_16x16x32_bf16 v[100:103], v[148:151], v[232:235], v[100:103]
  v_mfma_f32_16x16x32_bf16 v[108:111], v[148:151], v[236:239], v[108:111]
  ds_read_b128 v[132:135], v163 offset:20480
  s_waitcnt lgkmcnt(1)
  v_mfma_f32_16x16x32_bf16 v[100:103], v[128:131], v[240:243], v[100:103]
  v_mfma_f32_16x16x32_bf16 v[108:111], v[128:131], v[244:247], v[108:111]
  ds_read_b128 v[136:139], v160 offset:24576
  s_waitcnt lgkmcnt(1)
  v_mfma_f32_16x16x32_bf16 v[100:103], v[132:135], v[248:251], v[100:103]
  v_mfma_f32_16x16x32_bf16 v[108:111], v[132:135], v[252:255], v[108:111]
  ds_read_b128 v[140:143], v161 offset:24576
  s_waitcnt lgkmcnt(1)
  v_mfma_f32_16x16x32_bf16 v[112:115], v[136:139], v[224:227], 0
  v_mfma_f32_16x16x32_bf16 v[120:123], v[136:139], v[228:231], 0
  ds_read_b128 v[144:147], v162 offset:24576
  s_waitcnt lgkmcnt(1)
  v_mfma_f32_16x16x32_bf16 v[112:115], v[140:143], v[232:235], v[112:115]
  v_mfma_f32_16x16x32_bf16 v[120:123], v[140:143], v[236:239], v[120:123]
  ds_read_b128 v[148:151], v163 offset:24576
  s_waitcnt lgkmcnt(1)
  v_mfma_f32_16x16x32_bf16 v[112:115], v[144:147], v[240:243], v[112:115]
  v_mfma_f32_16x16x32_bf16 v[120:123], v[144:147], v[244:247], v[120:123]
  ds_read_b128 v[128:131], v160 offset:28672
  s_waitcnt lgkmcnt(1)
  v_mfma_f32_16x16x32_bf16 v[112:115], v[148:151], v[248:251], v[112:115]
  v_mfma_f32_16x16x32_bf16 v[120:123], v[148:151], v[252:255], v[120:123]
  ds_read_b128 v[132:135], v161 offset:28672
  s_waitcnt lgkmcnt(1)
  v_mfma_f32_16x16x32_bf16 v[116:119], v[128:131], v[224:227], 0
  v_mfma_f32_16x16x32_bf16 v[124:127], v[128:131], v[228:231], 0
  ds_read_b128 v[136:139], v162 offset:28672
  s_waitcnt lgkmcnt(1)
  v_mfma_f32_16x16x32_bf16 v[116:119], v[132:135], v[232:235], v[116:119]
  v_mfma_f32_16x16x32_bf16 v[124:127], v[132:135], v[236:239], v[124:127]
  ds_read_b128 v[140:143], v163 offset:28672
  s_waitcnt lgkmcnt(1)
  v_mfma_f32_16x16x32_bf16 v[116:119], v[136:139], v[240:243], v[116:119]
  v_mfma_f32_16x16x32_bf16 v[124:127], v[136:139], v[244:247], v[124:127]
  s_waitcnt lgkmcnt(0)
  v_mfma_f32_16x16x32_bf16 v[116:119], v[140:143], v[248:251], v[116:119]
  v_mfma_f32_16x16x32_bf16 v[124:127], v[140:143], v[252:255], v[124:127]
  v_mov_b32 v189, v184
  v_mov_b32 v190, v185
  s_nop 0
  v_permlane32_swap_b32 v184, v189
  v_permlane32_swap_b32 v185, v190
  v_max_f32 v184, v184, v189
  v_max_f32 v185, v185, v190
  v_mov_b32 v189, v184
  v_mov_b32 v190, v185
  s_nop 0
  v_permlane16_swap_b32 v184, v189
  v_permlane16_swap_b32 v185, v190
  v_max_f32 v184, v184, v189
  v_max_f32 v185, v185, v190
  v_sub_f32 v189, v188, v184
  v_min_f32 v189, s89, v189
  v_exp_f32 v189, v189
  v_mov_b32 v188, v184
  v_sub_f32 v190, v191, v185
  v_min_f32 v190, s89, v190
  v_exp_f32 v190, v190
  v_mov_b32 v191, v185
  s_mov_b32 s7, -1.0
  v_mul_f32 v152, v152, v189
  v_mul_f32 v156, v156, v190
  v_sub_f32 v64, v64, v184
  v_sub_f32 v65, v65, v184
  v_sub_f32 v66, v66, v184
  v_sub_f32 v67, v67, v184
  v_sub_f32 v68, v68, v184
  v_sub_f32 v69, v69, v184
  v_sub_f32 v70, v70, v184
  v_sub_f32 v71, v71, v184
  v_sub_f32 v72, v72, v185
  v_sub_f32 v73, v73, v185
  v_sub_f32 v74, v74, v185
  v_sub_f32 v75, v75, v185
  v_sub_f32 v76, v76, v185
  v_sub_f32 v77, v77, v185
  v_sub_f32 v78, v78, v185
  v_sub_f32 v79, v79, v185
  v_sub_f32 v80, v80, v184
  v_sub_f32 v81, v81, v184
  v_sub_f32 v82, v82, v184
  v_sub_f32 v83, v83, v184
  v_sub_f32 v84, v84, v184
  v_sub_f32 v85, v85, v184
  v_sub_f32 v86, v86, v184
  v_sub_f32 v87, v87, v184
  v_sub_f32 v88, v88, v185
  v_sub_f32 v89, v89, v185
  v_sub_f32 v90, v90, v185
  v_sub_f32 v91, v91, v185
  v_sub_f32 v92, v92, v185
  v_sub_f32 v93, v93, v185
  v_sub_f32 v94, v94, v185
  v_sub_f32 v95, v95, v185
  v_sub_f32 v96, v96, v184
  v_sub_f32 v97, v97, v184
  v_sub_f32 v98, v98, v184
  v_sub_f32 v99, v99, v184
  v_sub_f32 v100, v100, v184
  v_sub_f32 v101, v101, v184
  v_sub_f32 v102, v102, v184
  v_sub_f32 v103, v103, v184
  v_sub_f32 v104, v104, v185
  v_sub_f32 v105, v105, v185
  v_sub_f32 v106, v106, v185
  v_sub_f32 v107, v107, v185
  v_sub_f32 v108, v108, v185
  v_sub_f32 v109, v109, v185
  v_sub_f32 v110, v110, v185
  v_sub_f32 v111, v111, v185
  v_sub_f32 v112, v112, v184
  v_sub_f32 v113, v113, v184
  v_sub_f32 v114, v114, v184
  v_sub_f32 v115, v115, v184
  v_sub_f32 v116, v116, v184
  v_sub_f32 v117, v117, v184
  v_sub_f32 v118, v118, v184
  v_sub_f32 v119, v119, v184
  v_sub_f32 v120, v120, v185
  v_sub_f32 v121, v121, v185
  v_sub_f32 v122, v122, v185
  v_sub_f32 v123, v123, v185
  v_sub_f32 v124, v124, v185
  v_sub_f32 v125, v125, v185
  v_sub_f32 v126, v126, v185
  v_sub_f32 v127, v127, v185
  v_mul_f32 v0, v0, v189
  v_mul_f32 v1, v1, v189
  v_mul_f32 v2, v2, v189
  v_mul_f32 v3, v3, v189
  v_mul_f32 v4, v4, v189
  v_mul_f32 v5, v5, v189
  v_mul_f32 v6, v6, v189
  v_mul_f32 v7, v7, v189
  v_mul_f32 v8, v8, v189
  v_mul_f32 v9, v9, v189
  v_mul_f32 v10, v10, v189
  v_mul_f32 v11, v11, v189
  v_mul_f32 v12, v12, v189
  v_mul_f32 v13, v13, v189
  v_mul_f32 v14, v14, v189
  v_mul_f32 v15, v15, v189
  v_mul_f32 v16, v16, v189
  v_mul_f32 v17, v17, v189
  v_mul_f32 v18, v18, v189
  v_mul_f32 v19, v19, v189
  v_mul_f32 v20, v20, v189
  v_mul_f32 v21, v21, v189
  v_mul_f32 v22, v22, v189
  v_mul_f32 v23, v23, v189
  v_mul_f32 v24, v24, v189
  v_mul_f32 v25, v25, v189
  v_mul_f32 v26, v26, v189
  v_mul_f32 v27, v27, v189
  v_mul_f32 v28, v28, v189
  v_mul_f32 v29, v29, v189
  v_mul_f32 v30, v30, v189
  v_mul_f32 v31, v31, v189
  v_mul_f32 v32, v32, v190
  v_mul_f32 v33, v33, v190
  v_mul_f32 v34, v34, v190
  v_mul_f32 v35, v35, v190
  v_mul_f32 v36, v36, v190
  v_mul_f32 v37, v37, v190
  v_mul_f32 v38, v38, v190
  v_mul_f32 v39, v39, v190
  v_mul_f32 v40, v40, v190
  v_mul_f32 v41, v41, v190
  v_mul_f32 v42, v42, v190
  v_mul_f32 v43, v43, v190
  v_mul_f32 v44, v44, v190
  v_mul_f32 v45, v45, v190
  v_mul_f32 v46, v46, v190
  v_mul_f32 v47, v47, v190
  v_mul_f32 v48, v48, v190
  v_mul_f32 v49, v49, v190
  v_mul_f32 v50, v50, v190
  v_mul_f32 v51, v51, v190
  v_mul_f32 v52, v52, v190
  v_mul_f32 v53, v53, v190
  v_mul_f32 v54, v54, v190
  v_mul_f32 v55, v55, v190
  v_mul_f32 v56, v56, v190
  v_mul_f32 v57, v57, v190
  v_mul_f32 v58, v58, v190
  v_mul_f32 v59, v59, v190
  v_mul_f32 v60, v60, v190
  v_mul_f32 v61, v61, v190
  v_mul_f32 v62, v62, v190
  v_mul_f32 v63, v63, v190
  v_exp_f32 v64, v64
  v_exp_f32 v65, v65
  v_exp_f32 v66, v66
  v_cvt_pk_bf16_f32 v64, v64, v65
  v_exp_f32 v67, v67
  v_exp_f32 v68, v68
  v_cvt_pk_bf16_f32 v65, v66, v67
  v_exp_f32 v69, v69
  v_exp_f32 v70, v70
  v_cvt_pk_bf16_f32 v66, v68, v69
  v_exp_f32 v71, v71
  v_exp_f32 v72, v72
  v_cvt_pk_bf16_f32 v67, v70, v71
  v_exp_f32 v73, v73
  v_exp_f32 v74, v74
  v_cvt_pk_bf16_f32 v72, v72, v73
  v_exp_f32 v75, v75
  v_exp_f32 v76, v76
  v_cvt_pk_bf16_f32 v73, v74, v75
  v_exp_f32 v77, v77
  v_exp_f32 v78, v78
  v_cvt_pk_bf16_f32 v74, v76, v77
  v_exp_f32 v79, v79
  v_exp_f32 v80, v80
  v_cvt_pk_bf16_f32 v75, v78, v79
  v_exp_f32 v81, v81
  v_exp_f32 v82, v82
  v_cvt_pk_bf16_f32 v80, v80, v81
  v_exp_f32 v83, v83
  v_exp_f32 v84, v84
  v_cvt_pk_bf16_f32 v81, v82, v83
  v_exp_f32 v85, v85
  v_exp_f32 v86, v86
  v_cvt_pk_bf16_f32 v82, v84, v85
  v_exp_f32 v87, v87
  v_exp_f32 v88, v88
  v_cvt_pk_bf16_f32 v83, v86, v87
  v_exp_f32 v89, v89
  v_exp_f32 v90, v90
  v_cvt_pk_bf16_f32 v88, v88, v89
  v_exp_f32 v91, v91
  v_exp_f32 v92, v92
  v_cvt_pk_bf16_f32 v89, v90, v91
  v_exp_f32 v93, v93
  v_exp_f32 v94, v94
  v_cvt_pk_bf16_f32 v90, v92, v93
  v_exp_f32 v95, v95
  v_exp_f32 v96, v96
  v_cvt_pk_bf16_f32 v91, v94, v95
  v_exp_f32 v97, v97
  v_exp_f32 v98, v98
  v_cvt_pk_bf16_f32 v96, v96, v97
  v_exp_f32 v99, v99
  v_exp_f32 v100, v100
  v_cvt_pk_bf16_f32 v97, v98, v99
  v_exp_f32 v101, v101
  v_exp_f32 v102, v102
  v_cvt_pk_bf16_f32 v98, v100, v101
  v_exp_f32 v103, v103
  v_exp_f32 v104, v104
  v_cvt_pk_bf16_f32 v99, v102, v103
  v_exp_f32 v105, v105
  ds_read_b64_tr_b16 v[128:129], v168 offset:0
  ds_read_b64_tr_b16 v[130:131], v168 offset:4096
  ds_read_b64_tr_b16 v[132:133], v169 offset:0
  ds_read_b64_tr_b16 v[134:135], v169 offset:4096
  s_bitcmp0_b32 s97, s27
  s_cbranch_scc1 .Lk1_o_43
  s_waitcnt lgkmcnt(2)
  v_mfma_f32_16x16x32_bf16 v[0:3], v[128:131], v[64:67], v[0:3]
  v_mfma_f32_16x16x32_bf16 v[32:35], v[128:131], v[72:75], v[32:35]
  ds_read_b64_tr_b16 v[136:137], v170 offset:0
  ds_read_b64_tr_b16 v[138:139], v170 offset:4096
  s_waitcnt lgkmcnt(2)
  v_mfma_f32_16x16x32_bf16 v[4:7], v[132:135], v[64:67], v[4:7]
  v_mfma_f32_16x16x32_bf16 v[36:39], v[132:135], v[72:75], v[36:39]
  v_mov_b32 v190, s95
  ds_write_b32 v186, v190 offset:0
  ds_read_b64_tr_b16 v[140:141], v171 offset:0
  ds_read_b64_tr_b16 v[142:143], v171 offset:4096
  s_waitcnt lgkmcnt(3)
  v_mfma_f32_16x16x32_bf16 v[8:11], v[136:139], v[64:67], v[8:11]
  v_mfma_f32_16x16x32_bf16 v[40:43], v[136:139], v[72:75], v[40:43]
  v_mfma_f32_16x16x32_bf16 v[152:155], v[164:167], v[64:67], v[152:155]
  ds_read_b64_tr_b16 v[144:145], v172 offset:0
  ds_read_b64_tr_b16 v[146:147], v172 offset:4096
  v_xor_b32 v160, 0x10000, v160
  s_waitcnt lgkmcnt(2)
  v_mfma_f32_16x16x32_bf16 v[12:15], v[140:143], v[64:67], v[12:15]
  v_mfma_f32_16x16x32_bf16 v[44:47], v[140:143], v[72:75], v[44:47]
  ds_read_b64_tr_b16 v[148:149], v173 offset:0
  ds_read_b64_tr_b16 v[150:151], v173 offset:4096
  v_xor_b32 v161, 0x10000, v161
  s_waitcnt lgkmcnt(2)
  v_mfma_f32_16x16x32_bf16 v[16:19], v[144:147], v[64:67], v[16:19]
  v_mfma_f32_16x16x32_bf16 v[48:51], v[144:147], v[72:75], v[48:51]
  ds_read_b64_tr_b16 v[128:129], v174 offset:0
  ds_read_b64_tr_b16 v[130:131], v174 offset:4096
  v_xor_b32 v162, 0x10000, v162
  s_waitcnt lgkmcnt(2)
  v_mfma_f32_16x16x32_bf16 v[20:23], v[148:151], v[64:67], v[20:23]
  v_mfma_f32_16x16x32_bf16 v[52:55], v[148:151], v[72:75], v[52:55]
  v_mfma_f32_16x16x32_bf16 v[156:159], v[164:167], v[72:75], v[156:159]
  ds_read_b64_tr_b16 v[132:133], v175 offset:0
  ds_read_b64_tr_b16 v[134:135], v175 offset:4096
  v_xor_b32 v163, 0x10000, v163
  s_waitcnt lgkmcnt(2)
  v_mfma_f32_16x16x32_bf16 v[24:27], v[128:131], v[64:67], v[24:27]
  v_mfma_f32_16x16x32_bf16 v[56:59], v[128:131], v[72:75], v[56:59]
  ds_read_b64_tr_b16 v[136:137], v168 offset:8192
  ds_read_b64_tr_b16 v[138:139], v168 offset:12288
  s_cmp_eq_u32 s27, 5
  s_cbranch_scc1 .Lk1_o_47
.Lk1_k_48:
  s_waitcnt lgkmcnt(2)
  v_mfma_f32_16x16x32_bf16 v[28:31], v[132:135], v[64:67], v[28:31]
  v_mfma_f32_16x16x32_bf16 v[60:63], v[132:135], v[72:75], v[60:63]
  ds_read_b64_tr_b16 v[140:141], v169 offset:8192
  ds_read_b64_tr_b16 v[142:143], v169 offset:12288
.Lk1_k_44:
  s_waitcnt lgkmcnt(2)
  v_mfma_f32_16x16x32_bf16 v[0:3], v[136:139], v[80:83], v[0:3]
  v_mfma_f32_16x16x32_bf16 v[32:35], v[136:139], v[88:91], v[32:35]
  ds_read_b64_tr_b16 v[144:145], v170 offset:8192
  ds_read_b64_tr_b16 v[146:147], v170 offset:12288
  s_waitcnt lgkmcnt(2)
  v_mfma_f32_16x16x32_bf16 v[4:7], v[140:143], v[80:83], v[4:7]
  v_mfma_f32_16x16x32_bf16 v[36:39], v[140:143], v[88:91], v[36:39]
  ds_read_b64_tr_b16 v[148:149], v171 offset:8192
  ds_read_b64_tr_b16 v[150:151], v171 offset:12288
  s_waitcnt lgkmcnt(2)
  v_mfma_f32_16x16x32_bf16 v[8:11], v[144:147], v[80:83], v[8:11]
  v_mfma_f32_16x16x32_bf16 v[40:43], v[144:147], v[88:91], v[40:43]
  v_mfma_f32_16x16x32_bf16 v[152:155], v[164:167], v[80:83], v[152:155]
  ds_read_b64_tr_b16 v[128:129], v172 offset:8192
  ds_read_b64_tr_b16 v[130:131], v172 offset:12288
  s_waitcnt lgkmcnt(2)
  v_mfma_f32_16x16x32_bf16 v[12:15], v[148:151], v[80:83], v[12:15]
  v_mfma_f32_16x16x32_bf16 v[44:47], v[148:151], v[88:91], v[44:47]
  ds_read_b32 v189, v187
  ds_read_b64_tr_b16 v[132:133], v173 offset:8192
  ds_read_b64_tr_b16 v[134:135], v173 offset:12288
  s_waitcnt lgkmcnt(3)
  v_mfma_f32_16x16x32_bf16 v[16:19], v[128:131], v[80:83], v[16:19]
  v_mfma_f32_16x16x32_bf16 v[48:51], v[128:131], v[88:91], v[48:51]
  ds_read_b64_tr_b16 v[136:137], v174 offset:8192
  ds_read_b64_tr_b16 v[138:139], v174 offset:12288
  s_waitcnt lgkmcnt(2)
  v_mfma_f32_16x16x32_bf16 v[20:23], v[132:135], v[80:83], v[20:23]
  v_mfma_f32_16x16x32_bf16 v[52:55], v[132:135], v[88:91], v[52:55]
  v_mfma_f32_16x16x32_bf16 v[156:159], v[164:167], v[88:91], v[156:159]
  v_cmp_gt_u32 vcc, s93, v189
  s_cbranch_vccnz .Lk1_o_49
.Lk1_k_50:
  ds_read_b64_tr_b16 v[140:141], v175 offset:8192
  ds_read_b64_tr_b16 v[142:143], v175 offset:12288
  s_waitcnt lgkmcnt(2)
  v_mfma_f32_16x16x32_bf16 v[24:27], v[136:139], v[80:83], v[24:27]
  v_mfma_f32_16x16x32_bf16 v[56:59], v[136:139], v[88:91], v[56:59]
  ds_read_b128 v[128:131], v160 offset:0
  s_waitcnt lgkmcnt(1)
  v_mfma_f32_16x16x32_bf16 v[28:31], v[140:143], v[80:83], v[28:31]
  v_mfma_f32_16x16x32_bf16 v[60:63], v[140:143], v[88:91], v[60:63]
  v_mov_b32 v190, s96
  ds_write_b32 v186, v190 offset:0
  ds_read_b128 v[132:135], v161 offset:0
  s_branch .Lk1_k_41
.Lk1_o_65:
  s_waitcnt vmcnt(0)
  s_barrier
  s_branch .Lk1_fin
  s_branch .Lk1_k_66
.Lk1_o_68:
.Lk1_fl_70:
  s_sleep 1
  global_load_dword v186, v185, s[14:15] sc1
  s_waitcnt vmcnt(0)
  v_cmp_ne_u32 vcc, v235, v186
  s_cbranch_vccnz .Lk1_fl_70
  s_branch .Lk1_k_69
.Lk1_o_71:
  s_memrealtime s[84:85]
  s_waitcnt lgkmcnt(0)
  s_or_b32 s84, s84, 1
  v_mov_b32 v7, 0
  v_mov_b32 v8, s84
  s_mov_b64 exec, 1
  global_store_dword v7, v8, s[82:83] sc1
  s_mov_b64 exec, -1
  s_branch .Lk1_k_72
.Lk1_o_89:
.Lk1_sp_91:
  s_sleep 3
  ds_read_b32 v189, v177
  s_waitcnt lgkmcnt(0)
  v_cmp_gt_u32 vcc, 1001, v189
  s_nop 0
  s_cbranch_vccnz .Lk1_sp_91
  s_branch .Lk1_k_90
.Lk1_o_92:
  v_mov_b32 v180, v156
  s_nop 1
  v_permlane32_swap_b32 v156, v180
  v_max_f32 v156, v156, v180
  v_mov_b32 v180, v156
  s_nop 1
  v_permlane16_swap_b32 v156, v180
  v_max_f32 v156, v156, v180
  v_sub_f32 v180, v178, v156
  v_min_f32 v180, s89, v180
  v_exp_f32 v180, v180
  v_mov_b32 v178, v156
  s_mov_b32 s7, -1.0
  v_sub_f32 v64, v64, v156
  v_sub_f32 v65, v65, v156
  v_sub_f32 v66, v66, v156
  v_sub_f32 v67, v67, v156
  v_sub_f32 v68, v68, v156
  v_sub_f32 v69, v69, v156
  v_sub_f32 v70, v70, v156
  v_sub_f32 v71, v71, v156
  v_mul_f32 v179, v179, v180
  v_mul_f32 v0, v0, v180
  v_mul_f32 v1, v1, v180
  v_mul_f32 v2, v2, v180
  v_mul_f32 v3, v3, v180
  v_mul_f32 v4, v4, v180
  v_mul_f32 v5, v5, v180
  v_mul_f32 v6, v6, v180
  v_mul_f32 v7, v7, v180
  v_mul_f32 v8, v8, v180
  v_mul_f32 v9, v9, v180
  v_mul_f32 v10, v10, v180
  v_mul_f32 v11, v11, v180
  v_mul_f32 v12, v12, v180
  v_mul_f32 v13, v13, v180
  v_mul_f32 v14, v14, v180
  v_mul_f32 v15, v15, v180
  v_mul_f32 v16, v16, v180
  v_mul_f32 v17, v17, v180
  v_mul_f32 v18, v18, v180
  v_mul_f32 v19, v19, v180
  v_mul_f32 v20, v20, v180
  v_mul_f32 v21, v21, v180
  v_mul_f32 v22, v22, v180
  v_mul_f32 v23, v23, v180
  v_mul_f32 v24, v24, v180
  v_mul_f32 v25, v25, v180
  v_mul_f32 v26, v26, v180
  v_mul_f32 v27, v27, v180
  v_mul_f32 v28, v28, v180
  v_mul_f32 v29, v29, v180
  v_mul_f32 v30, v30, v180
  v_mul_f32 v31, v31, v180
  s_branch .Lk1_k_93
.Lk1_o_95:
  ds_read_b32 v189, v188
  s_waitcnt lgkmcnt(0)
  v_cmp_gt_u32 vcc, s25, v189
  s_cbranch_vccz .Lk1_nf_97
  s_waitcnt vmcnt(8)
  s_add_u32 s3, s24, 1
  s_max_u32 s98, s98, s3
  v_mov_b32 v190, s98
  ds_write_b32 v186, v190 offset:1024
  ds_read_b32 v189, v188
  s_waitcnt lgkmcnt(0)
  v_cmp_gt_u32 vcc, s25, v189
  s_cbranch_vccz .Lk1_nf_97
  s_waitcnt vmcnt(4)
  s_add_u32 s3, s24, 2
  s_max_u32 s98, s98, s3
  v_mov_b32 v190, s98
  ds_write_b32 v186, v190 offset:1024
  ds_read_b32 v189, v188
  s_waitcnt lgkmcnt(0)
  v_cmp_gt_u32 vcc, s25, v189
  s_cbranch_vccz .Lk1_nf_97
  s_waitcnt vmcnt(0)
  s_add_u32 s3, s24, 3
  s_max_u32 s98, s98, s3
  v_mov_b32 v190, s98
  ds_write_b32 v186, v190 offset:1024
  ds_read_b32 v189, v188
  s_waitcnt lgkmcnt(0)
  v_cmp_gt_u32 vcc, s25, v189
  s_cbranch_vccz .Lk1_nf_97
.Lk1_sp_98:
  s_sleep 3
  ds_read_b32 v189, v188
  s_waitcnt lgkmcnt(0)
  v_cmp_gt_u32 vcc, s25, v189
  s_cbranch_vccnz .Lk1_sp_98
.Lk1_nf_97:
  s_branch .Lk1_k_96
.Lk1_o_99:
  ds_read_b32 v189, v188
  s_waitcnt lgkmcnt(0)
  v_cmp_gt_u32 vcc, s25, v189
  s_cbranch_vccz .Lk1_nf_101
  s_waitcnt vmcnt(8)
  s_add_u32 s3, s24, 1
  s_max_u32 s98, s98, s3
  v_mov_b32 v190, s98
  ds_write_b32 v186, v190 offset:1024
  ds_read_b32 v189, v188
  s_waitcnt lgkmcnt(0)
  v_cmp_gt_u32 vcc, s25, v189
  s_cbranch_vccz .Lk1_nf_101
  s_waitcnt vmcnt(4)
  s_add_u32 s3, s24, 2
  s_max_u32 s98, s98, s3
  v_mov_b32 v190, s98
  ds_write_b32 v186, v190 offset:1024
  ds_read_b32 v189, v188
  s_waitcnt lgkmcnt(0)
  v_cmp_gt_u32 vcc, s25, v189
  s_cbranch_vccz .Lk1_nf_101
  s_waitcnt vmcnt(0)
  s_add_u32 s3, s24, 3
  s_max_u32 s98, s98, s3
  v_mov_b32 v190, s98
  ds_write_b32 v186, v190 offset:1024
  ds_read_b32 v189, v188
  s_waitcnt lgkmcnt(0)
  v_cmp_gt_u32 vcc, s25, v189
  s_cbranch_vccz .Lk1_nf_101
.Lk1_sp_102:
  s_sleep 3
  ds_read_b32 v189, v188
  s_waitcnt lgkmcnt(0)
  v_cmp_gt_u32 vcc, s25, v189
  s_cbranch_vccnz .Lk1_sp_102
.Lk1_nf_101:
  s_branch .Lk1_k_100
.Lk1_o_103:
  v_mov_b32 v180, v179
  s_nop 1
  v_permlane32_swap_b32 v179, v180
  v_add_f32 v179, v179, v180
  v_mov_b32 v180, v179
  s_nop 1
  v_permlane16_swap_b32 v179, v180
  v_add_f32 v179, v179, v180
  s_xor_b32 s3, s4, 1
  s_mul_i32 s3, s3, 6144
  s_add_u32 s3, s3, 131072
  v_add_u32 v180, s3, v176
  ds_write_b128 v180, v[8:11] offset:0
  ds_write_b128 v180, v[12:15] offset:1024
  s_xor_b32 s3, s4, 2
  s_mul_i32 s3, s3, 6144
  s_add_u32 s3, s3, 133120
  v_add_u32 v180, s3, v176
  ds_write_b128 v180, v[16:19] offset:0
  ds_write_b128 v180, v[20:23] offset:1024
  s_xor_b32 s3, s4, 3
  s_mul_i32 s3, s3, 6144
  s_add_u32 s3, s3, 135168
  v_add_u32 v180, s3, v176
  ds_write_b128 v180, v[24:27] offset:0
  ds_write_b128 v180, v[28:31] offset:1024
  v_lshrrev_b32 v122, 1, v176
  s_lshl_b32 s3, s4, 9
  s_add_u32 s3, s3, 155648
  v_add_u32 v122, s3, v122
  ds_write_b64 v122, v[178:179]
  v_mov_b32 v112, v0
  v_mov_b32 v113, v1
  v_mov_b32 v114, v2
  v_mov_b32 v115, v3
  v_mov_b32 v116, v4
  v_mov_b32 v117, v5
  v_mov_b32 v118, v6
  v_mov_b32 v119, v7
  v_mov_b32 v120, v178
  v_mov_b32 v121, v179
  s_waitcnt lgkmcnt(0)
  v_mov_b32 v190, 1002
  ds_write_b32 v186, v190 offset:0
  s_waitcnt lgkmcnt(0)
  v_mov_b32 v0, 0
  v_mov_b32 v1, 0
  v_mov_b32 v2, 0
  v_mov_b32 v3, 0
  v_mov_b32 v4, 0
  v_mov_b32 v5, 0
  v_mov_b32 v6, 0
  v_mov_b32 v7, 0
  v_mov_b32 v8, 0
  v_mov_b32 v9, 0
  v_mov_b32 v10, 0
  v_mov_b32 v11, 0
  v_mov_b32 v12, 0
  v_mov_b32 v13, 0
  v_mov_b32 v14, 0
  v_mov_b32 v15, 0
  v_mov_b32 v16, 0
  v_mov_b32 v17, 0
  v_mov_b32 v18, 0
  v_mov_b32 v19, 0
  v_mov_b32 v20, 0
  v_mov_b32 v21, 0
  v_mov_b32 v22, 0
  v_mov_b32 v23, 0
  v_mov_b32 v24, 0
  v_mov_b32 v25, 0
  v_mov_b32 v26, 0
  v_mov_b32 v27, 0
  v_mov_b32 v28, 0
  v_mov_b32 v29, 0
  v_mov_b32 v30, 0
  v_mov_b32 v31, 0
  v_mov_b32 v156, 0xf149f2ca
  v_mov_b32 v179, 0
  v_mov_b32 v178, 0
  s_mov_b32 s7, 0x42800000
  v_mov_b32 v32, v48
  v_mov_b32 v33, v49
  v_mov_b32 v34, v50
  v_mov_b32 v35, v51
  v_mov_b32 v36, v52
  v_mov_b32 v37, v53
  v_mov_b32 v38, v54
  v_mov_b32 v39, v55
  v_mov_b32 v40, v56
  v_mov_b32 v41, v57
  v_mov_b32 v42, v58
  v_mov_b32 v43, v59
  v_mov_b32 v44, v60
  v_mov_b32 v45, v61
  v_mov_b32 v46, v62
  v_mov_b32 v47, v63
  s_branch .Lk1_k_104
.Lk1_o_105:
  ds_read_b32 v189, v188
  s_waitcnt lgkmcnt(0)
  v_cmp_gt_u32 vcc, s25, v189
  s_cbranch_vccz .Lk1_nf_107
  s_waitcnt vmcnt(8)
  s_add_u32 s3, s24, 1
  s_max_u32 s98, s98, s3
  v_mov_b32 v190, s98
  ds_write_b32 v186, v190 offset:1024
  ds_read_b32 v189, v188
  s_waitcnt lgkmcnt(0)
  v_cmp_gt_u32 vcc, s25, v189
  s_cbranch_vccz .Lk1_nf_107
  s_waitcnt vmcnt(4)
  s_add_u32 s3, s24, 2
  s_max_u32 s98, s98, s3
  v_mov_b32 v190, s98
  ds_write_b32 v186, v190 offset:1024
  ds_read_b32 v189, v188
  s_waitcnt lgkmcnt(0)
  v_cmp_gt_u32 vcc, s25, v189
  s_cbranch_vccz .Lk1_nf_107
  s_waitcnt vmcnt(0)
  s_add_u32 s3, s24, 3
  s_max_u32 s98, s98, s3
  v_mov_b32 v190, s98
  ds_write_b32 v186, v190 offset:1024
  ds_read_b32 v189, v188
  s_waitcnt lgkmcnt(0)
  v_cmp_gt_u32 vcc, s25, v189
  s_cbranch_vccz .Lk1_nf_107
.Lk1_sp_108:
  s_sleep 3
  ds_read_b32 v189, v188
  s_waitcnt lgkmcnt(0)
  v_cmp_gt_u32 vcc, s25, v189
  s_cbranch_vccnz .Lk1_sp_108
.Lk1_nf_107:
  s_branch .Lk1_k_106
.Lk1_o_109:
  v_mov_b32 v180, v156
  s_nop 1
  v_permlane32_swap_b32 v156, v180
  v_max_f32 v156, v156, v180
  v_mov_b32 v180, v156
  s_nop 1
  v_permlane16_swap_b32 v156, v180
  v_max_f32 v156, v156, v180
  v_sub_f32 v180, v178, v156
  v_min_f32 v180, s89, v180
  v_exp_f32 v180, v180
  v_mov_b32 v178, v156
  s_mov_b32 s7, -1.0
  v_sub_f32 v64, v64, v156
  v_sub_f32 v65, v65, v156
  v_sub_f32 v66, v66, v156
  v_sub_f32 v67, v67, v156
  v_sub_f32 v68, v68, v156
  v_sub_f32 v69, v69, v156
  v_sub_f32 v70, v70, v156
  v_sub_f32 v71, v71, v156
  v_mul_f32 v179, v179, v180
  v_mul_f32 v0, v0, v180
  v_mul_f32 v1, v1, v180
  v_mul_f32 v2, v2, v180
  v_mul_f32 v3, v3, v180
  v_mul_f32 v4, v4, v180
  v_mul_f32 v5, v5, v180
  v_mul_f32 v6, v6, v180
  v_mul_f32 v7, v7, v180
  v_mul_f32 v8, v8, v180
  v_mul_f32 v9, v9, v180
  v_mul_f32 v10, v10, v180
  v_mul_f32 v11, v11, v180
  v_mul_f32 v12, v12, v180
  v_mul_f32 v13, v13, v180
  v_mul_f32 v14, v14, v180
  v_mul_f32 v15, v15, v180
  v_mul_f32 v16, v16, v180
  v_mul_f32 v17, v17, v180
  v_mul_f32 v18, v18, v180
  v_mul_f32 v19, v19, v180
  v_mul_f32 v20, v20, v180
  v_mul_f32 v21, v21, v180
  v_mul_f32 v22, v22, v180
  v_mul_f32 v23, v23, v180
  v_mul_f32 v24, v24, v180
  v_mul_f32 v25, v25, v180
  v_mul_f32 v26, v26, v180
  v_mul_f32 v27, v27, v180
  v_mul_f32 v28, v28, v180
  v_mul_f32 v29, v29, v180
  v_mul_f32 v30, v30, v180
  v_mul_f32 v31, v31, v180
  s_branch .Lk1_k_110
.Lk1_o_111:
  ds_read_b32 v189, v188
  s_waitcnt lgkmcnt(0)
  v_cmp_gt_u32 vcc, s25, v189
  s_cbranch_vccz .Lk1_nf_113
  s_waitcnt vmcnt(8)
  s_add_u32 s3, s24, 1
  s_max_u32 s98, s98, s3
  v_mov_b32 v190, s98
  ds_write_b32 v186, v190 offset:1024
  ds_read_b32 v189, v188
  s_waitcnt lgkmcnt(0)
  v_cmp_gt_u32 vcc, s25, v189
  s_cbranch_vccz .Lk1_nf_113
  s_waitcnt vmcnt(4)
  s_add_u32 s3, s24, 2
  s_max_u32 s98, s98, s3
  v_mov_b32 v190, s98
  ds_write_b32 v186, v190 offset:1024
  ds_read_b32 v189, v188
  s_waitcnt lgkmcnt(0)
  v_cmp_gt_u32 vcc, s25, v189
  s_cbranch_vccz .Lk1_nf_113
  s_waitcnt vmcnt(0)
  s_add_u32 s3, s24, 3
  s_max_u32 s98, s98, s3
  v_mov_b32 v190, s98
  ds_write_b32 v186, v190 offset:1024
  ds_read_b32 v189, v188
  s_waitcnt lgkmcnt(0)
  v_cmp_gt_u32 vcc, s25, v189
  s_cbranch_vccz .Lk1_nf_113
.Lk1_sp_114:
  s_sleep 3
  ds_read_b32 v189, v188
  s_waitcnt lgkmcnt(0)
  v_cmp_gt_u32 vcc, s25, v189
  s_cbranch_vccnz .Lk1_sp_114
.Lk1_nf_113:
  s_branch .Lk1_k_112
.Lk1_o_115:
  s_add_u32 s3, s23, 32768
  v_add_u32 v180, s3, v176
  s_cmp_eq_u32 s27, 0
  s_cbranch_scc0 .Lk1_s_117
  ds_write_b128 v180, v[192:195] offset:0
  ds_write_b128 v180, v[196:199] offset:1024
  ds_write_b128 v180, v[200:203] offset:2048
  ds_write_b128 v180, v[204:207] offset:3072
.Lk1_s_117:
  s_cmp_eq_u32 s27, 1
  s_cbranch_scc0 .Lk1_s_118
  ds_write_b128 v180, v[208:211] offset:0
  ds_write_b128 v180, v[212:215] offset:1024
  ds_write_b128 v180, v[216:219] offset:2048
  ds_write_b128 v180, v[220:223] offset:3072
.Lk1_s_118:
  s_cmp_eq_u32 s27, 4
  s_cbranch_scc0 .Lk1_s_119
  ds_write_b128 v180, v[224:227] offset:0
  ds_write_b128 v180, v[228:231] offset:1024
  ds_write_b128 v180, v[232:235] offset:2048
  ds_write_b128 v180, v[236:239] offset:3072
.Lk1_s_119:
  s_cmp_eq_u32 s27, 5
  s_cbranch_scc0 .Lk1_s_120
  ds_write_b128 v180, v[240:243] offset:0
  ds_write_b128 v180, v[244:247] offset:1024
  ds_write_b128 v180, v[248:251] offset:2048
  ds_write_b128 v180, v[252:255] offset:3072
.Lk1_s_120:
  buffer_load_dword v134, v135, s[40:43], 0 offen
  buffer_load_dword v134, v135, s[40:43], 0 offen
  buffer_load_dword v134, v135, s[40:43], 0 offen
  buffer_load_dword v134, v135, s[40:43], 0 offen
  s_waitcnt lgkmcnt(0)
  s_branch .Lk1_k_116
.Lk1_o_123:
.Lk1_sp_125:
  s_sleep 3
  ds_read_b32 v189, v177
  s_waitcnt lgkmcnt(0)
  v_cmp_gt_u32 vcc, 1002, v189
  s_nop 0
  s_cbranch_vccnz .Lk1_sp_125
  s_branch .Lk1_k_124
.Lk1_o_121:
  ds_read_b32 v189, v177
  s_waitcnt lgkmcnt(0)
  v_cmp_gt_u32 vcc, 1002, v189
  s_cbranch_vccnz .Lk1_o_123
.Lk1_k_124:
  s_mul_i32 s3, s4, 6144
  s_add_u32 s3, s3, 131072
  v_add_u32 v180, s3, v176
  v_xor_b32 v189, 512, v122
  ds_read_b64 v[74:75], v189
  v_xor_b32 v189, 1024, v122
  ds_read_b64 v[76:77], v189
  v_xor_b32 v189, 1536, v122
  ds_read_b64 v[78:79], v189
  ds_read_b128 v[88:91], v180 offset:0
  ds_read_b128 v[92:95], v180 offset:1024
  ds_read_b128 v[96:99], v180 offset:2048
  ds_read_b128 v[100:103], v180 offset:3072
  ds_read_b128 v[104:107], v180 offset:4096
  ds_read_b128 v[108:111], v180 offset:5120
  v_mov_b32 v72, v120
  v_mov_b32 v73, v121
  s_waitcnt lgkmcnt(6)
  v_max3_f32 v124, v72, v74, v76
  v_max_f32 v124, v124, v78
  v_sub_f32 v128, v72, v124
  v_sub_f32 v129, v74, v124
  v_sub_f32 v130, v76, v124
  v_sub_f32 v131, v78, v124
  v_exp_f32 v128, v128
  v_exp_f32 v129, v129
  v_exp_f32 v130, v130
  v_exp_f32 v131, v131
  v_mul_f32 v125, v128, v73
  v_fma_f32 v125, v129, v75, v125
  v_fma_f32 v125, v130, v77, v125
  v_fma_f32 v125, v131, v79, v125
  v_rcp_f32 v125, v125
  s_nop 0
  v_mul_f32 v128, v128, v125
  v_mul_f32 v129, v129, v125
  v_mul_f32 v130, v130, v125
  v_mul_f32 v131, v131, v125
  v_mul_f32 v112, v112, v128
  v_mul_f32 v113, v113, v128
  v_mul_f32 v114, v114, v128
  v_mul_f32 v115, v115, v128
  v_mul_f32 v116, v116, v128
  v_mul_f32 v117, v117, v128
  v_mul_f32 v118, v118, v128
  v_mul_f32 v119, v119, v128
  s_waitcnt lgkmcnt(4)
  v_fma_f32 v112, v88, v129, v112
  v_fma_f32 v113, v89, v129, v113
  v_fma_f32 v114, v90, v129, v114
  v_fma_f32 v115, v91, v129, v115
  v_fma_f32 v116, v92, v129, v116
  v_fma_f32 v117, v93, v129, v117
  v_fma_f32 v118, v94, v129, v118
  v_fma_f32 v119, v95, v129, v119
  s_waitcnt lgkmcnt(2)
  v_fma_f32 v112, v96, v130, v112
  v_fma_f32 v113, v97, v130, v113
  v_fma_f32 v114, v98, v130, v114
  v_fma_f32 v115, v99, v130, v115
  v_fma_f32 v116, v100, v130, v116
  v_fma_f32 v117, v101, v130, v117
  v_fma_f32 v118, v102, v130, v118
  v_fma_f32 v119, v103, v130, v119
  s_waitcnt lgkmcnt(0)
  v_fma_f32 v112, v104, v131, v112
  v_fma_f32 v113, v105, v131, v113
  v_fma_f32 v114, v106, v131, v114
  v_fma_f32 v115, v107, v131, v115
  v_fma_f32 v116, v108, v131, v116
  v_fma_f32 v117, v109, v131, v117
  v_fma_f32 v118, v110, v131, v118
  v_fma_f32 v119, v111, v131, v119
  v_cvt_pk_bf16_f32 v124, v112, v113
  v_cvt_pk_bf16_f32 v125, v114, v115
  v_cvt_pk_bf16_f32 v126, v116, v117
  v_cvt_pk_bf16_f32 v127, v118, v119
  s_add_u32 s26, s5, 1048576
  buffer_store_dwordx4 v[124:127], v176, s[44:47], s26 offen sc1
  s_branch .Lk1_k_122
.Lk1_o_126:
.Lk1_tg_128:
  s_sleep 8
  global_load_dword v159, v158, s[82:83] sc1
  s_waitcnt vmcnt(0)
  v_cmp_eq_u32 vcc, 0, v159
  s_cbranch_vccnz .Lk1_tg_128
  s_branch .Lk1_k_127
.Lk1_o_130:
  ds_read_b32 v189, v188
  s_waitcnt lgkmcnt(0)
  v_cmp_gt_u32 vcc, s25, v189
  s_cbranch_vccz .Lk1_nf_132
  s_waitcnt vmcnt(4)
  s_add_u32 s3, s24, 1
  s_max_u32 s98, s98, s3
  v_mov_b32 v190, s98
  ds_write_b32 v186, v190 offset:1024
  ds_read_b32 v189, v188
  s_waitcnt lgkmcnt(0)
  v_cmp_gt_u32 vcc, s25, v189
  s_cbranch_vccz .Lk1_nf_132
  s_waitcnt vmcnt(0)
  s_add_u32 s3, s24, 2
  s_max_u32 s98, s98, s3
  v_mov_b32 v190, s98
  ds_write_b32 v186, v190 offset:1024
  ds_read_b32 v189, v188
  s_waitcnt lgkmcnt(0)
  v_cmp_gt_u32 vcc, s25, v189
  s_cbranch_vccz .Lk1_nf_132
.Lk1_sp_133:
  s_sleep 3
  ds_read_b32 v189, v188
  s_waitcnt lgkmcnt(0)
  v_cmp_gt_u32 vcc, s25, v189
  s_cbranch_vccnz .Lk1_sp_133
.Lk1_nf_132:
  s_branch .Lk1_k_131
.Lk1_o_134:
.Lk1_sp_136:
  s_sleep 3
  ds_read_b32 v189, v177
  s_waitcnt lgkmcnt(0)
  v_cmp_gt_u32 vcc, 1003, v189
  s_nop 0
  s_cbranch_vccnz .Lk1_sp_136
  s_branch .Lk1_k_135
.Lk1_o_139:
  v_mov_b32 v180, v156
  s_nop 1
  v_permlane32_swap_b32 v156, v180
  v_max_f32 v156, v156, v180
  v_mov_b32 v180, v156
  s_nop 1
  v_permlane16_swap_b32 v156, v180
  v_max_f32 v156, v156, v180
  v_sub_f32 v180, v178, v156
  v_min_f32 v180, s89, v180
  v_exp_f32 v180, v180
  v_mov_b32 v178, v156
  s_mov_b32 s7, -1.0
  v_sub_f32 v64, v64, v156
  v_sub_f32 v65, v65, v156
  v_sub_f32 v66, v66, v156
  v_sub_f32 v67, v67, v156
  v_sub_f32 v68, v68, v156
  v_sub_f32 v69, v69, v156
  v_sub_f32 v70, v70, v156
  v_sub_f32 v71, v71, v156
  v_mul_f32 v179, v179, v180
  v_mul_f32 v0, v0, v180
  v_mul_f32 v1, v1, v180
  v_mul_f32 v2, v2, v180
  v_mul_f32 v3, v3, v180
  v_mul_f32 v4, v4, v180
  v_mul_f32 v5, v5, v180
  v_mul_f32 v6, v6, v180
  v_mul_f32 v7, v7, v180
  v_mul_f32 v8, v8, v180
  v_mul_f32 v9, v9, v180
  v_mul_f32 v10, v10, v180
  v_mul_f32 v11, v11, v180
  v_mul_f32 v12, v12, v180
  v_mul_f32 v13, v13, v180
  v_mul_f32 v14, v14, v180
  v_mul_f32 v15, v15, v180
  v_mul_f32 v16, v16, v180
  v_mul_f32 v17, v17, v180
  v_mul_f32 v18, v18, v180
  v_mul_f32 v19, v19, v180
  v_mul_f32 v20, v20, v180
  v_mul_f32 v21, v21, v180
  v_mul_f32 v22, v22, v180
  v_mul_f32 v23, v23, v180
  v_mul_f32 v24, v24, v180
  v_mul_f32 v25, v25, v180
  v_mul_f32 v26, v26, v180
  v_mul_f32 v27, v27, v180
  v_mul_f32 v28, v28, v180
  v_mul_f32 v29, v29, v180
  v_mul_f32 v30, v30, v180
  v_mul_f32 v31, v31, v180
  s_branch .Lk1_k_140
.Lk1_o_141:
.Lk1_sp_143:
  s_sleep 3
  ds_read_b32 v189, v177
  s_waitcnt lgkmcnt(0)
  v_cmp_gt_u32 vcc, 1004, v189
  s_nop 0
  s_cbranch_vccnz .Lk1_sp_143
  s_branch .Lk1_k_142
.Lk1_o_145:
.Lk1_sp_147:
  s_sleep 3
  ds_read_b32 v189, v188
  s_waitcnt lgkmcnt(0)
  v_cmp_gt_u32 vcc, 41, v189
  s_nop 0
  s_cbranch_vccnz .Lk1_sp_147
  s_branch .Lk1_k_146
.Lk1_o_148:
.Lk1_fl_150:
  s_sleep 1
  global_load_dword v206, v205, s[12:13] sc1
  s_waitcnt vmcnt(0)
  v_cmp_ne_u32 vcc, v159, v206
  s_cbranch_vccnz .Lk1_fl_150
  s_branch .Lk1_k_149
.Lk1_o_151:
.Lk1_sp_153:
  s_sleep 3
  ds_read_b32 v189, v177
  s_waitcnt lgkmcnt(0)
  v_cmp_gt_u32 vcc, 1005, v189
  s_nop 0
  s_cbranch_vccnz .Lk1_sp_153
  s_branch .Lk1_k_152
.Lk1_o_154:
  s_waitcnt vmcnt(0)
  s_barrier
  s_cmp_eq_u32 s4, 0
  s_cbranch_scc0 .Lk1_s_156
  s_mov_b64 exec, 1
  global_store_dword v157, v159, s[12:13] sc1
  s_mov_b64 exec, -1
.Lk1_s_156:
  s_branch .Lk1_fin
  s_branch .Lk1_k_155
.Lk1_o_158:
.Lk1_fl_160:
  s_sleep 1
  global_load_dword v206, v205, s[12:13] sc1
  s_waitcnt vmcnt(0)
  v_cmp_ne_u32 vcc, v159, v206
  s_cbranch_vccnz .Lk1_fl_160
  s_branch .Lk1_k_159
.Lk1_o_161:
  s_mov_b64 exec, 1
  global_store_dword v157, v159, s[12:13] sc1
  s_mov_b64 exec, -1
  s_branch .Lk1_k_162
.Lcode_end:
.section .rodata,"a"
.p2align 6
.amdhsa_kernel concat_heads__mha_block_cached__gqa_block_cached__near_ridge_kernel
  .amdhsa_next_free_vgpr 256
  .amdhsa_next_free_sgpr 102
  .amdhsa_accum_offset 256
  .amdhsa_group_segment_fixed_size 0
  .amdhsa_kernarg_size 104
  .amdhsa_user_sgpr_count 2
  .amdhsa_user_sgpr_kernarg_segment_ptr 1
  .amdhsa_system_sgpr_workgroup_id_x 1
.end_amdhsa_kernel
```
